```python
import torch

def _softmax(x, axis=-1):
    return torch.softmax(x, dim=axis)
def _gelu(x):
    return torch.nn.functional.gelu(x, approximate="tanh")
def _silu(x):
    return torch.nn.functional.silu(x)
def _sigmoid(x):
    return torch.sigmoid(x)
def _layernorm(x, axis=-1, eps=1e-5):
    m = x.mean(dim=axis, keepdim=True)
    v = x.var(dim=axis, keepdim=True, unbiased=False)
    return (x - m) / torch.sqrt(v + eps)
def _scatter_add(tgt, idx, src, axis=0):
    return tgt.clone().index_add_(axis, idx, src)
def _segment_sum(src, seg, n):
    out = torch.zeros((n,) + src.shape[1:], dtype=src.dtype)
    return out.index_add_(0, seg, src)
def _pad(x, pw):
    flat = tuple(v for pair in reversed(pw) for v in pair)
    return torch.nn.functional.pad(x, flat)

kernel_name = 'recurrent_scan__gqa_block_cached__mixer_channel_mlp__prompt'

def setup_inputs():

    _w = (lambda a: (lambda t: t.to(torch.bfloat16) if t.is_floating_point() else t)(torch.as_tensor(a)))
    def _A_setup():
        B, Sq, D = 1, 2048, 448
        Hq, Hkv, Sk, Dh = 16, 8, 2048, 256
        assert Hq % Hkv == 0, (Hq, Hkv)
        return {
            "x": _w((lambda *s: torch.randn(*s, dtype=torch.bfloat16) * 0.05)(B, Sq, D)),
            "k_cache": _w((lambda *s: torch.randn(*s, dtype=torch.bfloat16) * 1.6)(B, Hkv, Sk, Dh)),
            "v_cache": _w((lambda *s: torch.randn(*s, dtype=torch.bfloat16) * 0.8)(B, Hkv, Sk, Dh)),
            "wq": _w((lambda *s: torch.randn(*s, dtype=torch.bfloat16) * 1.6)(D, Hq * Dh) * (D ** -0.5)),
            "wo": _w((lambda *s: torch.randn(*s, dtype=torch.bfloat16) * 0.8)(Hq * Dh, D) * ((Hq * Dh) ** -0.5)),
        }
    _A_in = _A_setup()

    def _B_setup():
        B, S, D, F = 1, 2048, 448, 1792
        return {
            "x": _w((lambda *s: torch.randn(*s, dtype=torch.bfloat16) * 0.05)(B, S, D)),
            "w1": _w((lambda *s: torch.randn(*s, dtype=torch.bfloat16) * 1.6)(D, F) * (D ** -0.5)),
            "b1": _w((lambda *s: torch.randn(*s, dtype=torch.bfloat16) * 0.8)(F)),
            "w2": _w((lambda *s: torch.randn(*s, dtype=torch.bfloat16) * 0.2)(F, D) * (F ** -0.5)),
            "b2": _w((lambda *s: torch.randn(*s, dtype=torch.bfloat16) * 0.2)(D)),
        }
    _B_in = _B_setup()

    return {
        "A_x": _A_in["x"],
        "A_k_cache": _A_in["k_cache"],
        "A_v_cache": _A_in["v_cache"],
        "A_wq": _A_in["wq"],
        "A_wo": _A_in["wo"],
        "B_x": _B_in["x"],
        "B_w1": _B_in["w1"],
        "B_b1": _B_in["b1"],
        "B_w2": _B_in["w2"],
        "B_b2": _B_in["b2"],
    }

def reference(A_x, A_k_cache, A_v_cache, A_wq, A_wo, B_x, B_w1, B_b1, B_w2, B_b2):
    def _A_ref(x, k_cache, v_cache, wq, wo):
        B, Sq, D = x.shape
        Hq, Dh = 16, 256
        Hkv = k_cache.shape[1]
        rep = Hq // Hkv
        q = (lambda x, *d: x.permute(*d))((x @ wq).reshape(B, Sq, Hq, Dh), 0, 2, 1, 3)
        k = (lambda x, n, axis: torch.repeat_interleave(x, n, dim=axis))(k_cache, rep, axis=1)
        v = (lambda x, n, axis: torch.repeat_interleave(x, n, dim=axis))(v_cache, rep, axis=1)
        scores = torch.einsum("bhqd,bhkd->bhqk", q, k) * (Dh ** -0.5)
        p = _softmax(scores, axis=-1)
        o = torch.einsum("bhqk,bhkd->bhqd", p, v)
        return (lambda x, *d: x.permute(*d))(o, 0, 2, 1, 3).reshape(B, Sq, Hq * Dh) @ wo

    def _B_ref(x, w1, b1, w2, b2):
        y = _layernorm(x, axis=-1)
        h = _gelu(torch.einsum("bsd,df->bsf", y, w1) + b1)
        return torch.einsum("bsf,fd->bsd", h, w2) + b2

    x = A_x
    xn = _layernorm(x, axis=-1)
    s = _A_ref(xn, A_k_cache, A_v_cache, A_wq, A_wo)
    g = _silu(_B_ref(xn, B_w1, B_b1, B_w2, B_b2))
    return x + s * g
```

```asm
; @launch grid=(256,1,1) block=(512,1,1) lds=163840
.amdgcn_target "amdgcn-amd-amdhsa--gfx950"
.text
.globl recurrent_scan__gqa_block_cached__mixer_channel_mlp__prompt_kernel
.p2align 8
.type recurrent_scan__gqa_block_cached__mixer_channel_mlp__prompt_kernel,@function
recurrent_scan__gqa_block_cached__mixer_channel_mlp__prompt_kernel:
    s_cmp_ge_u32 s2, 256
    s_cbranch_scc1 L_end
    s_load_dwordx8 s[76:83], s[0:1], 0
    s_load_dwordx2 s[84:85], s[0:1], 32
    s_load_dwordx8 s[88:95], s[0:1], 48
    s_load_dwordx4 s[96:99], s[0:1], 88
    v_and_b32 v1, 63, v0
    v_lshrrev_b32 v5, 6, v0
    s_nop 0
    v_readfirstlane_b32 s40, v5
    s_and_b32 s41, s2, 7
    s_lshr_b32 s42, s2, 3
    v_and_b32 v2, 15, v1
    v_lshrrev_b32 v3, 4, v1
    s_and_b32 s43, s40, 3
    s_lshr_b32 s44, s40, 2
    s_waitcnt lgkmcnt(0)
    s_mul_i32 s54, s42, 57344
    s_add_u32 s4, s76, s54
    s_addc_u32 s5, s77, 0
    s_mov_b32 s6, 57344
    s_mov_b32 s7, 0x00020000
    v_lshrrev_b32 v5, 3, v1
    s_lshl_b32 s54, s40, 3
    v_add_u32 v5, s54, v5
    v_mul_u32_u24 v5, 896, v5
    v_and_b32 v6, 7, v1
    v_lshlrev_b32 v6, 4, v6
    v_add_u32 v5, v5, v6
    buffer_load_dwordx4 v[100:103], v5, s[4:7], 0 offen offset:0
    buffer_load_dwordx4 v[104:107], v5, s[4:7], 0 offen offset:128
    buffer_load_dwordx4 v[108:111], v5, s[4:7], 0 offen offset:256
    buffer_load_dwordx4 v[112:115], v5, s[4:7], 0 offen offset:384
    buffer_load_dwordx4 v[116:119], v5, s[4:7], 0 offen offset:512
    buffer_load_dwordx4 v[120:123], v5, s[4:7], 0 offen offset:640
    buffer_load_dwordx4 v[124:127], v5, s[4:7], 0 offen offset:768
    s_mul_i32 s54, s41, 448
    s_add_u32 s8, s88, s54
    s_addc_u32 s9, s89, 0
    s_mov_b32 s10, 0
    s_mov_b32 s11, 0x00020000
    s_sub_u32 s10, 1605632, s54
    s_add_u32 s32, s90, s54
    s_addc_u32 s33, s91, 0
    s_mov_b32 s34, 448
    s_mov_b32 s35, 0x00020000
    s_mul_i32 s54, s41, 200704
    s_add_u32 s12, s92, s54
    s_addc_u32 s13, s93, 0
    s_mov_b32 s14, 200704
    s_mov_b32 s15, 0x00020000
    s_lshl_b32 s54, s41, 10
    s_add_u32 s16, s82, s54
    s_addc_u32 s17, s83, 0
    s_mov_b32 s18, 0
    s_mov_b32 s19, 0x00020000
    s_sub_u32 s18, 3670016, s54
    s_lshl_b32 s54, s41, 20
    s_add_u32 s20, s78, s54
    s_addc_u32 s21, s79, 0
    s_mov_b32 s22, 1048576
    s_mov_b32 s23, 0x00020000
    s_add_u32 s24, s80, s54
    s_addc_u32 s25, s81, 0
    s_mov_b32 s26, 1048576
    s_mov_b32 s27, 0x00020000
    s_mul_i32 s54, s41, 458752
    s_add_u32 s28, s84, s54
    s_addc_u32 s29, s85, 0
    s_mov_b32 s30, 458752
    s_mov_b32 s31, 0x00020000
    s_mov_b32 s36, s98
    s_mov_b32 s37, s99
    s_mov_b32 s38, 268435456
    s_mov_b32 s39, 0x00020000
    v_bfe_u32 v5, v1, 2, 2
    v_lshl_add_u32 v5, v3, 2, v5
    v_mul_u32_u24 v5, 1056, v5
    v_and_b32 v6, 3, v1
    v_lshlrev_b32 v6, 3, v6
    v_add_u32 v4, v5, v6
    v_lshlrev_b32 v9, 4, v1
    v_lshrrev_b32 v5, 5, v1
    v_and_b32 v6, 31, v1
    v_lshlrev_b32 v6, 4, v6
    v_mul_u32_u24 v7, 14336, v5
    v_add_u32 v10, v7, v6
    v_cmp_gt_u32 vcc, 448, v6
    v_mov_b32 v7, 0x7fffffff
    s_nop 0
    v_cndmask_b32 v10, v7, v10, vcc
    v_lshlrev_b32 v7, 13, v5
    v_add_u32 v13, v7, v6
    s_lshr_b32 s54, s40, 1
    s_lshl_b32 s54, s54, 3
    s_and_b32 s55, s40, 1
    s_lshl_b32 s55, s55, 1
    s_add_u32 s54, s54, s55
    s_lshl_b32 s62, s54, 13
    s_mul_i32 s64, s54, 3584
    s_mul_i32 s63, s40, 1792
    s_mul_i32 s65, s40, 2112
    s_mul_i32 s52, s43, 4224
    s_lshl_b32 s66, s40, 10
    s_mul_i32 s69, s43, 3584
    s_lshr_b32 s54, s43, 1
    s_lshl_b32 s55, s54, 2
    s_mul_i32 s56, s54, 3
    s_add_u32 s56, s56, 8
    s_cmp_lt_u32 s40, 4
    s_cselect_b32 s67, s55, s56
    s_lshl_b32 s54, s67, 5
    v_lshlrev_b32 v5, 3, v3
    v_add_u32 v5, s54, v5
    buffer_load_dwordx2 v[92:93], v5, s[32:35], 0 offen offset:0
    buffer_load_dwordx2 v[94:95], v5, s[32:35], 0 offen offset:32
    buffer_load_dwordx2 v[96:97], v5, s[32:35], 0 offen offset:64
    buffer_load_dwordx2 v[98:99], v5, s[32:35], 0 offen offset:96
    s_mov_b32 s32, s96
    s_mov_b32 s33, s97
    s_mov_b32 s34, 256
    s_mov_b32 s35, 0x00020000
    s_lshl_b32 s54, s42, 3
    s_add_u32 s54, s54, s41
    s_lshl_b32 s54, s54, 3
    s_add_u32 s54, s54, s40
    s_lshl_b32 s54, s54, 7
    s_add_u32 s54, s54, 50331648
    v_mov_b32 v5, 0
    s_mov_b64 exec, 1
    buffer_store_dword v5, v5, s[36:39], s54 offen sc1
    s_mov_b64 exec, -1
    v_lshrrev_b32 v6, 2, v0
    v_and_b32 v7, 3, v0
    s_mul_i32 s54, s42, 14
    v_add_u32 v8, s54, v6
    v_mul_u32_u24 v8, 3584, v8
    v_lshlrev_b32 v7, 7, v7
    v_add_u32 v8, v8, v7
    v_cmp_gt_u32 vcc, 14, v6
    v_mov_b32 v7, 0x7fffffff
    s_nop 0
    v_cndmask_b32 v8, v7, v8, vcc
    buffer_load_dword v163, v8, s[8:11], 0 offen
    v_lshlrev_b32 v5, 7, v0
    s_mul_i32 s54, s42, 6272
    v_cmp_gt_u32 vcc, 6272, v5
    v_mov_b32 v7, 0x7fffffff
    v_add_u32 v8, s54, v5
    v_cndmask_b32 v8, v7, v8, vcc
    buffer_load_dword v163, v8, s[12:15], 0 offen
    v_lshrrev_b32 v6, 3, v0
    v_and_b32 v7, 7, v0
    s_mul_i32 s54, s42, 14
    v_add_u32 v8, s54, v6
    v_mul_u32_u24 v8, 8192, v8
    v_lshlrev_b32 v7, 7, v7
    v_add_u32 v8, v8, v7
    v_cmp_gt_u32 vcc, 14, v6
    v_mov_b32 v7, 0x7fffffff
    s_nop 0
    v_cndmask_b32 v8, v7, v8, vcc
    buffer_load_dword v163, v8, s[16:19], 0 offen
    s_getpc_b64 s[56:57]
L_pc0:
    s_sub_u32 s56, s56, L_pc0-recurrent_scan__gqa_block_cached__mixer_channel_mlp__prompt_kernel
    s_subb_u32 s57, s57, 0
    s_mov_b32 s96, s56
    s_mov_b32 s97, s57
    s_mov_b32 s98, L_codeend-recurrent_scan__gqa_block_cached__mixer_channel_mlp__prompt_kernel
    s_mov_b32 s99, 0x00020000
    v_lshlrev_b32 v5, 7, v0
    s_mul_i32 s54, s42, 2048
    v_cmp_gt_u32 vcc, 2048, v5
    v_mov_b32 v7, 0x7fffffff
    v_add_u32 v8, s54, v5
    v_cndmask_b32 v8, v7, v8, vcc
    buffer_load_dword v163, v8, s[96:99], 0 offen
    v_lshlrev_b32 v5, 7, v0
    s_mul_i32 s54, s42, 2048
    v_cmp_gt_u32 vcc, 2048, v5
    v_mov_b32 v7, 0x7fffffff
    v_add_u32 v8, s54, v5
    v_cndmask_b32 v8, v7, v8, vcc
    buffer_load_dword v163, v8, s[20:23], 0 offen
    v_lshlrev_b32 v5, 7, v0
    s_mul_i32 s54, s42, 1536
    v_cmp_gt_u32 vcc, 1536, v5
    v_mov_b32 v7, 0x7fffffff
    v_add_u32 v8, s54, v5
    v_cndmask_b32 v8, v7, v8, vcc
    buffer_load_dword v163, v8, s[24:27], 0 offen
    v_cmp_gt_u32 vcc, 56, v1
    v_mov_b32 v6, 0x7fffffff
    s_nop 0
    v_cndmask_b32 v0, v6, v9, vcc
    s_add_u32 s60, s64, 0
    s_add_u32 m0, s65, 0
    s_nop 0
    buffer_load_dwordx4 v10, s[8:11], s60 offen lds
    s_add_u32 s60, s60, 3584
    s_add_u32 m0, m0, 1056
    s_nop 0
    buffer_load_dwordx4 v10, s[8:11], s60 offen lds
    s_add_u32 s60, s64, 114688
    s_add_u32 m0, s65, 16896
    s_nop 0
    buffer_load_dwordx4 v10, s[8:11], s60 offen lds
    s_add_u32 s60, s60, 3584
    s_add_u32 m0, m0, 1056
    s_nop 0
    buffer_load_dwordx4 v10, s[8:11], s60 offen lds
    v_mov_b32 v18, 0x3f803f80
    s_mov_b32 s70, 0x3b124925
    s_mov_b32 s71, 0x3727c5ac
    v_lshrrev_b32 v5, 3, v1
    s_and_b32 s55, s40, 1
    s_lshl_b32 s55, s55, 3
    v_add_u32 v5, s55, v5
    v_and_b32 v6, 3, v1
    v_xor_b32 v5, v5, v6
    v_bfe_u32 v7, v1, 2, 1
    v_mul_u32_u24 v8, 12, v7
    v_xor_b32 v5, v5, v8
    v_lshlrev_b32 v5, 4, v5
    v_lshlrev_b32 v6, 8, v6
    v_lshlrev_b32 v7, 10, v7
    v_add3_u32 v5, v5, v6, v7
    s_lshr_b32 s54, s40, 1
    s_mul_i32 s54, s54, 14336
    s_add_u32 s54, s54, 101376
    v_add_u32 v19, s54, v5
    v_accvgpr_write_b32 a90, v19
    s_waitcnt vmcnt(15)
    v_mov_b32 v20, 0
    v_mov_b32 v21, 0
    v_mov_b32 v22, 0
    v_mov_b32 v23, 0
    v_dot2_f32_bf16 v20, v100, v18, v20
    v_dot2_f32_bf16 v22, v100, v100, v22
    v_dot2_f32_bf16 v21, v101, v18, v21
    v_dot2_f32_bf16 v23, v101, v101, v23
    v_dot2_f32_bf16 v20, v102, v18, v20
    v_dot2_f32_bf16 v22, v102, v102, v22
    v_dot2_f32_bf16 v21, v103, v18, v21
    v_dot2_f32_bf16 v23, v103, v103, v23
    v_dot2_f32_bf16 v20, v104, v18, v20
    v_dot2_f32_bf16 v22, v104, v104, v22
    v_dot2_f32_bf16 v21, v105, v18, v21
    v_dot2_f32_bf16 v23, v105, v105, v23
    v_dot2_f32_bf16 v20, v106, v18, v20
    v_dot2_f32_bf16 v22, v106, v106, v22
    v_dot2_f32_bf16 v21, v107, v18, v21
    v_dot2_f32_bf16 v23, v107, v107, v23
    v_dot2_f32_bf16 v20, v108, v18, v20
    v_dot2_f32_bf16 v22, v108, v108, v22
    v_dot2_f32_bf16 v21, v109, v18, v21
    v_dot2_f32_bf16 v23, v109, v109, v23
    v_dot2_f32_bf16 v20, v110, v18, v20
    v_dot2_f32_bf16 v22, v110, v110, v22
    v_dot2_f32_bf16 v21, v111, v18, v21
    v_dot2_f32_bf16 v23, v111, v111, v23
    v_dot2_f32_bf16 v20, v112, v18, v20
    v_dot2_f32_bf16 v22, v112, v112, v22
    v_dot2_f32_bf16 v21, v113, v18, v21
    v_dot2_f32_bf16 v23, v113, v113, v23
    v_dot2_f32_bf16 v20, v114, v18, v20
    v_dot2_f32_bf16 v22, v114, v114, v22
    v_dot2_f32_bf16 v21, v115, v18, v21
    v_dot2_f32_bf16 v23, v115, v115, v23
    v_dot2_f32_bf16 v20, v116, v18, v20
    v_dot2_f32_bf16 v22, v116, v116, v22
    v_dot2_f32_bf16 v21, v117, v18, v21
    v_dot2_f32_bf16 v23, v117, v117, v23
    v_dot2_f32_bf16 v20, v118, v18, v20
    v_dot2_f32_bf16 v22, v118, v118, v22
    v_dot2_f32_bf16 v21, v119, v18, v21
    v_dot2_f32_bf16 v23, v119, v119, v23
    v_dot2_f32_bf16 v20, v120, v18, v20
    v_dot2_f32_bf16 v22, v120, v120, v22
    v_dot2_f32_bf16 v21, v121, v18, v21
    v_dot2_f32_bf16 v23, v121, v121, v23
    v_dot2_f32_bf16 v20, v122, v18, v20
    v_dot2_f32_bf16 v22, v122, v122, v22
    v_dot2_f32_bf16 v21, v123, v18, v21
    v_dot2_f32_bf16 v23, v123, v123, v23
    v_dot2_f32_bf16 v20, v124, v18, v20
    v_dot2_f32_bf16 v22, v124, v124, v22
    v_dot2_f32_bf16 v21, v125, v18, v21
    v_dot2_f32_bf16 v23, v125, v125, v23
    v_dot2_f32_bf16 v20, v126, v18, v20
    v_dot2_f32_bf16 v22, v126, v126, v22
    v_dot2_f32_bf16 v21, v127, v18, v21
    v_dot2_f32_bf16 v23, v127, v127, v23
    s_nop 2
    v_add_f32 v20, v20, v21
    v_add_f32 v22, v22, v23
    s_nop 1
    v_add_f32_dpp v20, v20, v20 quad_perm:[1,0,3,2] row_mask:0xf bank_mask:0xf
    v_add_f32_dpp v22, v22, v22 quad_perm:[1,0,3,2] row_mask:0xf bank_mask:0xf
    s_nop 1
    v_add_f32_dpp v20, v20, v20 quad_perm:[2,3,0,1] row_mask:0xf bank_mask:0xf
    v_add_f32_dpp v22, v22, v22 quad_perm:[2,3,0,1] row_mask:0xf bank_mask:0xf
    s_nop 1
    v_add_f32_dpp v20, v20, v20 row_half_mirror row_mask:0xf bank_mask:0xf
    v_add_f32_dpp v22, v22, v22 row_half_mirror row_mask:0xf bank_mask:0xf
    v_mul_f32 v20, s70, v20
    v_mul_f32 v22, s70, v22
    v_fma_f32 v22, -v20, v20, v22
    v_max_f32 v22, 0, v22
    v_cvt_pk_bf16_f32 v20, v20, v20
    v_and_b32 v20, 0xffff0000, v20
    v_cvt_pk_bf16_f32 v22, v22, v22
    v_and_b32 v22, 0xffff0000, v22
    v_add_f32 v22, s71, v22
    v_cvt_pk_bf16_f32 v22, v22, v22
    v_and_b32 v22, 0xffff0000, v22
    v_sqrt_f32 v22, v22
    s_nop 0
    v_cvt_pk_bf16_f32 v22, v22, v22
    v_and_b32 v22, 0xffff0000, v22
    v_rcp_f32 v24, v22
    s_nop 0
    v_mul_f32 v26, v20, v24
    v_sub_f32 v26, 0, v26
    v_mov_b32 v25, v24
    v_mov_b32 v27, v26
    v_lshlrev_b32 v28, 16, v100
    v_and_b32 v29, 0xffff0000, v100
    v_pk_fma_f32 v[28:29], v[28:29], v[24:25], v[26:27]
    v_cvt_pk_bf16_f32 v100, v28, v29
    v_lshlrev_b32 v30, 16, v101
    v_and_b32 v31, 0xffff0000, v101
    v_pk_fma_f32 v[30:31], v[30:31], v[24:25], v[26:27]
    v_cvt_pk_bf16_f32 v101, v30, v31
    v_lshlrev_b32 v32, 16, v102
    v_and_b32 v33, 0xffff0000, v102
    v_pk_fma_f32 v[32:33], v[32:33], v[24:25], v[26:27]
    v_cvt_pk_bf16_f32 v102, v32, v33
    v_lshlrev_b32 v34, 16, v103
    v_and_b32 v35, 0xffff0000, v103
    v_pk_fma_f32 v[34:35], v[34:35], v[24:25], v[26:27]
    v_cvt_pk_bf16_f32 v103, v34, v35
    v_lshlrev_b32 v28, 16, v104
    v_and_b32 v29, 0xffff0000, v104
    v_pk_fma_f32 v[28:29], v[28:29], v[24:25], v[26:27]
    v_cvt_pk_bf16_f32 v104, v28, v29
    v_lshlrev_b32 v30, 16, v105
    v_and_b32 v31, 0xffff0000, v105
    v_pk_fma_f32 v[30:31], v[30:31], v[24:25], v[26:27]
    v_cvt_pk_bf16_f32 v105, v30, v31
    v_lshlrev_b32 v32, 16, v106
    v_and_b32 v33, 0xffff0000, v106
    v_pk_fma_f32 v[32:33], v[32:33], v[24:25], v[26:27]
    v_cvt_pk_bf16_f32 v106, v32, v33
    v_lshlrev_b32 v34, 16, v107
    v_and_b32 v35, 0xffff0000, v107
    v_pk_fma_f32 v[34:35], v[34:35], v[24:25], v[26:27]
    v_cvt_pk_bf16_f32 v107, v34, v35
    v_lshlrev_b32 v28, 16, v108
    v_and_b32 v29, 0xffff0000, v108
    v_pk_fma_f32 v[28:29], v[28:29], v[24:25], v[26:27]
    v_cvt_pk_bf16_f32 v108, v28, v29
    v_lshlrev_b32 v30, 16, v109
    v_and_b32 v31, 0xffff0000, v109
    v_pk_fma_f32 v[30:31], v[30:31], v[24:25], v[26:27]
    v_cvt_pk_bf16_f32 v109, v30, v31
    v_lshlrev_b32 v32, 16, v110
    v_and_b32 v33, 0xffff0000, v110
    v_pk_fma_f32 v[32:33], v[32:33], v[24:25], v[26:27]
    v_cvt_pk_bf16_f32 v110, v32, v33
    v_lshlrev_b32 v34, 16, v111
    v_and_b32 v35, 0xffff0000, v111
    v_pk_fma_f32 v[34:35], v[34:35], v[24:25], v[26:27]
    v_cvt_pk_bf16_f32 v111, v34, v35
    v_lshlrev_b32 v28, 16, v112
    v_and_b32 v29, 0xffff0000, v112
    v_pk_fma_f32 v[28:29], v[28:29], v[24:25], v[26:27]
    v_cvt_pk_bf16_f32 v112, v28, v29
    v_lshlrev_b32 v30, 16, v113
    v_and_b32 v31, 0xffff0000, v113
    v_pk_fma_f32 v[30:31], v[30:31], v[24:25], v[26:27]
    v_cvt_pk_bf16_f32 v113, v30, v31
    v_lshlrev_b32 v32, 16, v114
    v_and_b32 v33, 0xffff0000, v114
    v_pk_fma_f32 v[32:33], v[32:33], v[24:25], v[26:27]
    v_cvt_pk_bf16_f32 v114, v32, v33
    v_lshlrev_b32 v34, 16, v115
    v_and_b32 v35, 0xffff0000, v115
    v_pk_fma_f32 v[34:35], v[34:35], v[24:25], v[26:27]
    v_cvt_pk_bf16_f32 v115, v34, v35
    v_lshlrev_b32 v28, 16, v116
    v_and_b32 v29, 0xffff0000, v116
    v_pk_fma_f32 v[28:29], v[28:29], v[24:25], v[26:27]
    v_cvt_pk_bf16_f32 v116, v28, v29
    v_lshlrev_b32 v30, 16, v117
    v_and_b32 v31, 0xffff0000, v117
    v_pk_fma_f32 v[30:31], v[30:31], v[24:25], v[26:27]
    v_cvt_pk_bf16_f32 v117, v30, v31
    v_lshlrev_b32 v32, 16, v118
    v_and_b32 v33, 0xffff0000, v118
    v_pk_fma_f32 v[32:33], v[32:33], v[24:25], v[26:27]
    v_cvt_pk_bf16_f32 v118, v32, v33
    v_lshlrev_b32 v34, 16, v119
    v_and_b32 v35, 0xffff0000, v119
    v_pk_fma_f32 v[34:35], v[34:35], v[24:25], v[26:27]
    v_cvt_pk_bf16_f32 v119, v34, v35
    v_lshlrev_b32 v28, 16, v120
    v_and_b32 v29, 0xffff0000, v120
    v_pk_fma_f32 v[28:29], v[28:29], v[24:25], v[26:27]
    v_cvt_pk_bf16_f32 v120, v28, v29
    v_lshlrev_b32 v30, 16, v121
    v_and_b32 v31, 0xffff0000, v121
    v_pk_fma_f32 v[30:31], v[30:31], v[24:25], v[26:27]
    v_cvt_pk_bf16_f32 v121, v30, v31
    v_lshlrev_b32 v32, 16, v122
    v_and_b32 v33, 0xffff0000, v122
    v_pk_fma_f32 v[32:33], v[32:33], v[24:25], v[26:27]
    v_cvt_pk_bf16_f32 v122, v32, v33
    v_lshlrev_b32 v34, 16, v123
    v_and_b32 v35, 0xffff0000, v123
    v_pk_fma_f32 v[34:35], v[34:35], v[24:25], v[26:27]
    v_cvt_pk_bf16_f32 v123, v34, v35
    v_lshlrev_b32 v28, 16, v124
    v_and_b32 v29, 0xffff0000, v124
    v_pk_fma_f32 v[28:29], v[28:29], v[24:25], v[26:27]
    v_cvt_pk_bf16_f32 v124, v28, v29
    v_lshlrev_b32 v30, 16, v125
    v_and_b32 v31, 0xffff0000, v125
    v_pk_fma_f32 v[30:31], v[30:31], v[24:25], v[26:27]
    v_cvt_pk_bf16_f32 v125, v30, v31
    v_lshlrev_b32 v32, 16, v126
    v_and_b32 v33, 0xffff0000, v126
    v_pk_fma_f32 v[32:33], v[32:33], v[24:25], v[26:27]
    v_cvt_pk_bf16_f32 v126, v32, v33
    v_lshlrev_b32 v34, 16, v127
    v_and_b32 v35, 0xffff0000, v127
    v_pk_fma_f32 v[34:35], v[34:35], v[24:25], v[26:27]
    v_cvt_pk_bf16_f32 v127, v34, v35
    s_add_u32 s60, s64, 229376
    s_add_u32 m0, s65, 33792
    s_nop 0
    buffer_load_dwordx4 v10, s[8:11], s60 offen lds
    s_add_u32 s60, s60, 3584
    s_add_u32 m0, m0, 1056
    s_nop 0
    buffer_load_dwordx4 v10, s[8:11], s60 offen lds
    s_add_u32 s60, s64, 344064
    s_add_u32 m0, s65, 50688
    s_nop 0
    buffer_load_dwordx4 v10, s[8:11], s60 offen lds
    s_add_u32 s60, s60, 3584
    s_add_u32 m0, m0, 1056
    s_nop 0
    buffer_load_dwordx4 v10, s[8:11], s60 offen lds
    v_mov_b32 v20, 0
    v_mov_b32 v21, 0
    v_mov_b32 v22, 0
    v_mov_b32 v23, 0
    v_dot2_f32_bf16 v20, v100, v18, v20
    v_dot2_f32_bf16 v22, v100, v100, v22
    v_dot2_f32_bf16 v21, v101, v18, v21
    v_dot2_f32_bf16 v23, v101, v101, v23
    v_dot2_f32_bf16 v20, v102, v18, v20
    v_dot2_f32_bf16 v22, v102, v102, v22
    v_dot2_f32_bf16 v21, v103, v18, v21
    v_dot2_f32_bf16 v23, v103, v103, v23
    v_dot2_f32_bf16 v20, v104, v18, v20
    v_dot2_f32_bf16 v22, v104, v104, v22
    v_dot2_f32_bf16 v21, v105, v18, v21
    v_dot2_f32_bf16 v23, v105, v105, v23
    v_dot2_f32_bf16 v20, v106, v18, v20
    v_dot2_f32_bf16 v22, v106, v106, v22
    v_dot2_f32_bf16 v21, v107, v18, v21
    v_dot2_f32_bf16 v23, v107, v107, v23
    v_dot2_f32_bf16 v20, v108, v18, v20
    v_dot2_f32_bf16 v22, v108, v108, v22
    v_dot2_f32_bf16 v21, v109, v18, v21
    v_dot2_f32_bf16 v23, v109, v109, v23
    v_dot2_f32_bf16 v20, v110, v18, v20
    v_dot2_f32_bf16 v22, v110, v110, v22
    v_dot2_f32_bf16 v21, v111, v18, v21
    v_dot2_f32_bf16 v23, v111, v111, v23
    v_dot2_f32_bf16 v20, v112, v18, v20
    v_dot2_f32_bf16 v22, v112, v112, v22
    v_dot2_f32_bf16 v21, v113, v18, v21
    v_dot2_f32_bf16 v23, v113, v113, v23
    v_dot2_f32_bf16 v20, v114, v18, v20
    v_dot2_f32_bf16 v22, v114, v114, v22
    v_dot2_f32_bf16 v21, v115, v18, v21
    v_dot2_f32_bf16 v23, v115, v115, v23
    v_dot2_f32_bf16 v20, v116, v18, v20
    v_dot2_f32_bf16 v22, v116, v116, v22
    v_dot2_f32_bf16 v21, v117, v18, v21
    v_dot2_f32_bf16 v23, v117, v117, v23
    v_dot2_f32_bf16 v20, v118, v18, v20
    v_dot2_f32_bf16 v22, v118, v118, v22
    v_dot2_f32_bf16 v21, v119, v18, v21
    v_dot2_f32_bf16 v23, v119, v119, v23
    v_dot2_f32_bf16 v20, v120, v18, v20
    v_dot2_f32_bf16 v22, v120, v120, v22
    v_dot2_f32_bf16 v21, v121, v18, v21
    v_dot2_f32_bf16 v23, v121, v121, v23
    v_dot2_f32_bf16 v20, v122, v18, v20
    v_dot2_f32_bf16 v22, v122, v122, v22
    v_dot2_f32_bf16 v21, v123, v18, v21
    v_dot2_f32_bf16 v23, v123, v123, v23
    v_dot2_f32_bf16 v20, v124, v18, v20
    v_dot2_f32_bf16 v22, v124, v124, v22
    v_dot2_f32_bf16 v21, v125, v18, v21
    v_dot2_f32_bf16 v23, v125, v125, v23
    v_dot2_f32_bf16 v20, v126, v18, v20
    v_dot2_f32_bf16 v22, v126, v126, v22
    v_dot2_f32_bf16 v21, v127, v18, v21
    v_dot2_f32_bf16 v23, v127, v127, v23
    s_nop 2
    v_add_f32 v20, v20, v21
    v_add_f32 v22, v22, v23
    s_nop 1
    v_add_f32_dpp v20, v20, v20 quad_perm:[1,0,3,2] row_mask:0xf bank_mask:0xf
    v_add_f32_dpp v22, v22, v22 quad_perm:[1,0,3,2] row_mask:0xf bank_mask:0xf
    s_nop 1
    v_add_f32_dpp v20, v20, v20 quad_perm:[2,3,0,1] row_mask:0xf bank_mask:0xf
    v_add_f32_dpp v22, v22, v22 quad_perm:[2,3,0,1] row_mask:0xf bank_mask:0xf
    s_nop 1
    v_add_f32_dpp v20, v20, v20 row_half_mirror row_mask:0xf bank_mask:0xf
    v_add_f32_dpp v22, v22, v22 row_half_mirror row_mask:0xf bank_mask:0xf
    v_mul_f32 v20, s70, v20
    v_mul_f32 v22, s70, v22
    v_fma_f32 v22, -v20, v20, v22
    v_max_f32 v22, 0, v22
    v_cvt_pk_bf16_f32 v20, v20, v20
    v_and_b32 v20, 0xffff0000, v20
    v_cvt_pk_bf16_f32 v22, v22, v22
    v_and_b32 v22, 0xffff0000, v22
    v_add_f32 v22, s71, v22
    v_cvt_pk_bf16_f32 v22, v22, v22
    v_and_b32 v22, 0xffff0000, v22
    v_sqrt_f32 v22, v22
    s_nop 0
    v_cvt_pk_bf16_f32 v22, v22, v22
    v_and_b32 v22, 0xffff0000, v22
    v_rcp_f32 v24, v22
    s_nop 0
    v_mul_f32 v26, v20, v24
    v_sub_f32 v26, 0, v26
    v_mov_b32 v25, v24
    v_mov_b32 v27, v26
    v_lshlrev_b32 v28, 16, v100
    v_and_b32 v29, 0xffff0000, v100
    v_pk_fma_f32 v[28:29], v[28:29], v[24:25], v[26:27]
    v_cvt_pk_bf16_f32 v64, v28, v29
    v_lshlrev_b32 v30, 16, v101
    v_and_b32 v31, 0xffff0000, v101
    v_pk_fma_f32 v[30:31], v[30:31], v[24:25], v[26:27]
    v_cvt_pk_bf16_f32 v65, v30, v31
    v_lshlrev_b32 v32, 16, v102
    v_and_b32 v33, 0xffff0000, v102
    v_pk_fma_f32 v[32:33], v[32:33], v[24:25], v[26:27]
    v_cvt_pk_bf16_f32 v66, v32, v33
    v_lshlrev_b32 v34, 16, v103
    v_and_b32 v35, 0xffff0000, v103
    v_pk_fma_f32 v[34:35], v[34:35], v[24:25], v[26:27]
    v_cvt_pk_bf16_f32 v67, v34, v35
    v_lshlrev_b32 v28, 16, v104
    v_and_b32 v29, 0xffff0000, v104
    v_pk_fma_f32 v[28:29], v[28:29], v[24:25], v[26:27]
    v_cvt_pk_bf16_f32 v68, v28, v29
    v_lshlrev_b32 v30, 16, v105
    v_and_b32 v31, 0xffff0000, v105
    v_pk_fma_f32 v[30:31], v[30:31], v[24:25], v[26:27]
    v_cvt_pk_bf16_f32 v69, v30, v31
    v_lshlrev_b32 v32, 16, v106
    v_and_b32 v33, 0xffff0000, v106
    v_pk_fma_f32 v[32:33], v[32:33], v[24:25], v[26:27]
    v_cvt_pk_bf16_f32 v70, v32, v33
    v_lshlrev_b32 v34, 16, v107
    v_and_b32 v35, 0xffff0000, v107
    v_pk_fma_f32 v[34:35], v[34:35], v[24:25], v[26:27]
    v_cvt_pk_bf16_f32 v71, v34, v35
    v_lshlrev_b32 v28, 16, v108
    v_and_b32 v29, 0xffff0000, v108
    v_pk_fma_f32 v[28:29], v[28:29], v[24:25], v[26:27]
    v_cvt_pk_bf16_f32 v72, v28, v29
    v_lshlrev_b32 v30, 16, v109
    v_and_b32 v31, 0xffff0000, v109
    v_pk_fma_f32 v[30:31], v[30:31], v[24:25], v[26:27]
    v_cvt_pk_bf16_f32 v73, v30, v31
    v_lshlrev_b32 v32, 16, v110
    v_and_b32 v33, 0xffff0000, v110
    v_pk_fma_f32 v[32:33], v[32:33], v[24:25], v[26:27]
    v_cvt_pk_bf16_f32 v74, v32, v33
    v_lshlrev_b32 v34, 16, v111
    v_and_b32 v35, 0xffff0000, v111
    v_pk_fma_f32 v[34:35], v[34:35], v[24:25], v[26:27]
    v_cvt_pk_bf16_f32 v75, v34, v35
    v_lshlrev_b32 v28, 16, v112
    v_and_b32 v29, 0xffff0000, v112
    v_pk_fma_f32 v[28:29], v[28:29], v[24:25], v[26:27]
    v_cvt_pk_bf16_f32 v76, v28, v29
    v_lshlrev_b32 v30, 16, v113
    v_and_b32 v31, 0xffff0000, v113
    v_pk_fma_f32 v[30:31], v[30:31], v[24:25], v[26:27]
    v_cvt_pk_bf16_f32 v77, v30, v31
    v_lshlrev_b32 v32, 16, v114
    v_and_b32 v33, 0xffff0000, v114
    v_pk_fma_f32 v[32:33], v[32:33], v[24:25], v[26:27]
    v_cvt_pk_bf16_f32 v78, v32, v33
    v_lshlrev_b32 v34, 16, v115
    v_and_b32 v35, 0xffff0000, v115
    v_pk_fma_f32 v[34:35], v[34:35], v[24:25], v[26:27]
    v_cvt_pk_bf16_f32 v79, v34, v35
    v_lshlrev_b32 v28, 16, v116
    v_and_b32 v29, 0xffff0000, v116
    v_pk_fma_f32 v[28:29], v[28:29], v[24:25], v[26:27]
    v_cvt_pk_bf16_f32 v80, v28, v29
    v_lshlrev_b32 v30, 16, v117
    v_and_b32 v31, 0xffff0000, v117
    v_pk_fma_f32 v[30:31], v[30:31], v[24:25], v[26:27]
    v_cvt_pk_bf16_f32 v81, v30, v31
    v_lshlrev_b32 v32, 16, v118
    v_and_b32 v33, 0xffff0000, v118
    v_pk_fma_f32 v[32:33], v[32:33], v[24:25], v[26:27]
    v_cvt_pk_bf16_f32 v82, v32, v33
    v_lshlrev_b32 v34, 16, v119
    v_and_b32 v35, 0xffff0000, v119
    v_pk_fma_f32 v[34:35], v[34:35], v[24:25], v[26:27]
    v_cvt_pk_bf16_f32 v83, v34, v35
    v_lshlrev_b32 v28, 16, v120
    v_and_b32 v29, 0xffff0000, v120
    v_pk_fma_f32 v[28:29], v[28:29], v[24:25], v[26:27]
    v_cvt_pk_bf16_f32 v84, v28, v29
    v_lshlrev_b32 v30, 16, v121
    v_and_b32 v31, 0xffff0000, v121
    v_pk_fma_f32 v[30:31], v[30:31], v[24:25], v[26:27]
    v_cvt_pk_bf16_f32 v85, v30, v31
    v_lshlrev_b32 v32, 16, v122
    v_and_b32 v33, 0xffff0000, v122
    v_pk_fma_f32 v[32:33], v[32:33], v[24:25], v[26:27]
    v_cvt_pk_bf16_f32 v86, v32, v33
    v_lshlrev_b32 v34, 16, v123
    v_and_b32 v35, 0xffff0000, v123
    v_pk_fma_f32 v[34:35], v[34:35], v[24:25], v[26:27]
    v_cvt_pk_bf16_f32 v87, v34, v35
    v_lshlrev_b32 v28, 16, v124
    v_and_b32 v29, 0xffff0000, v124
    v_pk_fma_f32 v[28:29], v[28:29], v[24:25], v[26:27]
    v_cvt_pk_bf16_f32 v88, v28, v29
    v_lshlrev_b32 v30, 16, v125
    v_and_b32 v31, 0xffff0000, v125
    v_pk_fma_f32 v[30:31], v[30:31], v[24:25], v[26:27]
    v_cvt_pk_bf16_f32 v89, v30, v31
    v_lshlrev_b32 v32, 16, v126
    v_and_b32 v33, 0xffff0000, v126
    v_pk_fma_f32 v[32:33], v[32:33], v[24:25], v[26:27]
    v_cvt_pk_bf16_f32 v90, v32, v33
    v_lshlrev_b32 v34, 16, v127
    v_and_b32 v35, 0xffff0000, v127
    v_pk_fma_f32 v[34:35], v[34:35], v[24:25], v[26:27]
    v_cvt_pk_bf16_f32 v91, v34, v35
    s_add_u32 s60, s64, 458752
    s_add_u32 m0, s65, 67584
    s_nop 0
    buffer_load_dwordx4 v10, s[8:11], s60 offen lds
    s_add_u32 s60, s60, 3584
    s_add_u32 m0, m0, 1056
    s_nop 0
    buffer_load_dwordx4 v10, s[8:11], s60 offen lds
    s_add_u32 s60, s64, 573440
    s_add_u32 m0, s65, 84480
    s_nop 0
    buffer_load_dwordx4 v10, s[8:11], s60 offen lds
    s_add_u32 s60, s60, 3584
    s_add_u32 m0, m0, 1056
    s_nop 0
    buffer_load_dwordx4 v10, s[8:11], s60 offen lds
    ds_write_b128 v19, v[64:67] offset:0
    ds_write_b128 v19, v[68:71] offset:2048
    ds_write_b128 v19, v[72:75] offset:4096
    ds_write_b128 v19, v[76:79] offset:6144
    ds_write_b128 v19, v[80:83] offset:8192
    ds_write_b128 v19, v[84:87] offset:10240
    ds_write_b128 v19, v[88:91] offset:12288
    s_lshr_b32 s54, s43, 1
    s_lshl_b32 s55, s54, 2
    s_mul_i32 s56, s54, 3
    s_add_u32 s56, s56, 8
    s_cmp_lt_u32 s40, 4
    s_cselect_b32 s67, s55, s56
    s_lshl_b32 s54, s67, 5
    v_add_u32 v14, s54, v4
    s_and_b32 s55, s40, 1
    s_mul_i32 s55, s55, 28672
    s_add_u32 s55, s55, 101376
    v_xor_b32 v5, v2, v3
    v_lshlrev_b32 v6, 8, v3
    v_xor_b32 v7, 12, v5
    v_lshl_add_u32 v15, v5, 4, v6
    v_lshl_add_u32 v16, v7, 4, v6
    v_add_u32 v15, s55, v15
    v_add_u32 v16, s55, v16
    s_waitcnt vmcnt(19)
    v_lshlrev_b32 v20, 16, v92
    v_and_b32 v21, 0xffff0000, v92
    v_lshlrev_b32 v22, 16, v93
    v_and_b32 v23, 0xffff0000, v93
    v_lshlrev_b32 v24, 16, v94
    v_and_b32 v25, 0xffff0000, v94
    v_lshlrev_b32 v26, 16, v95
    v_and_b32 v27, 0xffff0000, v95
    v_lshlrev_b32 v28, 16, v96
    v_and_b32 v29, 0xffff0000, v96
    v_lshlrev_b32 v30, 16, v97
    v_and_b32 v31, 0xffff0000, v97
    v_lshlrev_b32 v32, 16, v98
    v_and_b32 v33, 0xffff0000, v98
    v_lshlrev_b32 v34, 16, v99
    v_and_b32 v35, 0xffff0000, v99
    v_mov_b32 v84, 0xbdd2d3e8
    v_mov_b32 v85, 0xbdd2d3e8
    v_mov_b32 v86, 0xc0135761
    v_mov_b32 v87, 0xc0135761
    v_mov_b32 v88, 1.0
    v_mov_b32 v89, 1.0
    s_and_b32 s68, s40, 1
    s_mul_i32 s68, s68, 14336
    s_add_u32 s68, s68, 101376
    s_mul_i32 s54, s43, 7
    s_lshl_b32 s55, s44, 2
    s_add_u32 s54, s54, s55
    s_lshl_b32 s71, s54, 11
    s_lshl_b32 s54, s54, 5
    v_add_u32 v18, s54, v4
    s_lshl_b32 s54, s40, 7
    v_add_u32 v19, s54, v4
    v_add_u32 v17, 101376, v9
    s_cmp_lt_u32 s40, 4
    s_cbranch_scc0 L_mlpB
    s_waitcnt vmcnt(4)
    s_waitcnt lgkmcnt(0)
    s_barrier
    v_add_u32 v11, 0, v14
    v_add_u32 v12, 16896, v14
    ds_read_b64_tr_b16 a[0:1], v11 offset:0
    ds_read_b64_tr_b16 a[2:3], v11 offset:512
    ds_read_b64_tr_b16 a[4:5], v11 offset:32
    ds_read_b64_tr_b16 a[6:7], v11 offset:544
    ds_read_b64_tr_b16 a[8:9], v11 offset:64
    ds_read_b64_tr_b16 a[10:11], v11 offset:576
    ds_read_b64_tr_b16 a[12:13], v11 offset:96
    ds_read_b64_tr_b16 a[14:15], v11 offset:608
    ds_read_b64_tr_b16 a[16:17], v12 offset:0
    ds_read_b64_tr_b16 a[18:19], v12 offset:512
    ds_read_b64_tr_b16 a[20:21], v12 offset:32
    ds_read_b64_tr_b16 a[22:23], v12 offset:544
    ds_read_b64_tr_b16 a[24:25], v12 offset:64
    ds_read_b64_tr_b16 a[26:27], v12 offset:576
    ds_read_b64_tr_b16 a[28:29], v12 offset:96
    s_waitcnt lgkmcnt(8)
    ds_read_b64_tr_b16 a[30:31], v12 offset:608
    ds_read_b128 v[128:131], v15 offset:0
    ds_read_b128 v[132:135], v15 offset:14336
    ds_read_b128 v[136:139], v16 offset:1024
    ds_read_b128 v[140:143], v16 offset:15360
    s_waitcnt lgkmcnt(0)
    v_mfma_f32_16x16x32_bf16 v[36:39], a[0:3], v[128:131], v[20:23]
    v_add_u32 v11, 33792, v14
    v_add_u32 v12, 50688, v14
    ds_read_b128 v[144:147], v15 offset:2048
    v_mfma_f32_16x16x32_bf16 v[40:43], a[0:3], v[132:135], v[20:23]
    ds_read_b128 v[148:151], v15 offset:16384
    ds_read_b128 v[152:155], v16 offset:3072
    v_mfma_f32_16x16x32_bf16 v[44:47], a[4:7], v[128:131], v[24:27]
    ds_read_b128 v[156:159], v16 offset:17408
    ds_read_b64_tr_b16 a[32:33], v11 offset:0
    ds_read_b64_tr_b16 a[34:35], v11 offset:512
    v_mfma_f32_16x16x32_bf16 v[48:51], a[4:7], v[132:135], v[24:27]
    ds_read_b64_tr_b16 a[36:37], v11 offset:32
    ds_read_b64_tr_b16 a[38:39], v11 offset:544
    v_mfma_f32_16x16x32_bf16 v[52:55], a[8:11], v[128:131], v[28:31]
    ds_read_b64_tr_b16 a[40:41], v11 offset:64
    ds_read_b64_tr_b16 a[42:43], v11 offset:576
    ds_read_b64_tr_b16 a[44:45], v11 offset:96
    v_mfma_f32_16x16x32_bf16 v[56:59], a[8:11], v[132:135], v[28:31]
    ds_read_b64_tr_b16 a[46:47], v11 offset:608
    ds_read_b64_tr_b16 a[48:49], v12 offset:0
    v_mfma_f32_16x16x32_bf16 v[60:63], a[12:15], v[128:131], v[32:35]
    ds_read_b64_tr_b16 a[50:51], v12 offset:512
    ds_read_b64_tr_b16 a[52:53], v12 offset:32
    s_waitcnt lgkmcnt(8)
    ds_read_b64_tr_b16 a[54:55], v12 offset:544
    v_mfma_f32_16x16x32_bf16 v[64:67], a[12:15], v[132:135], v[32:35]
    ds_read_b64_tr_b16 a[56:57], v12 offset:64
    ds_read_b64_tr_b16 a[58:59], v12 offset:576
    v_mfma_f32_16x16x32_bf16 v[36:39], a[16:19], v[136:139], v[36:39]
    ds_read_b64_tr_b16 a[60:61], v12 offset:96
    ds_read_b64_tr_b16 a[62:63], v12 offset:608
    v_mfma_f32_16x16x32_bf16 v[40:43], a[16:19], v[140:143], v[40:43]
    v_mfma_f32_16x16x32_bf16 v[44:47], a[20:23], v[136:139], v[44:47]
    v_mfma_f32_16x16x32_bf16 v[48:51], a[20:23], v[140:143], v[48:51]
    v_mfma_f32_16x16x32_bf16 v[52:55], a[24:27], v[136:139], v[52:55]
    v_mfma_f32_16x16x32_bf16 v[56:59], a[24:27], v[140:143], v[56:59]
    s_waitcnt vmcnt(0)
    s_waitcnt lgkmcnt(0)
    s_barrier
    v_mfma_f32_16x16x32_bf16 v[60:63], a[28:31], v[136:139], v[60:63]
    v_mfma_f32_16x16x32_bf16 v[64:67], a[28:31], v[140:143], v[64:67]
    v_mfma_f32_16x16x32_bf16 v[36:39], a[32:35], v[144:147], v[36:39]
    v_add_u32 v11, 67584, v14
    v_add_u32 v12, 84480, v14
    ds_read_b128 v[128:131], v15 offset:4096
    s_add_u32 s60, s64, 688128
    s_add_u32 m0, s65, 0
    s_nop 0
    buffer_load_dwordx4 v10, s[8:11], s60 offen lds
    v_mfma_f32_16x16x32_bf16 v[40:43], a[32:35], v[148:151], v[40:43]
    ds_read_b128 v[132:135], v15 offset:18432
    ds_read_b128 v[136:139], v16 offset:5120
    v_mfma_f32_16x16x32_bf16 v[44:47], a[36:39], v[144:147], v[44:47]
    ds_read_b128 v[140:143], v16 offset:19456
    ds_read_b64_tr_b16 a[0:1], v11 offset:0
    ds_read_b64_tr_b16 a[2:3], v11 offset:512
    s_add_u32 s60, s60, 3584
    s_add_u32 m0, m0, 1056
    s_nop 0
    buffer_load_dwordx4 v10, s[8:11], s60 offen lds
    v_mfma_f32_16x16x32_bf16 v[48:51], a[36:39], v[148:151], v[48:51]
    ds_read_b64_tr_b16 a[4:5], v11 offset:32
    ds_read_b64_tr_b16 a[6:7], v11 offset:544
    s_add_u32 s60, s64, 802816
    s_add_u32 m0, s65, 16896
    s_nop 0
    buffer_load_dwordx4 v10, s[8:11], s60 offen lds
    v_mfma_f32_16x16x32_bf16 v[52:55], a[40:43], v[144:147], v[52:55]
    ds_read_b64_tr_b16 a[8:9], v11 offset:64
    ds_read_b64_tr_b16 a[10:11], v11 offset:576
    ds_read_b64_tr_b16 a[12:13], v11 offset:96
    v_mfma_f32_16x16x32_bf16 v[56:59], a[40:43], v[148:151], v[56:59]
    ds_read_b64_tr_b16 a[14:15], v11 offset:608
    ds_read_b64_tr_b16 a[16:17], v12 offset:0
    s_add_u32 s60, s60, 3584
    s_add_u32 m0, m0, 1056
    s_nop 0
    buffer_load_dwordx4 v10, s[8:11], s60 offen lds
    v_mfma_f32_16x16x32_bf16 v[60:63], a[44:47], v[144:147], v[60:63]
    ds_read_b64_tr_b16 a[18:19], v12 offset:512
    ds_read_b64_tr_b16 a[20:21], v12 offset:32
    s_waitcnt lgkmcnt(8)
    ds_read_b64_tr_b16 a[22:23], v12 offset:544
    v_mfma_f32_16x16x32_bf16 v[64:67], a[44:47], v[148:151], v[64:67]
    ds_read_b64_tr_b16 a[24:25], v12 offset:64
    ds_read_b64_tr_b16 a[26:27], v12 offset:576
    s_add_u32 s60, s64, 917504
    s_add_u32 m0, s65, 33792
    s_nop 0
    buffer_load_dwordx4 v10, s[8:11], s60 offen lds
    v_mfma_f32_16x16x32_bf16 v[36:39], a[48:51], v[152:155], v[36:39]
    ds_read_b64_tr_b16 a[28:29], v12 offset:96
    ds_read_b64_tr_b16 a[30:31], v12 offset:608
    s_add_u32 s60, s60, 3584
    s_add_u32 m0, m0, 1056
    s_nop 0
    buffer_load_dwordx4 v10, s[8:11], s60 offen lds
    v_mfma_f32_16x16x32_bf16 v[40:43], a[48:51], v[156:159], v[40:43]
    v_mfma_f32_16x16x32_bf16 v[44:47], a[52:55], v[152:155], v[44:47]
    s_add_u32 s60, s64, 1032192
    s_add_u32 m0, s65, 50688
    s_nop 0
    buffer_load_dwordx4 v10, s[8:11], s60 offen lds
    v_mfma_f32_16x16x32_bf16 v[48:51], a[52:55], v[156:159], v[48:51]
    v_mfma_f32_16x16x32_bf16 v[52:55], a[56:59], v[152:155], v[52:55]
    s_add_u32 s60, s60, 3584
    s_add_u32 m0, m0, 1056
    s_nop 0
    buffer_load_dwordx4 v10, s[8:11], s60 offen lds
    v_mfma_f32_16x16x32_bf16 v[56:59], a[56:59], v[156:159], v[56:59]
    s_waitcnt vmcnt(4)
    s_waitcnt lgkmcnt(0)
    s_barrier
    v_mfma_f32_16x16x32_bf16 v[60:63], a[60:63], v[152:155], v[60:63]
    v_mfma_f32_16x16x32_bf16 v[64:67], a[60:63], v[156:159], v[64:67]
    v_mfma_f32_16x16x32_bf16 v[36:39], a[0:3], v[128:131], v[36:39]
    v_add_u32 v11, 0, v14
    v_add_u32 v12, 16896, v14
    ds_read_b128 v[144:147], v15 offset:6144
    v_mfma_f32_16x16x32_bf16 v[40:43], a[0:3], v[132:135], v[40:43]
    ds_read_b128 v[148:151], v15 offset:20480
    ds_read_b128 v[152:155], v16 offset:7168
    s_add_u32 s60, s64, 1146880
    s_add_u32 m0, s65, 67584
    s_nop 0
    buffer_load_dwordx4 v10, s[8:11], s60 offen lds
    v_mfma_f32_16x16x32_bf16 v[44:47], a[4:7], v[128:131], v[44:47]
    ds_read_b128 v[156:159], v16 offset:21504
    ds_read_b64_tr_b16 a[32:33], v11 offset:0
    ds_read_b64_tr_b16 a[34:35], v11 offset:512
    v_mfma_f32_16x16x32_bf16 v[48:51], a[4:7], v[132:135], v[48:51]
    ds_read_b64_tr_b16 a[36:37], v11 offset:32
    ds_read_b64_tr_b16 a[38:39], v11 offset:544
    v_mfma_f32_16x16x32_bf16 v[52:55], a[8:11], v[128:131], v[52:55]
    ds_read_b64_tr_b16 a[40:41], v11 offset:64
    ds_read_b64_tr_b16 a[42:43], v11 offset:576
    ds_read_b64_tr_b16 a[44:45], v11 offset:96
    s_add_u32 s60, s60, 3584
    s_add_u32 m0, m0, 1056
    s_nop 0
    buffer_load_dwordx4 v10, s[8:11], s60 offen lds
    v_mfma_f32_16x16x32_bf16 v[56:59], a[8:11], v[132:135], v[56:59]
    ds_read_b64_tr_b16 a[46:47], v11 offset:608
    ds_read_b64_tr_b16 a[48:49], v12 offset:0
    v_mfma_f32_16x16x32_bf16 v[60:63], a[12:15], v[128:131], v[60:63]
    ds_read_b64_tr_b16 a[50:51], v12 offset:512
    ds_read_b64_tr_b16 a[52:53], v12 offset:32
    s_waitcnt lgkmcnt(8)
    ds_read_b64_tr_b16 a[54:55], v12 offset:544
    v_mfma_f32_16x16x32_bf16 v[64:67], a[12:15], v[132:135], v[64:67]
    ds_read_b64_tr_b16 a[56:57], v12 offset:64
    ds_read_b64_tr_b16 a[58:59], v12 offset:576
    s_add_u32 s60, s64, 1261568
    s_add_u32 m0, s65, 84480
    s_nop 0
    buffer_load_dwordx4 v10, s[8:11], s60 offen lds
    v_mfma_f32_16x16x32_bf16 v[36:39], a[16:19], v[136:139], v[36:39]
    ds_read_b64_tr_b16 a[60:61], v12 offset:96
    ds_read_b64_tr_b16 a[62:63], v12 offset:608
    v_mfma_f32_16x16x32_bf16 v[40:43], a[16:19], v[140:143], v[40:43]
    v_mfma_f32_16x16x32_bf16 v[44:47], a[20:23], v[136:139], v[44:47]
    v_mfma_f32_16x16x32_bf16 v[48:51], a[20:23], v[140:143], v[48:51]
    s_add_u32 s60, s60, 3584
    s_add_u32 m0, m0, 1056
    s_nop 0
    buffer_load_dwordx4 v10, s[8:11], s60 offen lds
    v_mfma_f32_16x16x32_bf16 v[52:55], a[24:27], v[136:139], v[52:55]
    v_mfma_f32_16x16x32_bf16 v[56:59], a[24:27], v[140:143], v[56:59]
    s_waitcnt vmcnt(4)
    s_waitcnt lgkmcnt(0)
    s_barrier
    v_mfma_f32_16x16x32_bf16 v[60:63], a[28:31], v[136:139], v[60:63]
    v_mfma_f32_16x16x32_bf16 v[64:67], a[28:31], v[140:143], v[64:67]
    v_mfma_f32_16x16x32_bf16 v[36:39], a[32:35], v[144:147], v[36:39]
    v_add_u32 v11, 33792, v14
    v_add_u32 v12, 50688, v14
    ds_read_b128 v[128:131], v15 offset:8192
    v_mfma_f32_16x16x32_bf16 v[40:43], a[32:35], v[148:151], v[40:43]
    ds_read_b128 v[132:135], v15 offset:22528
    ds_read_b128 v[136:139], v16 offset:9216
    s_add_u32 s60, s64, 1376256
    s_add_u32 m0, s65, 0
    s_nop 0
    buffer_load_dwordx4 v10, s[8:11], s60 offen lds
    v_mfma_f32_16x16x32_bf16 v[44:47], a[36:39], v[144:147], v[44:47]
    ds_read_b128 v[140:143], v16 offset:23552
    ds_read_b64_tr_b16 a[0:1], v11 offset:0
    ds_read_b64_tr_b16 a[2:3], v11 offset:512
    v_mfma_f32_16x16x32_bf16 v[48:51], a[36:39], v[148:151], v[48:51]
    ds_read_b64_tr_b16 a[4:5], v11 offset:32
    ds_read_b64_tr_b16 a[6:7], v11 offset:544
    v_mfma_f32_16x16x32_bf16 v[52:55], a[40:43], v[144:147], v[52:55]
    ds_read_b64_tr_b16 a[8:9], v11 offset:64
    ds_read_b64_tr_b16 a[10:11], v11 offset:576
    ds_read_b64_tr_b16 a[12:13], v11 offset:96
    s_add_u32 s60, s60, 3584
    s_add_u32 m0, m0, 1056
    s_nop 0
    buffer_load_dwordx4 v10, s[8:11], s60 offen lds
    v_mfma_f32_16x16x32_bf16 v[56:59], a[40:43], v[148:151], v[56:59]
    ds_read_b64_tr_b16 a[14:15], v11 offset:608
    ds_read_b64_tr_b16 a[16:17], v12 offset:0
    v_mfma_f32_16x16x32_bf16 v[60:63], a[44:47], v[144:147], v[60:63]
    ds_read_b64_tr_b16 a[18:19], v12 offset:512
    ds_read_b64_tr_b16 a[20:21], v12 offset:32
    s_waitcnt lgkmcnt(8)
    ds_read_b64_tr_b16 a[22:23], v12 offset:544
    v_mfma_f32_16x16x32_bf16 v[64:67], a[44:47], v[148:151], v[64:67]
    ds_read_b64_tr_b16 a[24:25], v12 offset:64
    ds_read_b64_tr_b16 a[26:27], v12 offset:576
    s_add_u32 s60, s64, 1490944
    s_add_u32 m0, s65, 16896
    s_nop 0
    buffer_load_dwordx4 v10, s[8:11], s60 offen lds
    v_mfma_f32_16x16x32_bf16 v[36:39], a[48:51], v[152:155], v[36:39]
    ds_read_b64_tr_b16 a[28:29], v12 offset:96
    ds_read_b64_tr_b16 a[30:31], v12 offset:608
    v_mfma_f32_16x16x32_bf16 v[40:43], a[48:51], v[156:159], v[40:43]
    v_mfma_f32_16x16x32_bf16 v[44:47], a[52:55], v[152:155], v[44:47]
    v_mfma_f32_16x16x32_bf16 v[48:51], a[52:55], v[156:159], v[48:51]
    s_add_u32 s60, s60, 3584
    s_add_u32 m0, m0, 1056
    s_nop 0
    buffer_load_dwordx4 v10, s[8:11], s60 offen lds
    v_mfma_f32_16x16x32_bf16 v[52:55], a[56:59], v[152:155], v[52:55]
    v_mfma_f32_16x16x32_bf16 v[56:59], a[56:59], v[156:159], v[56:59]
    s_waitcnt vmcnt(4)
    s_waitcnt lgkmcnt(0)
    s_barrier
    v_mfma_f32_16x16x32_bf16 v[60:63], a[60:63], v[152:155], v[60:63]
    v_mfma_f32_16x16x32_bf16 v[64:67], a[60:63], v[156:159], v[64:67]
    v_mfma_f32_16x16x32_bf16 v[36:39], a[0:3], v[128:131], v[36:39]
    v_add_u32 v11, 67584, v14
    v_add_u32 v12, 84480, v14
    ds_read_b128 v[144:147], v15 offset:10240
    v_mfma_f32_16x16x32_bf16 v[40:43], a[0:3], v[132:135], v[40:43]
    ds_read_b128 v[148:151], v15 offset:24576
    ds_read_b128 v[152:155], v16 offset:11264
    s_add_u32 s60, s63, 0
    s_add_u32 m0, s65, 33792
    s_nop 0
    buffer_load_dwordx4 v0, s[12:15], s60 offen lds
    v_mfma_f32_16x16x32_bf16 v[44:47], a[4:7], v[128:131], v[44:47]
    ds_read_b128 v[156:159], v16 offset:25600
    ds_read_b64_tr_b16 a[32:33], v11 offset:0
    ds_read_b64_tr_b16 a[34:35], v11 offset:512
    v_mfma_f32_16x16x32_bf16 v[48:51], a[4:7], v[132:135], v[48:51]
    ds_read_b64_tr_b16 a[36:37], v11 offset:32
    ds_read_b64_tr_b16 a[38:39], v11 offset:544
    v_mfma_f32_16x16x32_bf16 v[52:55], a[8:11], v[128:131], v[52:55]
    ds_read_b64_tr_b16 a[40:41], v11 offset:64
    ds_read_b64_tr_b16 a[42:43], v11 offset:576
    ds_read_b64_tr_b16 a[44:45], v11 offset:96
    s_add_u32 s60, s60, 896
    s_add_u32 m0, m0, 1056
    s_nop 0
    buffer_load_dwordx4 v0, s[12:15], s60 offen lds
    v_mfma_f32_16x16x32_bf16 v[56:59], a[8:11], v[132:135], v[56:59]
    ds_read_b64_tr_b16 a[46:47], v11 offset:608
    ds_read_b64_tr_b16 a[48:49], v12 offset:0
    v_mfma_f32_16x16x32_bf16 v[60:63], a[12:15], v[128:131], v[60:63]
    ds_read_b64_tr_b16 a[50:51], v12 offset:512
    ds_read_b64_tr_b16 a[52:53], v12 offset:32
    s_waitcnt lgkmcnt(8)
    ds_read_b64_tr_b16 a[54:55], v12 offset:544
    v_mfma_f32_16x16x32_bf16 v[64:67], a[12:15], v[132:135], v[64:67]
    ds_read_b64_tr_b16 a[56:57], v12 offset:64
    ds_read_b64_tr_b16 a[58:59], v12 offset:576
    s_add_u32 s60, s63, 14336
    s_add_u32 m0, s65, 50688
    s_nop 0
    buffer_load_dwordx4 v0, s[12:15], s60 offen lds
    v_mfma_f32_16x16x32_bf16 v[36:39], a[16:19], v[136:139], v[36:39]
    ds_read_b64_tr_b16 a[60:61], v12 offset:96
    ds_read_b64_tr_b16 a[62:63], v12 offset:608
    v_mfma_f32_16x16x32_bf16 v[40:43], a[16:19], v[140:143], v[40:43]
    v_mfma_f32_16x16x32_bf16 v[44:47], a[20:23], v[136:139], v[44:47]
    v_mfma_f32_16x16x32_bf16 v[48:51], a[20:23], v[140:143], v[48:51]
    s_add_u32 s60, s60, 896
    s_add_u32 m0, m0, 1056
    s_nop 0
    buffer_load_dwordx4 v0, s[12:15], s60 offen lds
    v_mfma_f32_16x16x32_bf16 v[52:55], a[24:27], v[136:139], v[52:55]
    v_mfma_f32_16x16x32_bf16 v[56:59], a[24:27], v[140:143], v[56:59]
    s_waitcnt vmcnt(4)
    s_waitcnt lgkmcnt(0)
    s_barrier
    v_mfma_f32_16x16x32_bf16 v[60:63], a[28:31], v[136:139], v[60:63]
    v_mfma_f32_16x16x32_bf16 v[64:67], a[28:31], v[140:143], v[64:67]
    v_mfma_f32_16x16x32_bf16 v[36:39], a[32:35], v[144:147], v[36:39]
    v_add_u32 v11, 0, v14
    v_add_u32 v12, 16896, v14
    ds_read_b128 v[128:131], v15 offset:12288
    v_mfma_f32_16x16x32_bf16 v[40:43], a[32:35], v[148:151], v[40:43]
    ds_read_b128 v[132:135], v15 offset:26624
    ds_read_b128 v[136:139], v16 offset:13312
    s_add_u32 s60, s63, 28672
    s_add_u32 m0, s65, 67584
    s_nop 0
    buffer_load_dwordx4 v0, s[12:15], s60 offen lds
    v_mfma_f32_16x16x32_bf16 v[44:47], a[36:39], v[144:147], v[44:47]
    ds_read_b128 v[140:143], v16 offset:27648
    ds_read_b64_tr_b16 a[0:1], v11 offset:0
    ds_read_b64_tr_b16 a[2:3], v11 offset:512
    v_mfma_f32_16x16x32_bf16 v[48:51], a[36:39], v[148:151], v[48:51]
    ds_read_b64_tr_b16 a[4:5], v11 offset:32
    ds_read_b64_tr_b16 a[6:7], v11 offset:544
    v_mfma_f32_16x16x32_bf16 v[52:55], a[40:43], v[144:147], v[52:55]
    ds_read_b64_tr_b16 a[8:9], v11 offset:64
    ds_read_b64_tr_b16 a[10:11], v11 offset:576
    ds_read_b64_tr_b16 a[12:13], v11 offset:96
    s_add_u32 s60, s60, 896
    s_add_u32 m0, m0, 1056
    s_nop 0
    buffer_load_dwordx4 v0, s[12:15], s60 offen lds
    v_mfma_f32_16x16x32_bf16 v[56:59], a[40:43], v[148:151], v[56:59]
    ds_read_b64_tr_b16 a[14:15], v11 offset:608
    ds_read_b64_tr_b16 a[16:17], v12 offset:0
    v_mfma_f32_16x16x32_bf16 v[60:63], a[44:47], v[144:147], v[60:63]
    ds_read_b64_tr_b16 a[18:19], v12 offset:512
    ds_read_b64_tr_b16 a[20:21], v12 offset:32
    s_waitcnt lgkmcnt(8)
    ds_read_b64_tr_b16 a[22:23], v12 offset:544
    v_mfma_f32_16x16x32_bf16 v[64:67], a[44:47], v[148:151], v[64:67]
    ds_read_b64_tr_b16 a[24:25], v12 offset:64
    ds_read_b64_tr_b16 a[26:27], v12 offset:576
    s_add_u32 s60, s63, 43008
    s_add_u32 m0, s65, 84480
    s_nop 0
    buffer_load_dwordx4 v0, s[12:15], s60 offen lds
    v_mfma_f32_16x16x32_bf16 v[36:39], a[48:51], v[152:155], v[36:39]
    ds_read_b64_tr_b16 a[28:29], v12 offset:96
    ds_read_b64_tr_b16 a[30:31], v12 offset:608
    v_mfma_f32_16x16x32_bf16 v[40:43], a[48:51], v[156:159], v[40:43]
    v_mfma_f32_16x16x32_bf16 v[44:47], a[52:55], v[152:155], v[44:47]
    v_mfma_f32_16x16x32_bf16 v[48:51], a[52:55], v[156:159], v[48:51]
    s_add_u32 s60, s60, 896
    s_add_u32 m0, m0, 1056
    s_nop 0
    buffer_load_dwordx4 v0, s[12:15], s60 offen lds
    v_mfma_f32_16x16x32_bf16 v[52:55], a[56:59], v[152:155], v[52:55]
    v_mfma_f32_16x16x32_bf16 v[56:59], a[56:59], v[156:159], v[56:59]
    s_waitcnt vmcnt(4)
    s_waitcnt lgkmcnt(0)
    s_barrier
    v_mfma_f32_16x16x32_bf16 v[60:63], a[60:63], v[152:155], v[60:63]
    v_mfma_f32_16x16x32_bf16 v[64:67], a[60:63], v[156:159], v[64:67]
    v_mfma_f32_16x16x32_bf16 v[36:39], a[0:3], v[128:131], v[36:39]
    v_add_u32 v11, 33792, v18
    v_mfma_f32_16x16x32_bf16 v[40:43], a[0:3], v[132:135], v[40:43]
    v_add_u32 v12, 50688, v18
    s_add_u32 s60, s63, 57344
    s_add_u32 m0, s65, 0
    s_nop 0
    buffer_load_dwordx4 v0, s[12:15], s60 offen lds
    v_mfma_f32_16x16x32_bf16 v[44:47], a[4:7], v[128:131], v[44:47]
    ds_read_b64_tr_b16 a[32:33], v11 offset:0
    v_mfma_f32_16x16x32_bf16 v[48:51], a[4:7], v[132:135], v[48:51]
    ds_read_b64_tr_b16 a[34:35], v12 offset:0
    v_mfma_f32_16x16x32_bf16 v[52:55], a[8:11], v[128:131], v[52:55]
    ds_read_b64_tr_b16 a[36:37], v11 offset:32
    v_mfma_f32_16x16x32_bf16 v[56:59], a[8:11], v[132:135], v[56:59]
    ds_read_b64_tr_b16 a[38:39], v12 offset:32
    s_add_u32 s60, s60, 896
    s_add_u32 m0, m0, 1056
    s_nop 0
    buffer_load_dwordx4 v0, s[12:15], s60 offen lds
    v_mfma_f32_16x16x32_bf16 v[60:63], a[12:15], v[128:131], v[60:63]
    ds_read_b64_tr_b16 a[40:41], v11 offset:64
    v_mfma_f32_16x16x32_bf16 v[64:67], a[12:15], v[132:135], v[64:67]
    ds_read_b64_tr_b16 a[42:43], v12 offset:64
    v_mfma_f32_16x16x32_bf16 v[36:39], a[16:19], v[136:139], v[36:39]
    ds_read_b64_tr_b16 a[44:45], v11 offset:96
    v_mfma_f32_16x16x32_bf16 v[40:43], a[16:19], v[140:143], v[40:43]
    ds_read_b64_tr_b16 a[46:47], v12 offset:96
    s_add_u32 s60, s63, 71680
    s_add_u32 m0, s65, 16896
    s_nop 0
    buffer_load_dwordx4 v0, s[12:15], s60 offen lds
    v_mfma_f32_16x16x32_bf16 v[44:47], a[20:23], v[136:139], v[44:47]
    v_mfma_f32_16x16x32_bf16 v[48:51], a[20:23], v[140:143], v[48:51]
    v_mfma_f32_16x16x32_bf16 v[52:55], a[24:27], v[136:139], v[52:55]
    s_add_u32 s60, s60, 896
    s_add_u32 m0, m0, 1056
    s_nop 0
    buffer_load_dwordx4 v0, s[12:15], s60 offen lds
    v_mfma_f32_16x16x32_bf16 v[56:59], a[24:27], v[140:143], v[56:59]
    v_mfma_f32_16x16x32_bf16 v[60:63], a[28:31], v[136:139], v[60:63]
    v_mfma_f32_16x16x32_bf16 v[64:67], a[28:31], v[140:143], v[64:67]
    s_nop 7
    s_add_u32 s54, s67, 0
    s_lshr_b32 s55, s54, 1
    s_lshl_b32 s55, s55, 10
    s_and_b32 s54, s54, 1
    s_lshl_b32 s54, s54, 3
    s_add_u32 s54, s54, s55
    s_add_u32 s54, s54, s68
    v_add_u32 v8, s54, v9
    v_pk_mul_f32 v[68:69], v[36:37], v[36:37]
    v_pk_mul_f32 v[70:71], v[38:39], v[38:39]
    v_pk_mul_f32 v[72:73], v[40:41], v[40:41]
    v_pk_mul_f32 v[74:75], v[42:43], v[42:43]
    v_pk_fma_f32 v[68:69], v[68:69], v[84:85], v[86:87]
    v_pk_fma_f32 v[70:71], v[70:71], v[84:85], v[86:87]
    v_pk_fma_f32 v[72:73], v[72:73], v[84:85], v[86:87]
    v_pk_fma_f32 v[74:75], v[74:75], v[84:85], v[86:87]
    v_pk_mul_f32 v[68:69], v[68:69], v[36:37]
    v_pk_mul_f32 v[70:71], v[70:71], v[38:39]
    v_pk_mul_f32 v[72:73], v[72:73], v[40:41]
    v_pk_mul_f32 v[74:75], v[74:75], v[42:43]
    v_exp_f32 v68, v68
    v_exp_f32 v69, v69
    v_exp_f32 v70, v70
    v_exp_f32 v71, v71
    v_exp_f32 v72, v72
    v_exp_f32 v73, v73
    v_exp_f32 v74, v74
    v_exp_f32 v75, v75
    v_pk_add_f32 v[68:69], v[68:69], v[88:89]
    v_pk_add_f32 v[70:71], v[70:71], v[88:89]
    v_pk_add_f32 v[72:73], v[72:73], v[88:89]
    v_pk_add_f32 v[74:75], v[74:75], v[88:89]
    v_rcp_f32 v68, v68
    v_rcp_f32 v69, v69
    v_rcp_f32 v70, v70
    v_rcp_f32 v71, v71
    v_rcp_f32 v72, v72
    v_rcp_f32 v73, v73
    v_rcp_f32 v74, v74
    v_rcp_f32 v75, v75
    v_pk_mul_f32 v[36:37], v[36:37], v[68:69]
    v_pk_mul_f32 v[38:39], v[38:39], v[70:71]
    v_pk_mul_f32 v[40:41], v[40:41], v[72:73]
    v_pk_mul_f32 v[42:43], v[42:43], v[74:75]
    v_cvt_pk_bf16_f32 v68, v36, v37
    v_cvt_pk_bf16_f32 v69, v38, v39
    ds_write_b64 v8, v[68:69] offset:0
    v_cvt_pk_bf16_f32 v72, v40, v41
    v_cvt_pk_bf16_f32 v73, v42, v43
    ds_write_b64 v8, v[72:73] offset:7168
    s_add_u32 s54, s67, 1
    s_lshr_b32 s55, s54, 1
    s_lshl_b32 s55, s55, 10
    s_and_b32 s54, s54, 1
    s_lshl_b32 s54, s54, 3
    s_add_u32 s54, s54, s55
    s_add_u32 s54, s54, s68
    v_add_u32 v8, s54, v9
    v_pk_mul_f32 v[76:77], v[44:45], v[44:45]
    v_pk_mul_f32 v[78:79], v[46:47], v[46:47]
    v_pk_mul_f32 v[80:81], v[48:49], v[48:49]
    v_pk_mul_f32 v[82:83], v[50:51], v[50:51]
    v_pk_fma_f32 v[76:77], v[76:77], v[84:85], v[86:87]
    v_pk_fma_f32 v[78:79], v[78:79], v[84:85], v[86:87]
    v_pk_fma_f32 v[80:81], v[80:81], v[84:85], v[86:87]
    v_pk_fma_f32 v[82:83], v[82:83], v[84:85], v[86:87]
    v_pk_mul_f32 v[76:77], v[76:77], v[44:45]
    v_pk_mul_f32 v[78:79], v[78:79], v[46:47]
    v_pk_mul_f32 v[80:81], v[80:81], v[48:49]
    v_pk_mul_f32 v[82:83], v[82:83], v[50:51]
    v_exp_f32 v76, v76
    v_exp_f32 v77, v77
    v_exp_f32 v78, v78
    v_exp_f32 v79, v79
    v_exp_f32 v80, v80
    v_exp_f32 v81, v81
    v_exp_f32 v82, v82
    v_exp_f32 v83, v83
    v_pk_add_f32 v[76:77], v[76:77], v[88:89]
    v_pk_add_f32 v[78:79], v[78:79], v[88:89]
    v_pk_add_f32 v[80:81], v[80:81], v[88:89]
    v_pk_add_f32 v[82:83], v[82:83], v[88:89]
    v_rcp_f32 v76, v76
    v_rcp_f32 v77, v77
    v_rcp_f32 v78, v78
    v_rcp_f32 v79, v79
    v_rcp_f32 v80, v80
    v_rcp_f32 v81, v81
    v_rcp_f32 v82, v82
    v_rcp_f32 v83, v83
    v_pk_mul_f32 v[44:45], v[44:45], v[76:77]
    v_pk_mul_f32 v[46:47], v[46:47], v[78:79]
    v_pk_mul_f32 v[48:49], v[48:49], v[80:81]
    v_pk_mul_f32 v[50:51], v[50:51], v[82:83]
    v_cvt_pk_bf16_f32 v76, v44, v45
    v_cvt_pk_bf16_f32 v77, v46, v47
    ds_write_b64 v8, v[76:77] offset:0
    v_cvt_pk_bf16_f32 v80, v48, v49
    v_cvt_pk_bf16_f32 v81, v50, v51
    ds_write_b64 v8, v[80:81] offset:7168
    s_add_u32 s54, s67, 2
    s_lshr_b32 s55, s54, 1
    s_lshl_b32 s55, s55, 10
    s_and_b32 s54, s54, 1
    s_lshl_b32 s54, s54, 3
    s_add_u32 s54, s54, s55
    s_add_u32 s54, s54, s68
    v_add_u32 v8, s54, v9
    v_pk_mul_f32 v[68:69], v[52:53], v[52:53]
    v_pk_mul_f32 v[70:71], v[54:55], v[54:55]
    v_pk_mul_f32 v[72:73], v[56:57], v[56:57]
    v_pk_mul_f32 v[74:75], v[58:59], v[58:59]
    v_pk_fma_f32 v[68:69], v[68:69], v[84:85], v[86:87]
    v_pk_fma_f32 v[70:71], v[70:71], v[84:85], v[86:87]
    v_pk_fma_f32 v[72:73], v[72:73], v[84:85], v[86:87]
    v_pk_fma_f32 v[74:75], v[74:75], v[84:85], v[86:87]
    v_pk_mul_f32 v[68:69], v[68:69], v[52:53]
    v_pk_mul_f32 v[70:71], v[70:71], v[54:55]
    v_pk_mul_f32 v[72:73], v[72:73], v[56:57]
    v_pk_mul_f32 v[74:75], v[74:75], v[58:59]
    v_exp_f32 v68, v68
    v_exp_f32 v69, v69
    v_exp_f32 v70, v70
    v_exp_f32 v71, v71
    v_exp_f32 v72, v72
    v_exp_f32 v73, v73
    v_exp_f32 v74, v74
    v_exp_f32 v75, v75
    v_pk_add_f32 v[68:69], v[68:69], v[88:89]
    v_pk_add_f32 v[70:71], v[70:71], v[88:89]
    v_pk_add_f32 v[72:73], v[72:73], v[88:89]
    v_pk_add_f32 v[74:75], v[74:75], v[88:89]
    v_rcp_f32 v68, v68
    v_rcp_f32 v69, v69
    v_rcp_f32 v70, v70
    v_rcp_f32 v71, v71
    v_rcp_f32 v72, v72
    v_rcp_f32 v73, v73
    v_rcp_f32 v74, v74
    v_rcp_f32 v75, v75
    v_pk_mul_f32 v[52:53], v[52:53], v[68:69]
    v_pk_mul_f32 v[54:55], v[54:55], v[70:71]
    v_pk_mul_f32 v[56:57], v[56:57], v[72:73]
    v_pk_mul_f32 v[58:59], v[58:59], v[74:75]
    v_cvt_pk_bf16_f32 v68, v52, v53
    v_cvt_pk_bf16_f32 v69, v54, v55
    ds_write_b64 v8, v[68:69] offset:0
    v_cvt_pk_bf16_f32 v72, v56, v57
    v_cvt_pk_bf16_f32 v73, v58, v59
    ds_write_b64 v8, v[72:73] offset:7168
    s_add_u32 s54, s67, 3
    s_lshr_b32 s55, s54, 1
    s_lshl_b32 s55, s55, 10
    s_and_b32 s54, s54, 1
    s_lshl_b32 s54, s54, 3
    s_add_u32 s54, s54, s55
    s_add_u32 s54, s54, s68
    v_add_u32 v8, s54, v9
    v_pk_mul_f32 v[76:77], v[60:61], v[60:61]
    v_pk_mul_f32 v[78:79], v[62:63], v[62:63]
    v_pk_mul_f32 v[80:81], v[64:65], v[64:65]
    v_pk_mul_f32 v[82:83], v[66:67], v[66:67]
    v_pk_fma_f32 v[76:77], v[76:77], v[84:85], v[86:87]
    v_pk_fma_f32 v[78:79], v[78:79], v[84:85], v[86:87]
    v_pk_fma_f32 v[80:81], v[80:81], v[84:85], v[86:87]
    v_pk_fma_f32 v[82:83], v[82:83], v[84:85], v[86:87]
    v_pk_mul_f32 v[76:77], v[76:77], v[60:61]
    v_pk_mul_f32 v[78:79], v[78:79], v[62:63]
    v_pk_mul_f32 v[80:81], v[80:81], v[64:65]
    v_pk_mul_f32 v[82:83], v[82:83], v[66:67]
    v_exp_f32 v76, v76
    v_exp_f32 v77, v77
    v_exp_f32 v78, v78
    v_exp_f32 v79, v79
    v_exp_f32 v80, v80
    v_exp_f32 v81, v81
    v_exp_f32 v82, v82
    v_exp_f32 v83, v83
    v_pk_add_f32 v[76:77], v[76:77], v[88:89]
    v_pk_add_f32 v[78:79], v[78:79], v[88:89]
    v_pk_add_f32 v[80:81], v[80:81], v[88:89]
    v_pk_add_f32 v[82:83], v[82:83], v[88:89]
    v_rcp_f32 v76, v76
    v_rcp_f32 v77, v77
    v_rcp_f32 v78, v78
    v_rcp_f32 v79, v79
    v_rcp_f32 v80, v80
    v_rcp_f32 v81, v81
    v_rcp_f32 v82, v82
    v_rcp_f32 v83, v83
    v_pk_mul_f32 v[60:61], v[60:61], v[76:77]
    v_pk_mul_f32 v[62:63], v[62:63], v[78:79]
    v_pk_mul_f32 v[64:65], v[64:65], v[80:81]
    v_pk_mul_f32 v[66:67], v[66:67], v[82:83]
    v_cvt_pk_bf16_f32 v76, v60, v61
    v_cvt_pk_bf16_f32 v77, v62, v63
    ds_write_b64 v8, v[76:77] offset:0
    v_cvt_pk_bf16_f32 v80, v64, v65
    v_cvt_pk_bf16_f32 v81, v66, v67
    ds_write_b64 v8, v[80:81] offset:7168
    s_waitcnt vmcnt(4)
    s_waitcnt lgkmcnt(0)
    s_barrier
    ds_read_b128 a[64:67], v17 offset:0
    ds_read_b128 a[68:71], v17 offset:7168
    ds_read_b128 a[72:75], v17 offset:14336
    ds_read_b128 a[76:79], v17 offset:21504
    s_waitcnt lgkmcnt(0)
    v_mfma_f32_16x16x32_bf16 v[36:39], a[32:35], a[64:67], 0
    v_add_u32 v11, 67584, v18
    v_add_u32 v12, 84480, v18
    v_mfma_f32_16x16x32_bf16 v[40:43], a[32:35], a[68:71], 0
    ds_read_b128 a[0:3], v17 offset:1024
    ds_read_b128 a[4:7], v17 offset:8192
    s_add_u32 s60, s63, 86016
    s_add_u32 m0, s65, 33792
    s_nop 0
    buffer_load_dwordx4 v0, s[12:15], s60 offen lds
    v_mfma_f32_16x16x32_bf16 v[44:47], a[32:35], a[72:75], 0
    ds_read_b128 a[8:11], v17 offset:15360
    v_mfma_f32_16x16x32_bf16 v[48:51], a[32:35], a[76:79], 0
    ds_read_b128 a[12:15], v17 offset:22528
    ds_read_b64_tr_b16 a[48:49], v11 offset:0
    v_mfma_f32_16x16x32_bf16 v[52:55], a[36:39], a[64:67], 0
    ds_read_b64_tr_b16 a[50:51], v12 offset:0
    s_add_u32 s60, s60, 896
    s_add_u32 m0, m0, 1056
    s_nop 0
    buffer_load_dwordx4 v0, s[12:15], s60 offen lds
    v_mfma_f32_16x16x32_bf16 v[56:59], a[36:39], a[68:71], 0
    ds_read_b64_tr_b16 a[52:53], v11 offset:32
    ds_read_b64_tr_b16 a[54:55], v12 offset:32
    v_mfma_f32_16x16x32_bf16 v[60:63], a[36:39], a[72:75], 0
    ds_read_b64_tr_b16 a[56:57], v11 offset:64
    v_mfma_f32_16x16x32_bf16 v[64:67], a[36:39], a[76:79], 0
    ds_read_b64_tr_b16 a[58:59], v12 offset:64
    ds_read_b64_tr_b16 a[60:61], v11 offset:96
    s_add_u32 s60, s63, 100352
    s_add_u32 m0, s65, 50688
    s_nop 0
    buffer_load_dwordx4 v0, s[12:15], s60 offen lds
    v_mfma_f32_16x16x32_bf16 v[68:71], a[40:43], a[64:67], 0
    ds_read_b64_tr_b16 a[62:63], v12 offset:96
    v_mfma_f32_16x16x32_bf16 v[72:75], a[40:43], a[68:71], 0
    v_mfma_f32_16x16x32_bf16 v[76:79], a[40:43], a[72:75], 0
    v_mfma_f32_16x16x32_bf16 v[80:83], a[40:43], a[76:79], 0
    s_add_u32 s60, s60, 896
    s_add_u32 m0, m0, 1056
    s_nop 0
    buffer_load_dwordx4 v0, s[12:15], s60 offen lds
    v_mfma_f32_16x16x32_bf16 v[84:87], a[44:47], a[64:67], 0
    v_mfma_f32_16x16x32_bf16 v[88:91], a[44:47], a[68:71], 0
    s_waitcnt vmcnt(4)
    s_waitcnt lgkmcnt(0)
    s_barrier
    v_mfma_f32_16x16x32_bf16 v[92:95], a[44:47], a[72:75], 0
    v_mfma_f32_16x16x32_bf16 v[96:99], a[44:47], a[76:79], 0
    v_mfma_f32_16x16x32_bf16 v[36:39], a[48:51], a[0:3], v[36:39]
    v_add_u32 v11, 0, v18
    v_add_u32 v12, 16896, v18
    v_mfma_f32_16x16x32_bf16 v[40:43], a[48:51], a[4:7], v[40:43]
    ds_read_b128 a[64:67], v17 offset:2048
    ds_read_b128 a[68:71], v17 offset:9216
    s_add_u32 s60, s63, 114688
    s_add_u32 m0, s65, 67584
    s_nop 0
    buffer_load_dwordx4 v0, s[12:15], s60 offen lds
    v_mfma_f32_16x16x32_bf16 v[44:47], a[48:51], a[8:11], v[44:47]
    ds_read_b128 a[72:75], v17 offset:16384
    v_mfma_f32_16x16x32_bf16 v[48:51], a[48:51], a[12:15], v[48:51]
    ds_read_b128 a[76:79], v17 offset:23552
    ds_read_b64_tr_b16 a[32:33], v11 offset:0
    v_mfma_f32_16x16x32_bf16 v[52:55], a[52:55], a[0:3], v[52:55]
    ds_read_b64_tr_b16 a[34:35], v12 offset:0
    s_add_u32 s60, s60, 896
    s_add_u32 m0, m0, 1056
    s_nop 0
    buffer_load_dwordx4 v0, s[12:15], s60 offen lds
    v_mfma_f32_16x16x32_bf16 v[56:59], a[52:55], a[4:7], v[56:59]
    ds_read_b64_tr_b16 a[36:37], v11 offset:32
    ds_read_b64_tr_b16 a[38:39], v12 offset:32
    v_mfma_f32_16x16x32_bf16 v[60:63], a[52:55], a[8:11], v[60:63]
    ds_read_b64_tr_b16 a[40:41], v11 offset:64
    v_mfma_f32_16x16x32_bf16 v[64:67], a[52:55], a[12:15], v[64:67]
    ds_read_b64_tr_b16 a[42:43], v12 offset:64
    ds_read_b64_tr_b16 a[44:45], v11 offset:96
    s_add_u32 s60, s63, 129024
    s_add_u32 m0, s65, 84480
    s_nop 0
    buffer_load_dwordx4 v0, s[12:15], s60 offen lds
    v_mfma_f32_16x16x32_bf16 v[68:71], a[56:59], a[0:3], v[68:71]
    ds_read_b64_tr_b16 a[46:47], v12 offset:96
    v_mfma_f32_16x16x32_bf16 v[72:75], a[56:59], a[4:7], v[72:75]
    v_mfma_f32_16x16x32_bf16 v[76:79], a[56:59], a[8:11], v[76:79]
    v_mfma_f32_16x16x32_bf16 v[80:83], a[56:59], a[12:15], v[80:83]
    s_add_u32 s60, s60, 896
    s_add_u32 m0, m0, 1056
    s_nop 0
    buffer_load_dwordx4 v0, s[12:15], s60 offen lds
    v_mfma_f32_16x16x32_bf16 v[84:87], a[60:63], a[0:3], v[84:87]
    v_mfma_f32_16x16x32_bf16 v[88:91], a[60:63], a[4:7], v[88:91]
    s_waitcnt vmcnt(4)
    s_waitcnt lgkmcnt(0)
    s_barrier
    v_mfma_f32_16x16x32_bf16 v[92:95], a[60:63], a[8:11], v[92:95]
    v_mfma_f32_16x16x32_bf16 v[96:99], a[60:63], a[12:15], v[96:99]
    v_mfma_f32_16x16x32_bf16 v[36:39], a[32:35], a[64:67], v[36:39]
    v_add_u32 v11, 33792, v18
    v_add_u32 v12, 50688, v18
    v_mfma_f32_16x16x32_bf16 v[40:43], a[32:35], a[68:71], v[40:43]
    ds_read_b128 a[0:3], v17 offset:3072
    ds_read_b128 a[4:7], v17 offset:10240
    s_add_u32 s60, s63, 143360
    s_add_u32 m0, s65, 0
    s_nop 0
    buffer_load_dwordx4 v0, s[12:15], s60 offen lds
    v_mfma_f32_16x16x32_bf16 v[44:47], a[32:35], a[72:75], v[44:47]
    ds_read_b128 a[8:11], v17 offset:17408
    v_mfma_f32_16x16x32_bf16 v[48:51], a[32:35], a[76:79], v[48:51]
    ds_read_b128 a[12:15], v17 offset:24576
    ds_read_b64_tr_b16 a[48:49], v11 offset:0
    v_mfma_f32_16x16x32_bf16 v[52:55], a[36:39], a[64:67], v[52:55]
    ds_read_b64_tr_b16 a[50:51], v12 offset:0
    s_add_u32 s60, s60, 896
    s_add_u32 m0, m0, 1056
    s_nop 0
    buffer_load_dwordx4 v0, s[12:15], s60 offen lds
    v_mfma_f32_16x16x32_bf16 v[56:59], a[36:39], a[68:71], v[56:59]
    ds_read_b64_tr_b16 a[52:53], v11 offset:32
    ds_read_b64_tr_b16 a[54:55], v12 offset:32
    v_mfma_f32_16x16x32_bf16 v[60:63], a[36:39], a[72:75], v[60:63]
    ds_read_b64_tr_b16 a[56:57], v11 offset:64
    v_mfma_f32_16x16x32_bf16 v[64:67], a[36:39], a[76:79], v[64:67]
    ds_read_b64_tr_b16 a[58:59], v12 offset:64
    ds_read_b64_tr_b16 a[60:61], v11 offset:96
    s_add_u32 s60, s63, 157696
    s_add_u32 m0, s65, 16896
    s_nop 0
    buffer_load_dwordx4 v0, s[12:15], s60 offen lds
    v_mfma_f32_16x16x32_bf16 v[68:71], a[40:43], a[64:67], v[68:71]
    ds_read_b64_tr_b16 a[62:63], v12 offset:96
    v_mfma_f32_16x16x32_bf16 v[72:75], a[40:43], a[68:71], v[72:75]
    v_mfma_f32_16x16x32_bf16 v[76:79], a[40:43], a[72:75], v[76:79]
    v_mfma_f32_16x16x32_bf16 v[80:83], a[40:43], a[76:79], v[80:83]
    s_add_u32 s60, s60, 896
    s_add_u32 m0, m0, 1056
    s_nop 0
    buffer_load_dwordx4 v0, s[12:15], s60 offen lds
    v_mfma_f32_16x16x32_bf16 v[84:87], a[44:47], a[64:67], v[84:87]
    v_mfma_f32_16x16x32_bf16 v[88:91], a[44:47], a[68:71], v[88:91]
    s_waitcnt vmcnt(4)
    s_waitcnt lgkmcnt(0)
    s_barrier
    v_mfma_f32_16x16x32_bf16 v[92:95], a[44:47], a[72:75], v[92:95]
    v_mfma_f32_16x16x32_bf16 v[96:99], a[44:47], a[76:79], v[96:99]
    v_mfma_f32_16x16x32_bf16 v[36:39], a[48:51], a[0:3], v[36:39]
    v_add_u32 v11, 67584, v18
    v_add_u32 v12, 84480, v18
    v_mfma_f32_16x16x32_bf16 v[40:43], a[48:51], a[4:7], v[40:43]
    ds_read_b128 a[64:67], v17 offset:4096
    ds_read_b128 a[68:71], v17 offset:11264
    s_add_u32 s60, s63, 172032
    s_add_u32 m0, s65, 33792
    s_nop 0
    buffer_load_dwordx4 v0, s[12:15], s60 offen lds
    v_mfma_f32_16x16x32_bf16 v[44:47], a[48:51], a[8:11], v[44:47]
    ds_read_b128 a[72:75], v17 offset:18432
    v_mfma_f32_16x16x32_bf16 v[48:51], a[48:51], a[12:15], v[48:51]
    ds_read_b128 a[76:79], v17 offset:25600
    ds_read_b64_tr_b16 a[32:33], v11 offset:0
    v_mfma_f32_16x16x32_bf16 v[52:55], a[52:55], a[0:3], v[52:55]
    ds_read_b64_tr_b16 a[34:35], v12 offset:0
    s_add_u32 s60, s60, 896
    s_add_u32 m0, m0, 1056
    s_nop 0
    buffer_load_dwordx4 v0, s[12:15], s60 offen lds
    v_mfma_f32_16x16x32_bf16 v[56:59], a[52:55], a[4:7], v[56:59]
    ds_read_b64_tr_b16 a[36:37], v11 offset:32
    ds_read_b64_tr_b16 a[38:39], v12 offset:32
    v_mfma_f32_16x16x32_bf16 v[60:63], a[52:55], a[8:11], v[60:63]
    ds_read_b64_tr_b16 a[40:41], v11 offset:64
    v_mfma_f32_16x16x32_bf16 v[64:67], a[52:55], a[12:15], v[64:67]
    ds_read_b64_tr_b16 a[42:43], v12 offset:64
    ds_read_b64_tr_b16 a[44:45], v11 offset:96
    s_add_u32 s60, s63, 186368
    s_add_u32 m0, s65, 50688
    s_nop 0
    buffer_load_dwordx4 v0, s[12:15], s60 offen lds
    v_mfma_f32_16x16x32_bf16 v[68:71], a[56:59], a[0:3], v[68:71]
    ds_read_b64_tr_b16 a[46:47], v12 offset:96
    v_mfma_f32_16x16x32_bf16 v[72:75], a[56:59], a[4:7], v[72:75]
    v_mfma_f32_16x16x32_bf16 v[76:79], a[56:59], a[8:11], v[76:79]
    v_mfma_f32_16x16x32_bf16 v[80:83], a[56:59], a[12:15], v[80:83]
    s_add_u32 s60, s60, 896
    s_add_u32 m0, m0, 1056
    s_nop 0
    buffer_load_dwordx4 v0, s[12:15], s60 offen lds
    v_mfma_f32_16x16x32_bf16 v[84:87], a[60:63], a[0:3], v[84:87]
    v_mfma_f32_16x16x32_bf16 v[88:91], a[60:63], a[4:7], v[88:91]
    s_waitcnt vmcnt(4)
    s_waitcnt lgkmcnt(0)
    s_barrier
    v_mfma_f32_16x16x32_bf16 v[92:95], a[60:63], a[8:11], v[92:95]
    v_mfma_f32_16x16x32_bf16 v[96:99], a[60:63], a[12:15], v[96:99]
    v_mfma_f32_16x16x32_bf16 v[36:39], a[32:35], a[64:67], v[36:39]
    v_add_u32 v11, 0, v18
    v_add_u32 v12, 16896, v18
    v_mfma_f32_16x16x32_bf16 v[40:43], a[32:35], a[68:71], v[40:43]
    ds_read_b128 a[0:3], v17 offset:5120
    ds_read_b128 a[4:7], v17 offset:12288
    s_add_u32 s60, s62, 0
    s_add_u32 m0, s65, 67584
    s_nop 0
    buffer_load_dwordx4 v9, s[16:19], s60 offen lds
    v_mfma_f32_16x16x32_bf16 v[44:47], a[32:35], a[72:75], v[44:47]
    ds_read_b128 a[8:11], v17 offset:19456
    v_mfma_f32_16x16x32_bf16 v[48:51], a[32:35], a[76:79], v[48:51]
    ds_read_b128 a[12:15], v17 offset:26624
    ds_read_b64_tr_b16 a[48:49], v11 offset:0
    v_mfma_f32_16x16x32_bf16 v[52:55], a[36:39], a[64:67], v[52:55]
    ds_read_b64_tr_b16 a[50:51], v12 offset:0
    s_add_u32 s60, s60, 8192
    s_add_u32 m0, m0, 1056
    s_nop 0
    buffer_load_dwordx4 v9, s[16:19], s60 offen lds
    v_mfma_f32_16x16x32_bf16 v[56:59], a[36:39], a[68:71], v[56:59]
    ds_read_b64_tr_b16 a[52:53], v11 offset:32
    ds_read_b64_tr_b16 a[54:55], v12 offset:32
    v_mfma_f32_16x16x32_bf16 v[60:63], a[36:39], a[72:75], v[60:63]
    ds_read_b64_tr_b16 a[56:57], v11 offset:64
    v_mfma_f32_16x16x32_bf16 v[64:67], a[36:39], a[76:79], v[64:67]
    ds_read_b64_tr_b16 a[58:59], v12 offset:64
    ds_read_b64_tr_b16 a[60:61], v11 offset:96
    s_add_u32 s60, s62, 32768
    s_add_u32 m0, s65, 84480
    s_nop 0
    buffer_load_dwordx4 v9, s[16:19], s60 offen lds
    v_mfma_f32_16x16x32_bf16 v[68:71], a[40:43], a[64:67], v[68:71]
    ds_read_b64_tr_b16 a[62:63], v12 offset:96
    v_mfma_f32_16x16x32_bf16 v[72:75], a[40:43], a[68:71], v[72:75]
    v_mfma_f32_16x16x32_bf16 v[76:79], a[40:43], a[72:75], v[76:79]
    v_mfma_f32_16x16x32_bf16 v[80:83], a[40:43], a[76:79], v[80:83]
    s_add_u32 s60, s60, 8192
    s_add_u32 m0, m0, 1056
    s_nop 0
    buffer_load_dwordx4 v9, s[16:19], s60 offen lds
    v_mfma_f32_16x16x32_bf16 v[84:87], a[44:47], a[64:67], v[84:87]
    v_mfma_f32_16x16x32_bf16 v[88:91], a[44:47], a[68:71], v[88:91]
    s_waitcnt vmcnt(4)
    s_waitcnt lgkmcnt(0)
    s_barrier
    v_mfma_f32_16x16x32_bf16 v[92:95], a[44:47], a[72:75], v[92:95]
    v_mfma_f32_16x16x32_bf16 v[96:99], a[44:47], a[76:79], v[96:99]
    v_mfma_f32_16x16x32_bf16 v[36:39], a[48:51], a[0:3], v[36:39]
    v_add_u32 v11, 33792, v18
    v_add_u32 v12, 50688, v18
    v_mfma_f32_16x16x32_bf16 v[40:43], a[48:51], a[4:7], v[40:43]
    ds_read_b128 a[64:67], v17 offset:6144
    ds_read_b128 a[68:71], v17 offset:13312
    s_add_u32 s60, s62, 262144
    s_add_u32 m0, s65, 0
    s_nop 0
    buffer_load_dwordx4 v9, s[16:19], s60 offen lds
    v_mfma_f32_16x16x32_bf16 v[44:47], a[48:51], a[8:11], v[44:47]
    ds_read_b128 a[72:75], v17 offset:20480
    v_mfma_f32_16x16x32_bf16 v[48:51], a[48:51], a[12:15], v[48:51]
    ds_read_b128 a[76:79], v17 offset:27648
    ds_read_b64_tr_b16 a[32:33], v11 offset:0
    v_mfma_f32_16x16x32_bf16 v[52:55], a[52:55], a[0:3], v[52:55]
    ds_read_b64_tr_b16 a[34:35], v12 offset:0
    s_add_u32 s60, s60, 8192
    s_add_u32 m0, m0, 1056
    s_nop 0
    buffer_load_dwordx4 v9, s[16:19], s60 offen lds
    v_mfma_f32_16x16x32_bf16 v[56:59], a[52:55], a[4:7], v[56:59]
    ds_read_b64_tr_b16 a[36:37], v11 offset:32
    ds_read_b64_tr_b16 a[38:39], v12 offset:32
    v_mfma_f32_16x16x32_bf16 v[60:63], a[52:55], a[8:11], v[60:63]
    ds_read_b64_tr_b16 a[40:41], v11 offset:64
    v_mfma_f32_16x16x32_bf16 v[64:67], a[52:55], a[12:15], v[64:67]
    ds_read_b64_tr_b16 a[42:43], v12 offset:64
    ds_read_b64_tr_b16 a[44:45], v11 offset:96
    s_add_u32 s60, s62, 294912
    s_add_u32 m0, s65, 16896
    s_nop 0
    buffer_load_dwordx4 v9, s[16:19], s60 offen lds
    v_mfma_f32_16x16x32_bf16 v[68:71], a[56:59], a[0:3], v[68:71]
    ds_read_b64_tr_b16 a[46:47], v12 offset:96
    v_mfma_f32_16x16x32_bf16 v[72:75], a[56:59], a[4:7], v[72:75]
    v_mfma_f32_16x16x32_bf16 v[76:79], a[56:59], a[8:11], v[76:79]
    v_mfma_f32_16x16x32_bf16 v[80:83], a[56:59], a[12:15], v[80:83]
    s_add_u32 s60, s60, 8192
    s_add_u32 m0, m0, 1056
    s_nop 0
    buffer_load_dwordx4 v9, s[16:19], s60 offen lds
    v_mfma_f32_16x16x32_bf16 v[84:87], a[60:63], a[0:3], v[84:87]
    v_mfma_f32_16x16x32_bf16 v[88:91], a[60:63], a[4:7], v[88:91]
    s_waitcnt vmcnt(4)
    s_waitcnt lgkmcnt(0)
    s_barrier
    v_mfma_f32_16x16x32_bf16 v[92:95], a[60:63], a[8:11], v[92:95]
    v_mfma_f32_16x16x32_bf16 v[96:99], a[60:63], a[12:15], v[96:99]
    v_mfma_f32_16x16x32_bf16 v[36:39], a[32:35], a[64:67], v[36:39]
    v_add_u32 v11, 67584, v19
    v_mfma_f32_16x16x32_bf16 v[40:43], a[32:35], a[68:71], v[40:43]
    v_add_u32 v12, 84480, v19
    s_add_u32 s60, s62, 524288
    s_add_u32 m0, s65, 33792
    s_nop 0
    buffer_load_dwordx4 v9, s[16:19], s60 offen lds
    v_mfma_f32_16x16x32_bf16 v[44:47], a[32:35], a[72:75], v[44:47]
    ds_read_b64_tr_b16 a[48:49], v11 offset:0
    v_mfma_f32_16x16x32_bf16 v[48:51], a[32:35], a[76:79], v[48:51]
    ds_read_b64_tr_b16 a[50:51], v12 offset:0
    v_mfma_f32_16x16x32_bf16 v[52:55], a[36:39], a[64:67], v[52:55]
    ds_read_b64_tr_b16 a[52:53], v11 offset:32
    v_mfma_f32_16x16x32_bf16 v[56:59], a[36:39], a[68:71], v[56:59]
    ds_read_b64_tr_b16 a[54:55], v12 offset:32
    s_add_u32 s60, s60, 8192
    s_add_u32 m0, m0, 1056
    s_nop 0
    buffer_load_dwordx4 v9, s[16:19], s60 offen lds
    v_mfma_f32_16x16x32_bf16 v[60:63], a[36:39], a[72:75], v[60:63]
    ds_read_b64_tr_b16 a[56:57], v11 offset:64
    v_mfma_f32_16x16x32_bf16 v[64:67], a[36:39], a[76:79], v[64:67]
    ds_read_b64_tr_b16 a[58:59], v12 offset:64
    v_mfma_f32_16x16x32_bf16 v[68:71], a[40:43], a[64:67], v[68:71]
    ds_read_b64_tr_b16 a[60:61], v11 offset:96
    v_mfma_f32_16x16x32_bf16 v[72:75], a[40:43], a[68:71], v[72:75]
    ds_read_b64_tr_b16 a[62:63], v12 offset:96
    s_add_u32 s60, s62, 557056
    s_add_u32 m0, s65, 50688
    s_nop 0
    buffer_load_dwordx4 v9, s[16:19], s60 offen lds
    v_mfma_f32_16x16x32_bf16 v[76:79], a[40:43], a[72:75], v[76:79]
    v_mfma_f32_16x16x32_bf16 v[80:83], a[40:43], a[76:79], v[80:83]
    v_mfma_f32_16x16x32_bf16 v[84:87], a[44:47], a[64:67], v[84:87]
    s_add_u32 s60, s60, 8192
    s_add_u32 m0, m0, 1056
    s_nop 0
    buffer_load_dwordx4 v9, s[16:19], s60 offen lds
    v_mfma_f32_16x16x32_bf16 v[88:91], a[44:47], a[68:71], v[88:91]
    v_mfma_f32_16x16x32_bf16 v[92:95], a[44:47], a[72:75], v[92:95]
    v_mfma_f32_16x16x32_bf16 v[96:99], a[44:47], a[76:79], v[96:99]
    v_accvgpr_read_b32 v8, a90
    s_nop 0
    ds_write_b128 v8, v[100:103] offset:0
    ds_write_b128 v8, v[104:107] offset:2048
    ds_write_b128 v8, v[108:111] offset:4096
    ds_write_b128 v8, v[112:115] offset:6144
    ds_write_b128 v8, v[116:119] offset:8192
    ds_write_b128 v8, v[120:123] offset:10240
    ds_write_b128 v8, v[124:127] offset:12288
    s_nop 1
    s_nop 7
    v_cvt_pk_bf16_f32 v100, v36, v37
    v_cvt_pk_bf16_f32 v101, v38, v39
    v_cvt_pk_bf16_f32 v102, v40, v41
    v_cvt_pk_bf16_f32 v103, v42, v43
    v_cvt_pk_bf16_f32 v104, v44, v45
    v_cvt_pk_bf16_f32 v105, v46, v47
    v_cvt_pk_bf16_f32 v106, v48, v49
    v_cvt_pk_bf16_f32 v107, v50, v51
    v_cvt_pk_bf16_f32 v108, v52, v53
    v_cvt_pk_bf16_f32 v109, v54, v55
    v_cvt_pk_bf16_f32 v110, v56, v57
    v_cvt_pk_bf16_f32 v111, v58, v59
    v_cvt_pk_bf16_f32 v112, v60, v61
    v_cvt_pk_bf16_f32 v113, v62, v63
    v_cvt_pk_bf16_f32 v114, v64, v65
    v_cvt_pk_bf16_f32 v115, v66, v67
    v_cvt_pk_bf16_f32 v116, v68, v69
    v_cvt_pk_bf16_f32 v117, v70, v71
    v_cvt_pk_bf16_f32 v118, v72, v73
    v_cvt_pk_bf16_f32 v119, v74, v75
    v_cvt_pk_bf16_f32 v120, v76, v77
    v_cvt_pk_bf16_f32 v121, v78, v79
    v_cvt_pk_bf16_f32 v122, v80, v81
    v_cvt_pk_bf16_f32 v123, v82, v83
    v_cvt_pk_bf16_f32 v124, v84, v85
    v_cvt_pk_bf16_f32 v125, v86, v87
    v_cvt_pk_bf16_f32 v126, v88, v89
    v_cvt_pk_bf16_f32 v127, v90, v91
    v_cvt_pk_bf16_f32 v160, v92, v93
    v_cvt_pk_bf16_f32 v161, v94, v95
    v_cvt_pk_bf16_f32 v162, v96, v97
    v_cvt_pk_bf16_f32 v163, v98, v99
    s_branch L_mlpD
L_mlpB:
    s_waitcnt vmcnt(4)
    s_waitcnt lgkmcnt(0)
    s_barrier
    v_add_u32 v11, 0, v14
    v_add_u32 v12, 16896, v14
    ds_read_b64_tr_b16 a[0:1], v11 offset:0
    ds_read_b64_tr_b16 a[2:3], v11 offset:512
    ds_read_b64_tr_b16 a[4:5], v11 offset:32
    ds_read_b64_tr_b16 a[6:7], v11 offset:544
    ds_read_b64_tr_b16 a[8:9], v11 offset:64
    ds_read_b64_tr_b16 a[10:11], v11 offset:576
    ds_read_b64_tr_b16 a[16:17], v12 offset:0
    ds_read_b64_tr_b16 a[18:19], v12 offset:512
    ds_read_b64_tr_b16 a[20:21], v12 offset:32
    ds_read_b64_tr_b16 a[22:23], v12 offset:544
    ds_read_b64_tr_b16 a[24:25], v12 offset:64
    ds_read_b64_tr_b16 a[26:27], v12 offset:576
    ds_read_b128 v[128:131], v15 offset:0
    ds_read_b128 v[132:135], v15 offset:14336
    ds_read_b128 v[136:139], v16 offset:1024
    s_waitcnt lgkmcnt(8)
    ds_read_b128 v[140:143], v16 offset:15360
    s_waitcnt lgkmcnt(0)
    v_mfma_f32_16x16x32_bf16 v[36:39], a[0:3], v[128:131], v[20:23]
    v_add_u32 v11, 33792, v14
    v_add_u32 v12, 50688, v14
    ds_read_b128 v[144:147], v15 offset:2048
    v_mfma_f32_16x16x32_bf16 v[40:43], a[0:3], v[132:135], v[20:23]
    ds_read_b128 v[148:151], v15 offset:16384
    ds_read_b128 v[152:155], v16 offset:3072
    ds_read_b128 v[156:159], v16 offset:17408
    v_mfma_f32_16x16x32_bf16 v[44:47], a[4:7], v[128:131], v[24:27]
    ds_read_b64_tr_b16 a[32:33], v11 offset:0
    ds_read_b64_tr_b16 a[34:35], v11 offset:512
    v_mfma_f32_16x16x32_bf16 v[48:51], a[4:7], v[132:135], v[24:27]
    ds_read_b64_tr_b16 a[36:37], v11 offset:32
    ds_read_b64_tr_b16 a[38:39], v11 offset:544
    ds_read_b64_tr_b16 a[40:41], v11 offset:64
    v_mfma_f32_16x16x32_bf16 v[52:55], a[8:11], v[128:131], v[28:31]
    ds_read_b64_tr_b16 a[42:43], v11 offset:576
    ds_read_b64_tr_b16 a[48:49], v12 offset:0
    v_mfma_f32_16x16x32_bf16 v[56:59], a[8:11], v[132:135], v[28:31]
    ds_read_b64_tr_b16 a[50:51], v12 offset:512
    ds_read_b64_tr_b16 a[52:53], v12 offset:32
    ds_read_b64_tr_b16 a[54:55], v12 offset:544
    v_mfma_f32_16x16x32_bf16 v[36:39], a[16:19], v[136:139], v[36:39]
    ds_read_b64_tr_b16 a[56:57], v12 offset:64
    s_waitcnt lgkmcnt(8)
    ds_read_b64_tr_b16 a[58:59], v12 offset:576
    v_mfma_f32_16x16x32_bf16 v[40:43], a[16:19], v[140:143], v[40:43]
    v_mfma_f32_16x16x32_bf16 v[44:47], a[20:23], v[136:139], v[44:47]
    v_mfma_f32_16x16x32_bf16 v[48:51], a[20:23], v[140:143], v[48:51]
    s_waitcnt vmcnt(0)
    s_waitcnt lgkmcnt(0)
    s_barrier
    v_mfma_f32_16x16x32_bf16 v[52:55], a[24:27], v[136:139], v[52:55]
    v_mfma_f32_16x16x32_bf16 v[56:59], a[24:27], v[140:143], v[56:59]
    v_mfma_f32_16x16x32_bf16 v[36:39], a[32:35], v[144:147], v[36:39]
    v_add_u32 v11, 67584, v14
    v_add_u32 v12, 84480, v14
    ds_read_b128 v[128:131], v15 offset:4096
    s_add_u32 s60, s64, 688128
    s_add_u32 m0, s65, 0
    s_nop 0
    buffer_load_dwordx4 v10, s[8:11], s60 offen lds
    v_mfma_f32_16x16x32_bf16 v[40:43], a[32:35], v[148:151], v[40:43]
    ds_read_b128 v[132:135], v15 offset:18432
    ds_read_b128 v[136:139], v16 offset:5120
    ds_read_b128 v[140:143], v16 offset:19456
    s_add_u32 s60, s60, 3584
    s_add_u32 m0, m0, 1056
    s_nop 0
    buffer_load_dwordx4 v10, s[8:11], s60 offen lds
    v_mfma_f32_16x16x32_bf16 v[44:47], a[36:39], v[144:147], v[44:47]
    ds_read_b64_tr_b16 a[0:1], v11 offset:0
    ds_read_b64_tr_b16 a[2:3], v11 offset:512
    s_add_u32 s60, s64, 802816
    s_add_u32 m0, s65, 16896
    s_nop 0
    buffer_load_dwordx4 v10, s[8:11], s60 offen lds
    v_mfma_f32_16x16x32_bf16 v[48:51], a[36:39], v[148:151], v[48:51]
    ds_read_b64_tr_b16 a[4:5], v11 offset:32
    ds_read_b64_tr_b16 a[6:7], v11 offset:544
    ds_read_b64_tr_b16 a[8:9], v11 offset:64
    s_add_u32 s60, s60, 3584
    s_add_u32 m0, m0, 1056
    s_nop 0
    buffer_load_dwordx4 v10, s[8:11], s60 offen lds
    v_mfma_f32_16x16x32_bf16 v[52:55], a[40:43], v[144:147], v[52:55]
    ds_read_b64_tr_b16 a[10:11], v11 offset:576
    ds_read_b64_tr_b16 a[16:17], v12 offset:0
    s_add_u32 s60, s64, 917504
    s_add_u32 m0, s65, 33792
    s_nop 0
    buffer_load_dwordx4 v10, s[8:11], s60 offen lds
    v_mfma_f32_16x16x32_bf16 v[56:59], a[40:43], v[148:151], v[56:59]
    ds_read_b64_tr_b16 a[18:19], v12 offset:512
    ds_read_b64_tr_b16 a[20:21], v12 offset:32
    ds_read_b64_tr_b16 a[22:23], v12 offset:544
    v_mfma_f32_16x16x32_bf16 v[36:39], a[48:51], v[152:155], v[36:39]
    ds_read_b64_tr_b16 a[24:25], v12 offset:64
    s_waitcnt lgkmcnt(8)
    ds_read_b64_tr_b16 a[26:27], v12 offset:576
    s_add_u32 s60, s60, 3584
    s_add_u32 m0, m0, 1056
    s_nop 0
    buffer_load_dwordx4 v10, s[8:11], s60 offen lds
    v_mfma_f32_16x16x32_bf16 v[40:43], a[48:51], v[156:159], v[40:43]
    s_add_u32 s60, s64, 1032192
    s_add_u32 m0, s65, 50688
    s_nop 0
    buffer_load_dwordx4 v10, s[8:11], s60 offen lds
    v_mfma_f32_16x16x32_bf16 v[44:47], a[52:55], v[152:155], v[44:47]
    s_add_u32 s60, s60, 3584
    s_add_u32 m0, m0, 1056
    s_nop 0
    buffer_load_dwordx4 v10, s[8:11], s60 offen lds
    v_mfma_f32_16x16x32_bf16 v[48:51], a[52:55], v[156:159], v[48:51]
    s_waitcnt vmcnt(4)
    s_waitcnt lgkmcnt(0)
    s_barrier
    v_mfma_f32_16x16x32_bf16 v[52:55], a[56:59], v[152:155], v[52:55]
    v_mfma_f32_16x16x32_bf16 v[56:59], a[56:59], v[156:159], v[56:59]
    v_mfma_f32_16x16x32_bf16 v[36:39], a[0:3], v[128:131], v[36:39]
    v_add_u32 v11, 0, v14
    v_add_u32 v12, 16896, v14
    ds_read_b128 v[144:147], v15 offset:6144
    s_add_u32 s60, s64, 1146880
    s_add_u32 m0, s65, 67584
    s_nop 0
    buffer_load_dwordx4 v10, s[8:11], s60 offen lds
    v_mfma_f32_16x16x32_bf16 v[40:43], a[0:3], v[132:135], v[40:43]
    ds_read_b128 v[148:151], v15 offset:20480
    ds_read_b128 v[152:155], v16 offset:7168
    ds_read_b128 v[156:159], v16 offset:21504
    v_mfma_f32_16x16x32_bf16 v[44:47], a[4:7], v[128:131], v[44:47]
    ds_read_b64_tr_b16 a[32:33], v11 offset:0
    ds_read_b64_tr_b16 a[34:35], v11 offset:512
    v_mfma_f32_16x16x32_bf16 v[48:51], a[4:7], v[132:135], v[48:51]
    ds_read_b64_tr_b16 a[36:37], v11 offset:32
    ds_read_b64_tr_b16 a[38:39], v11 offset:544
    ds_read_b64_tr_b16 a[40:41], v11 offset:64
    s_add_u32 s60, s60, 3584
    s_add_u32 m0, m0, 1056
    s_nop 0
    buffer_load_dwordx4 v10, s[8:11], s60 offen lds
    v_mfma_f32_16x16x32_bf16 v[52:55], a[8:11], v[128:131], v[52:55]
    ds_read_b64_tr_b16 a[42:43], v11 offset:576
    ds_read_b64_tr_b16 a[48:49], v12 offset:0
    v_mfma_f32_16x16x32_bf16 v[56:59], a[8:11], v[132:135], v[56:59]
    ds_read_b64_tr_b16 a[50:51], v12 offset:512
    ds_read_b64_tr_b16 a[52:53], v12 offset:32
    ds_read_b64_tr_b16 a[54:55], v12 offset:544
    s_add_u32 s60, s64, 1261568
    s_add_u32 m0, s65, 84480
    s_nop 0
    buffer_load_dwordx4 v10, s[8:11], s60 offen lds
    v_mfma_f32_16x16x32_bf16 v[36:39], a[16:19], v[136:139], v[36:39]
    ds_read_b64_tr_b16 a[56:57], v12 offset:64
    s_waitcnt lgkmcnt(8)
    ds_read_b64_tr_b16 a[58:59], v12 offset:576
    v_mfma_f32_16x16x32_bf16 v[40:43], a[16:19], v[140:143], v[40:43]
    s_add_u32 s60, s60, 3584
    s_add_u32 m0, m0, 1056
    s_nop 0
    buffer_load_dwordx4 v10, s[8:11], s60 offen lds
    v_mfma_f32_16x16x32_bf16 v[44:47], a[20:23], v[136:139], v[44:47]
    v_mfma_f32_16x16x32_bf16 v[48:51], a[20:23], v[140:143], v[48:51]
    s_waitcnt vmcnt(4)
    s_waitcnt lgkmcnt(0)
    s_barrier
    v_mfma_f32_16x16x32_bf16 v[52:55], a[24:27], v[136:139], v[52:55]
    v_mfma_f32_16x16x32_bf16 v[56:59], a[24:27], v[140:143], v[56:59]
    v_mfma_f32_16x16x32_bf16 v[36:39], a[32:35], v[144:147], v[36:39]
    v_add_u32 v11, 33792, v14
    v_add_u32 v12, 50688, v14
    ds_read_b128 v[128:131], v15 offset:8192
    s_add_u32 s60, s64, 1376256
    s_add_u32 m0, s65, 0
    s_nop 0
    buffer_load_dwordx4 v10, s[8:11], s60 offen lds
    v_mfma_f32_16x16x32_bf16 v[40:43], a[32:35], v[148:151], v[40:43]
    ds_read_b128 v[132:135], v15 offset:22528
    ds_read_b128 v[136:139], v16 offset:9216
    ds_read_b128 v[140:143], v16 offset:23552
    v_mfma_f32_16x16x32_bf16 v[44:47], a[36:39], v[144:147], v[44:47]
    ds_read_b64_tr_b16 a[0:1], v11 offset:0
    ds_read_b64_tr_b16 a[2:3], v11 offset:512
    v_mfma_f32_16x16x32_bf16 v[48:51], a[36:39], v[148:151], v[48:51]
    ds_read_b64_tr_b16 a[4:5], v11 offset:32
    ds_read_b64_tr_b16 a[6:7], v11 offset:544
    ds_read_b64_tr_b16 a[8:9], v11 offset:64
    s_add_u32 s60, s60, 3584
    s_add_u32 m0, m0, 1056
    s_nop 0
    buffer_load_dwordx4 v10, s[8:11], s60 offen lds
    v_mfma_f32_16x16x32_bf16 v[52:55], a[40:43], v[144:147], v[52:55]
    ds_read_b64_tr_b16 a[10:11], v11 offset:576
    ds_read_b64_tr_b16 a[16:17], v12 offset:0
    v_mfma_f32_16x16x32_bf16 v[56:59], a[40:43], v[148:151], v[56:59]
    ds_read_b64_tr_b16 a[18:19], v12 offset:512
    ds_read_b64_tr_b16 a[20:21], v12 offset:32
    ds_read_b64_tr_b16 a[22:23], v12 offset:544
    s_add_u32 s60, s64, 1490944
    s_add_u32 m0, s65, 16896
    s_nop 0
    buffer_load_dwordx4 v10, s[8:11], s60 offen lds
    v_mfma_f32_16x16x32_bf16 v[36:39], a[48:51], v[152:155], v[36:39]
    ds_read_b64_tr_b16 a[24:25], v12 offset:64
    s_waitcnt lgkmcnt(8)
    ds_read_b64_tr_b16 a[26:27], v12 offset:576
    v_mfma_f32_16x16x32_bf16 v[40:43], a[48:51], v[156:159], v[40:43]
    s_add_u32 s60, s60, 3584
    s_add_u32 m0, m0, 1056
    s_nop 0
    buffer_load_dwordx4 v10, s[8:11], s60 offen lds
    v_mfma_f32_16x16x32_bf16 v[44:47], a[52:55], v[152:155], v[44:47]
    v_mfma_f32_16x16x32_bf16 v[48:51], a[52:55], v[156:159], v[48:51]
    s_waitcnt vmcnt(4)
    s_waitcnt lgkmcnt(0)
    s_barrier
    v_mfma_f32_16x16x32_bf16 v[52:55], a[56:59], v[152:155], v[52:55]
    v_mfma_f32_16x16x32_bf16 v[56:59], a[56:59], v[156:159], v[56:59]
    v_mfma_f32_16x16x32_bf16 v[36:39], a[0:3], v[128:131], v[36:39]
    v_add_u32 v11, 67584, v14
    v_add_u32 v12, 84480, v14
    ds_read_b128 v[144:147], v15 offset:10240
    s_add_u32 s60, s63, 0
    s_add_u32 m0, s65, 33792
    s_nop 0
    buffer_load_dwordx4 v0, s[12:15], s60 offen lds
    v_mfma_f32_16x16x32_bf16 v[40:43], a[0:3], v[132:135], v[40:43]
    ds_read_b128 v[148:151], v15 offset:24576
    ds_read_b128 v[152:155], v16 offset:11264
    ds_read_b128 v[156:159], v16 offset:25600
    v_mfma_f32_16x16x32_bf16 v[44:47], a[4:7], v[128:131], v[44:47]
    ds_read_b64_tr_b16 a[32:33], v11 offset:0
    ds_read_b64_tr_b16 a[34:35], v11 offset:512
    v_mfma_f32_16x16x32_bf16 v[48:51], a[4:7], v[132:135], v[48:51]
    ds_read_b64_tr_b16 a[36:37], v11 offset:32
    ds_read_b64_tr_b16 a[38:39], v11 offset:544
    ds_read_b64_tr_b16 a[40:41], v11 offset:64
    s_add_u32 s60, s60, 896
    s_add_u32 m0, m0, 1056
    s_nop 0
    buffer_load_dwordx4 v0, s[12:15], s60 offen lds
    v_mfma_f32_16x16x32_bf16 v[52:55], a[8:11], v[128:131], v[52:55]
    ds_read_b64_tr_b16 a[42:43], v11 offset:576
    ds_read_b64_tr_b16 a[48:49], v12 offset:0
    v_mfma_f32_16x16x32_bf16 v[56:59], a[8:11], v[132:135], v[56:59]
    ds_read_b64_tr_b16 a[50:51], v12 offset:512
    ds_read_b64_tr_b16 a[52:53], v12 offset:32
    ds_read_b64_tr_b16 a[54:55], v12 offset:544
    s_add_u32 s60, s63, 14336
    s_add_u32 m0, s65, 50688
    s_nop 0
    buffer_load_dwordx4 v0, s[12:15], s60 offen lds
    v_mfma_f32_16x16x32_bf16 v[36:39], a[16:19], v[136:139], v[36:39]
    ds_read_b64_tr_b16 a[56:57], v12 offset:64
    s_waitcnt lgkmcnt(8)
    ds_read_b64_tr_b16 a[58:59], v12 offset:576
    v_mfma_f32_16x16x32_bf16 v[40:43], a[16:19], v[140:143], v[40:43]
    s_add_u32 s60, s60, 896
    s_add_u32 m0, m0, 1056
    s_nop 0
    buffer_load_dwordx4 v0, s[12:15], s60 offen lds
    v_mfma_f32_16x16x32_bf16 v[44:47], a[20:23], v[136:139], v[44:47]
    v_mfma_f32_16x16x32_bf16 v[48:51], a[20:23], v[140:143], v[48:51]
    s_waitcnt vmcnt(4)
    s_waitcnt lgkmcnt(0)
    s_barrier
    v_mfma_f32_16x16x32_bf16 v[52:55], a[24:27], v[136:139], v[52:55]
    v_mfma_f32_16x16x32_bf16 v[56:59], a[24:27], v[140:143], v[56:59]
    v_mfma_f32_16x16x32_bf16 v[36:39], a[32:35], v[144:147], v[36:39]
    v_add_u32 v11, 0, v14
    v_add_u32 v12, 16896, v14
    ds_read_b128 v[128:131], v15 offset:12288
    s_add_u32 s60, s63, 28672
    s_add_u32 m0, s65, 67584
    s_nop 0
    buffer_load_dwordx4 v0, s[12:15], s60 offen lds
    v_mfma_f32_16x16x32_bf16 v[40:43], a[32:35], v[148:151], v[40:43]
    ds_read_b128 v[132:135], v15 offset:26624
    ds_read_b128 v[136:139], v16 offset:13312
    ds_read_b128 v[140:143], v16 offset:27648
    v_mfma_f32_16x16x32_bf16 v[44:47], a[36:39], v[144:147], v[44:47]
    ds_read_b64_tr_b16 a[0:1], v11 offset:0
    ds_read_b64_tr_b16 a[2:3], v11 offset:512
    v_mfma_f32_16x16x32_bf16 v[48:51], a[36:39], v[148:151], v[48:51]
    ds_read_b64_tr_b16 a[4:5], v11 offset:32
    ds_read_b64_tr_b16 a[6:7], v11 offset:544
    ds_read_b64_tr_b16 a[8:9], v11 offset:64
    s_add_u32 s60, s60, 896
    s_add_u32 m0, m0, 1056
    s_nop 0
    buffer_load_dwordx4 v0, s[12:15], s60 offen lds
    v_mfma_f32_16x16x32_bf16 v[52:55], a[40:43], v[144:147], v[52:55]
    ds_read_b64_tr_b16 a[10:11], v11 offset:576
    ds_read_b64_tr_b16 a[16:17], v12 offset:0
    v_mfma_f32_16x16x32_bf16 v[56:59], a[40:43], v[148:151], v[56:59]
    ds_read_b64_tr_b16 a[18:19], v12 offset:512
    ds_read_b64_tr_b16 a[20:21], v12 offset:32
    ds_read_b64_tr_b16 a[22:23], v12 offset:544
    s_add_u32 s60, s63, 43008
    s_add_u32 m0, s65, 84480
    s_nop 0
    buffer_load_dwordx4 v0, s[12:15], s60 offen lds
    v_mfma_f32_16x16x32_bf16 v[36:39], a[48:51], v[152:155], v[36:39]
    ds_read_b64_tr_b16 a[24:25], v12 offset:64
    s_waitcnt lgkmcnt(8)
    ds_read_b64_tr_b16 a[26:27], v12 offset:576
    v_mfma_f32_16x16x32_bf16 v[40:43], a[48:51], v[156:159], v[40:43]
    s_add_u32 s60, s60, 896
    s_add_u32 m0, m0, 1056
    s_nop 0
    buffer_load_dwordx4 v0, s[12:15], s60 offen lds
    v_mfma_f32_16x16x32_bf16 v[44:47], a[52:55], v[152:155], v[44:47]
    v_mfma_f32_16x16x32_bf16 v[48:51], a[52:55], v[156:159], v[48:51]
    s_waitcnt vmcnt(4)
    s_waitcnt lgkmcnt(0)
    s_barrier
    v_mfma_f32_16x16x32_bf16 v[52:55], a[56:59], v[152:155], v[52:55]
    v_mfma_f32_16x16x32_bf16 v[56:59], a[56:59], v[156:159], v[56:59]
    v_mfma_f32_16x16x32_bf16 v[36:39], a[0:3], v[128:131], v[36:39]
    v_add_u32 v11, 33792, v18
    v_mfma_f32_16x16x32_bf16 v[40:43], a[0:3], v[132:135], v[40:43]
    v_add_u32 v12, 50688, v18
    s_add_u32 s60, s63, 57344
    s_add_u32 m0, s65, 0
    s_nop 0
    buffer_load_dwordx4 v0, s[12:15], s60 offen lds
    v_mfma_f32_16x16x32_bf16 v[44:47], a[4:7], v[128:131], v[44:47]
    ds_read_b64_tr_b16 a[32:33], v11 offset:0
    v_mfma_f32_16x16x32_bf16 v[48:51], a[4:7], v[132:135], v[48:51]
    ds_read_b64_tr_b16 a[34:35], v12 offset:0
    s_add_u32 s60, s60, 896
    s_add_u32 m0, m0, 1056
    s_nop 0
    buffer_load_dwordx4 v0, s[12:15], s60 offen lds
    v_mfma_f32_16x16x32_bf16 v[52:55], a[8:11], v[128:131], v[52:55]
    ds_read_b64_tr_b16 a[36:37], v11 offset:32
    v_mfma_f32_16x16x32_bf16 v[56:59], a[8:11], v[132:135], v[56:59]
    ds_read_b64_tr_b16 a[38:39], v12 offset:32
    v_mfma_f32_16x16x32_bf16 v[36:39], a[16:19], v[136:139], v[36:39]
    ds_read_b64_tr_b16 a[40:41], v11 offset:64
    s_add_u32 s60, s63, 71680
    s_add_u32 m0, s65, 16896
    s_nop 0
    buffer_load_dwordx4 v0, s[12:15], s60 offen lds
    v_mfma_f32_16x16x32_bf16 v[40:43], a[16:19], v[140:143], v[40:43]
    ds_read_b64_tr_b16 a[42:43], v12 offset:64
    v_mfma_f32_16x16x32_bf16 v[44:47], a[20:23], v[136:139], v[44:47]
    v_mfma_f32_16x16x32_bf16 v[48:51], a[20:23], v[140:143], v[48:51]
    s_add_u32 s60, s60, 896
    s_add_u32 m0, m0, 1056
    s_nop 0
    buffer_load_dwordx4 v0, s[12:15], s60 offen lds
    v_mfma_f32_16x16x32_bf16 v[52:55], a[24:27], v[136:139], v[52:55]
    v_mfma_f32_16x16x32_bf16 v[56:59], a[24:27], v[140:143], v[56:59]
    s_nop 7
    s_add_u32 s54, s67, 0
    s_lshr_b32 s55, s54, 1
    s_lshl_b32 s55, s55, 10
    s_and_b32 s54, s54, 1
    s_lshl_b32 s54, s54, 3
    s_add_u32 s54, s54, s55
    s_add_u32 s54, s54, s68
    v_add_u32 v8, s54, v9
    v_pk_mul_f32 v[68:69], v[36:37], v[36:37]
    v_pk_mul_f32 v[70:71], v[38:39], v[38:39]
    v_pk_mul_f32 v[72:73], v[40:41], v[40:41]
    v_pk_mul_f32 v[74:75], v[42:43], v[42:43]
    v_pk_fma_f32 v[68:69], v[68:69], v[84:85], v[86:87]
    v_pk_fma_f32 v[70:71], v[70:71], v[84:85], v[86:87]
    v_pk_fma_f32 v[72:73], v[72:73], v[84:85], v[86:87]
    v_pk_fma_f32 v[74:75], v[74:75], v[84:85], v[86:87]
    v_pk_mul_f32 v[68:69], v[68:69], v[36:37]
    v_pk_mul_f32 v[70:71], v[70:71], v[38:39]
    v_pk_mul_f32 v[72:73], v[72:73], v[40:41]
    v_pk_mul_f32 v[74:75], v[74:75], v[42:43]
    v_exp_f32 v68, v68
    v_exp_f32 v69, v69
    v_exp_f32 v70, v70
    v_exp_f32 v71, v71
    v_exp_f32 v72, v72
    v_exp_f32 v73, v73
    v_exp_f32 v74, v74
    v_exp_f32 v75, v75
    v_pk_add_f32 v[68:69], v[68:69], v[88:89]
    v_pk_add_f32 v[70:71], v[70:71], v[88:89]
    v_pk_add_f32 v[72:73], v[72:73], v[88:89]
    v_pk_add_f32 v[74:75], v[74:75], v[88:89]
    v_rcp_f32 v68, v68
    v_rcp_f32 v69, v69
    v_rcp_f32 v70, v70
    v_rcp_f32 v71, v71
    v_rcp_f32 v72, v72
    v_rcp_f32 v73, v73
    v_rcp_f32 v74, v74
    v_rcp_f32 v75, v75
    v_pk_mul_f32 v[36:37], v[36:37], v[68:69]
    v_pk_mul_f32 v[38:39], v[38:39], v[70:71]
    v_pk_mul_f32 v[40:41], v[40:41], v[72:73]
    v_pk_mul_f32 v[42:43], v[42:43], v[74:75]
    v_cvt_pk_bf16_f32 v68, v36, v37
    v_cvt_pk_bf16_f32 v69, v38, v39
    ds_write_b64 v8, v[68:69] offset:0
    v_cvt_pk_bf16_f32 v72, v40, v41
    v_cvt_pk_bf16_f32 v73, v42, v43
    ds_write_b64 v8, v[72:73] offset:7168
    s_add_u32 s54, s67, 1
    s_lshr_b32 s55, s54, 1
    s_lshl_b32 s55, s55, 10
    s_and_b32 s54, s54, 1
    s_lshl_b32 s54, s54, 3
    s_add_u32 s54, s54, s55
    s_add_u32 s54, s54, s68
    v_add_u32 v8, s54, v9
    v_pk_mul_f32 v[76:77], v[44:45], v[44:45]
    v_pk_mul_f32 v[78:79], v[46:47], v[46:47]
    v_pk_mul_f32 v[80:81], v[48:49], v[48:49]
    v_pk_mul_f32 v[82:83], v[50:51], v[50:51]
    v_pk_fma_f32 v[76:77], v[76:77], v[84:85], v[86:87]
    v_pk_fma_f32 v[78:79], v[78:79], v[84:85], v[86:87]
    v_pk_fma_f32 v[80:81], v[80:81], v[84:85], v[86:87]
    v_pk_fma_f32 v[82:83], v[82:83], v[84:85], v[86:87]
    v_pk_mul_f32 v[76:77], v[76:77], v[44:45]
    v_pk_mul_f32 v[78:79], v[78:79], v[46:47]
    v_pk_mul_f32 v[80:81], v[80:81], v[48:49]
    v_pk_mul_f32 v[82:83], v[82:83], v[50:51]
    v_exp_f32 v76, v76
    v_exp_f32 v77, v77
    v_exp_f32 v78, v78
    v_exp_f32 v79, v79
    v_exp_f32 v80, v80
    v_exp_f32 v81, v81
    v_exp_f32 v82, v82
    v_exp_f32 v83, v83
    v_pk_add_f32 v[76:77], v[76:77], v[88:89]
    v_pk_add_f32 v[78:79], v[78:79], v[88:89]
    v_pk_add_f32 v[80:81], v[80:81], v[88:89]
    v_pk_add_f32 v[82:83], v[82:83], v[88:89]
    v_rcp_f32 v76, v76
    v_rcp_f32 v77, v77
    v_rcp_f32 v78, v78
    v_rcp_f32 v79, v79
    v_rcp_f32 v80, v80
    v_rcp_f32 v81, v81
    v_rcp_f32 v82, v82
    v_rcp_f32 v83, v83
    v_pk_mul_f32 v[44:45], v[44:45], v[76:77]
    v_pk_mul_f32 v[46:47], v[46:47], v[78:79]
    v_pk_mul_f32 v[48:49], v[48:49], v[80:81]
    v_pk_mul_f32 v[50:51], v[50:51], v[82:83]
    v_cvt_pk_bf16_f32 v76, v44, v45
    v_cvt_pk_bf16_f32 v77, v46, v47
    ds_write_b64 v8, v[76:77] offset:0
    v_cvt_pk_bf16_f32 v80, v48, v49
    v_cvt_pk_bf16_f32 v81, v50, v51
    ds_write_b64 v8, v[80:81] offset:7168
    s_add_u32 s54, s67, 2
    s_lshr_b32 s55, s54, 1
    s_lshl_b32 s55, s55, 10
    s_and_b32 s54, s54, 1
    s_lshl_b32 s54, s54, 3
    s_add_u32 s54, s54, s55
    s_add_u32 s54, s54, s68
    v_add_u32 v8, s54, v9
    v_pk_mul_f32 v[68:69], v[52:53], v[52:53]
    v_pk_mul_f32 v[70:71], v[54:55], v[54:55]
    v_pk_mul_f32 v[72:73], v[56:57], v[56:57]
    v_pk_mul_f32 v[74:75], v[58:59], v[58:59]
    v_pk_fma_f32 v[68:69], v[68:69], v[84:85], v[86:87]
    v_pk_fma_f32 v[70:71], v[70:71], v[84:85], v[86:87]
    v_pk_fma_f32 v[72:73], v[72:73], v[84:85], v[86:87]
    v_pk_fma_f32 v[74:75], v[74:75], v[84:85], v[86:87]
    v_pk_mul_f32 v[68:69], v[68:69], v[52:53]
    v_pk_mul_f32 v[70:71], v[70:71], v[54:55]
    v_pk_mul_f32 v[72:73], v[72:73], v[56:57]
    v_pk_mul_f32 v[74:75], v[74:75], v[58:59]
    v_exp_f32 v68, v68
    v_exp_f32 v69, v69
    v_exp_f32 v70, v70
    v_exp_f32 v71, v71
    v_exp_f32 v72, v72
    v_exp_f32 v73, v73
    v_exp_f32 v74, v74
    v_exp_f32 v75, v75
    v_pk_add_f32 v[68:69], v[68:69], v[88:89]
    v_pk_add_f32 v[70:71], v[70:71], v[88:89]
    v_pk_add_f32 v[72:73], v[72:73], v[88:89]
    v_pk_add_f32 v[74:75], v[74:75], v[88:89]
    v_rcp_f32 v68, v68
    v_rcp_f32 v69, v69
    v_rcp_f32 v70, v70
    v_rcp_f32 v71, v71
    v_rcp_f32 v72, v72
    v_rcp_f32 v73, v73
    v_rcp_f32 v74, v74
    v_rcp_f32 v75, v75
    v_pk_mul_f32 v[52:53], v[52:53], v[68:69]
    v_pk_mul_f32 v[54:55], v[54:55], v[70:71]
    v_pk_mul_f32 v[56:57], v[56:57], v[72:73]
    v_pk_mul_f32 v[58:59], v[58:59], v[74:75]
    v_cvt_pk_bf16_f32 v68, v52, v53
    v_cvt_pk_bf16_f32 v69, v54, v55
    ds_write_b64 v8, v[68:69] offset:0
    v_cvt_pk_bf16_f32 v72, v56, v57
    v_cvt_pk_bf16_f32 v73, v58, v59
    ds_write_b64 v8, v[72:73] offset:7168
    s_waitcnt vmcnt(4)
    s_waitcnt lgkmcnt(0)
    s_barrier
    ds_read_b128 a[64:67], v17 offset:0
    ds_read_b128 a[68:71], v17 offset:7168
    ds_read_b128 a[72:75], v17 offset:14336
    ds_read_b128 a[76:79], v17 offset:21504
    s_waitcnt lgkmcnt(0)
    v_mfma_f32_16x16x32_bf16 v[36:39], a[32:35], a[64:67], 0
    v_add_u32 v11, 67584, v18
    v_add_u32 v12, 84480, v18
    s_add_u32 s60, s63, 86016
    s_add_u32 m0, s65, 33792
    s_nop 0
    buffer_load_dwordx4 v0, s[12:15], s60 offen lds
    v_mfma_f32_16x16x32_bf16 v[40:43], a[32:35], a[68:71], 0
    ds_read_b128 a[0:3], v17 offset:1024
    ds_read_b128 a[4:7], v17 offset:8192
    v_mfma_f32_16x16x32_bf16 v[44:47], a[32:35], a[72:75], 0
    ds_read_b128 a[8:11], v17 offset:15360
    ds_read_b128 a[12:15], v17 offset:22528
    v_mfma_f32_16x16x32_bf16 v[48:51], a[32:35], a[76:79], 0
    ds_read_b64_tr_b16 a[48:49], v11 offset:0
    s_add_u32 s60, s60, 896
    s_add_u32 m0, m0, 1056
    s_nop 0
    buffer_load_dwordx4 v0, s[12:15], s60 offen lds
    v_mfma_f32_16x16x32_bf16 v[52:55], a[36:39], a[64:67], 0
    ds_read_b64_tr_b16 a[50:51], v12 offset:0
    ds_read_b64_tr_b16 a[52:53], v11 offset:32
    v_mfma_f32_16x16x32_bf16 v[56:59], a[36:39], a[68:71], 0
    ds_read_b64_tr_b16 a[54:55], v12 offset:32
    ds_read_b64_tr_b16 a[56:57], v11 offset:64
    s_add_u32 s60, s63, 100352
    s_add_u32 m0, s65, 50688
    s_nop 0
    buffer_load_dwordx4 v0, s[12:15], s60 offen lds
    v_mfma_f32_16x16x32_bf16 v[60:63], a[36:39], a[72:75], 0
    ds_read_b64_tr_b16 a[58:59], v12 offset:64
    v_mfma_f32_16x16x32_bf16 v[64:67], a[36:39], a[76:79], 0
    s_add_u32 s60, s60, 896
    s_add_u32 m0, m0, 1056
    s_nop 0
    buffer_load_dwordx4 v0, s[12:15], s60 offen lds
    v_mfma_f32_16x16x32_bf16 v[68:71], a[40:43], a[64:67], 0
    v_mfma_f32_16x16x32_bf16 v[72:75], a[40:43], a[68:71], 0
    s_waitcnt vmcnt(4)
    s_waitcnt lgkmcnt(0)
    s_barrier
    v_mfma_f32_16x16x32_bf16 v[76:79], a[40:43], a[72:75], 0
    v_mfma_f32_16x16x32_bf16 v[80:83], a[40:43], a[76:79], 0
    v_mfma_f32_16x16x32_bf16 v[36:39], a[48:51], a[0:3], v[36:39]
    v_add_u32 v11, 0, v18
    v_add_u32 v12, 16896, v18
    s_add_u32 s60, s63, 114688
    s_add_u32 m0, s65, 67584
    s_nop 0
    buffer_load_dwordx4 v0, s[12:15], s60 offen lds
    v_mfma_f32_16x16x32_bf16 v[40:43], a[48:51], a[4:7], v[40:43]
    ds_read_b128 a[64:67], v17 offset:2048
    ds_read_b128 a[68:71], v17 offset:9216
    v_mfma_f32_16x16x32_bf16 v[44:47], a[48:51], a[8:11], v[44:47]
    ds_read_b128 a[72:75], v17 offset:16384
    ds_read_b128 a[76:79], v17 offset:23552
    v_mfma_f32_16x16x32_bf16 v[48:51], a[48:51], a[12:15], v[48:51]
    ds_read_b64_tr_b16 a[32:33], v11 offset:0
    s_add_u32 s60, s60, 896
    s_add_u32 m0, m0, 1056
    s_nop 0
    buffer_load_dwordx4 v0, s[12:15], s60 offen lds
    v_mfma_f32_16x16x32_bf16 v[52:55], a[52:55], a[0:3], v[52:55]
    ds_read_b64_tr_b16 a[34:35], v12 offset:0
    ds_read_b64_tr_b16 a[36:37], v11 offset:32
    v_mfma_f32_16x16x32_bf16 v[56:59], a[52:55], a[4:7], v[56:59]
    ds_read_b64_tr_b16 a[38:39], v12 offset:32
    ds_read_b64_tr_b16 a[40:41], v11 offset:64
    s_add_u32 s60, s63, 129024
    s_add_u32 m0, s65, 84480
    s_nop 0
    buffer_load_dwordx4 v0, s[12:15], s60 offen lds
    v_mfma_f32_16x16x32_bf16 v[60:63], a[52:55], a[8:11], v[60:63]
    ds_read_b64_tr_b16 a[42:43], v12 offset:64
    v_mfma_f32_16x16x32_bf16 v[64:67], a[52:55], a[12:15], v[64:67]
    s_add_u32 s60, s60, 896
    s_add_u32 m0, m0, 1056
    s_nop 0
    buffer_load_dwordx4 v0, s[12:15], s60 offen lds
    v_mfma_f32_16x16x32_bf16 v[68:71], a[56:59], a[0:3], v[68:71]
    v_mfma_f32_16x16x32_bf16 v[72:75], a[56:59], a[4:7], v[72:75]
    s_waitcnt vmcnt(4)
    s_waitcnt lgkmcnt(0)
    s_barrier
    v_mfma_f32_16x16x32_bf16 v[76:79], a[56:59], a[8:11], v[76:79]
    v_mfma_f32_16x16x32_bf16 v[80:83], a[56:59], a[12:15], v[80:83]
    v_mfma_f32_16x16x32_bf16 v[36:39], a[32:35], a[64:67], v[36:39]
    v_add_u32 v11, 33792, v18
    v_add_u32 v12, 50688, v18
    s_add_u32 s60, s63, 143360
    s_add_u32 m0, s65, 0
    s_nop 0
    buffer_load_dwordx4 v0, s[12:15], s60 offen lds
    v_mfma_f32_16x16x32_bf16 v[40:43], a[32:35], a[68:71], v[40:43]
    ds_read_b128 a[0:3], v17 offset:3072
    ds_read_b128 a[4:7], v17 offset:10240
    v_mfma_f32_16x16x32_bf16 v[44:47], a[32:35], a[72:75], v[44:47]
    ds_read_b128 a[8:11], v17 offset:17408
    ds_read_b128 a[12:15], v17 offset:24576
    v_mfma_f32_16x16x32_bf16 v[48:51], a[32:35], a[76:79], v[48:51]
    ds_read_b64_tr_b16 a[48:49], v11 offset:0
    s_add_u32 s60, s60, 896
    s_add_u32 m0, m0, 1056
    s_nop 0
    buffer_load_dwordx4 v0, s[12:15], s60 offen lds
    v_mfma_f32_16x16x32_bf16 v[52:55], a[36:39], a[64:67], v[52:55]
    ds_read_b64_tr_b16 a[50:51], v12 offset:0
    ds_read_b64_tr_b16 a[52:53], v11 offset:32
    v_mfma_f32_16x16x32_bf16 v[56:59], a[36:39], a[68:71], v[56:59]
    ds_read_b64_tr_b16 a[54:55], v12 offset:32
    ds_read_b64_tr_b16 a[56:57], v11 offset:64
    s_add_u32 s60, s63, 157696
    s_add_u32 m0, s65, 16896
    s_nop 0
    buffer_load_dwordx4 v0, s[12:15], s60 offen lds
    v_mfma_f32_16x16x32_bf16 v[60:63], a[36:39], a[72:75], v[60:63]
    ds_read_b64_tr_b16 a[58:59], v12 offset:64
    v_mfma_f32_16x16x32_bf16 v[64:67], a[36:39], a[76:79], v[64:67]
    s_add_u32 s60, s60, 896
    s_add_u32 m0, m0, 1056
    s_nop 0
    buffer_load_dwordx4 v0, s[12:15], s60 offen lds
    v_mfma_f32_16x16x32_bf16 v[68:71], a[40:43], a[64:67], v[68:71]
    v_mfma_f32_16x16x32_bf16 v[72:75], a[40:43], a[68:71], v[72:75]
    s_waitcnt vmcnt(4)
    s_waitcnt lgkmcnt(0)
    s_barrier
    v_mfma_f32_16x16x32_bf16 v[76:79], a[40:43], a[72:75], v[76:79]
    v_mfma_f32_16x16x32_bf16 v[80:83], a[40:43], a[76:79], v[80:83]
    v_mfma_f32_16x16x32_bf16 v[36:39], a[48:51], a[0:3], v[36:39]
    v_add_u32 v11, 67584, v18
    v_add_u32 v12, 84480, v18
    s_add_u32 s60, s63, 172032
    s_add_u32 m0, s65, 33792
    s_nop 0
    buffer_load_dwordx4 v0, s[12:15], s60 offen lds
    v_mfma_f32_16x16x32_bf16 v[40:43], a[48:51], a[4:7], v[40:43]
    ds_read_b128 a[64:67], v17 offset:4096
    ds_read_b128 a[68:71], v17 offset:11264
    v_mfma_f32_16x16x32_bf16 v[44:47], a[48:51], a[8:11], v[44:47]
    ds_read_b128 a[72:75], v17 offset:18432
    ds_read_b128 a[76:79], v17 offset:25600
    v_mfma_f32_16x16x32_bf16 v[48:51], a[48:51], a[12:15], v[48:51]
    ds_read_b64_tr_b16 a[32:33], v11 offset:0
    s_add_u32 s60, s60, 896
    s_add_u32 m0, m0, 1056
    s_nop 0
    buffer_load_dwordx4 v0, s[12:15], s60 offen lds
    v_mfma_f32_16x16x32_bf16 v[52:55], a[52:55], a[0:3], v[52:55]
    ds_read_b64_tr_b16 a[34:35], v12 offset:0
    ds_read_b64_tr_b16 a[36:37], v11 offset:32
    v_mfma_f32_16x16x32_bf16 v[56:59], a[52:55], a[4:7], v[56:59]
    ds_read_b64_tr_b16 a[38:39], v12 offset:32
    ds_read_b64_tr_b16 a[40:41], v11 offset:64
    s_add_u32 s60, s63, 186368
    s_add_u32 m0, s65, 50688
    s_nop 0
    buffer_load_dwordx4 v0, s[12:15], s60 offen lds
    v_mfma_f32_16x16x32_bf16 v[60:63], a[52:55], a[8:11], v[60:63]
    ds_read_b64_tr_b16 a[42:43], v12 offset:64
    v_mfma_f32_16x16x32_bf16 v[64:67], a[52:55], a[12:15], v[64:67]
    s_add_u32 s60, s60, 896
    s_add_u32 m0, m0, 1056
    s_nop 0
    buffer_load_dwordx4 v0, s[12:15], s60 offen lds
    v_mfma_f32_16x16x32_bf16 v[68:71], a[56:59], a[0:3], v[68:71]
    v_mfma_f32_16x16x32_bf16 v[72:75], a[56:59], a[4:7], v[72:75]
    s_waitcnt vmcnt(4)
    s_waitcnt lgkmcnt(0)
    s_barrier
    v_mfma_f32_16x16x32_bf16 v[76:79], a[56:59], a[8:11], v[76:79]
    v_mfma_f32_16x16x32_bf16 v[80:83], a[56:59], a[12:15], v[80:83]
    v_mfma_f32_16x16x32_bf16 v[36:39], a[32:35], a[64:67], v[36:39]
    v_add_u32 v11, 0, v18
    v_add_u32 v12, 16896, v18
    s_add_u32 s60, s62, 0
    s_add_u32 m0, s65, 67584
    s_nop 0
    buffer_load_dwordx4 v9, s[16:19], s60 offen lds
    v_mfma_f32_16x16x32_bf16 v[40:43], a[32:35], a[68:71], v[40:43]
    ds_read_b128 a[0:3], v17 offset:5120
    ds_read_b128 a[4:7], v17 offset:12288
    v_mfma_f32_16x16x32_bf16 v[44:47], a[32:35], a[72:75], v[44:47]
    ds_read_b128 a[8:11], v17 offset:19456
    ds_read_b128 a[12:15], v17 offset:26624
    v_mfma_f32_16x16x32_bf16 v[48:51], a[32:35], a[76:79], v[48:51]
    ds_read_b64_tr_b16 a[48:49], v11 offset:0
    s_add_u32 s60, s60, 8192
    s_add_u32 m0, m0, 1056
    s_nop 0
    buffer_load_dwordx4 v9, s[16:19], s60 offen lds
    v_mfma_f32_16x16x32_bf16 v[52:55], a[36:39], a[64:67], v[52:55]
    ds_read_b64_tr_b16 a[50:51], v12 offset:0
    ds_read_b64_tr_b16 a[52:53], v11 offset:32
    v_mfma_f32_16x16x32_bf16 v[56:59], a[36:39], a[68:71], v[56:59]
    ds_read_b64_tr_b16 a[54:55], v12 offset:32
    ds_read_b64_tr_b16 a[56:57], v11 offset:64
    s_add_u32 s60, s62, 32768
    s_add_u32 m0, s65, 84480
    s_nop 0
    buffer_load_dwordx4 v9, s[16:19], s60 offen lds
    v_mfma_f32_16x16x32_bf16 v[60:63], a[36:39], a[72:75], v[60:63]
    ds_read_b64_tr_b16 a[58:59], v12 offset:64
    v_mfma_f32_16x16x32_bf16 v[64:67], a[36:39], a[76:79], v[64:67]
    s_add_u32 s60, s60, 8192
    s_add_u32 m0, m0, 1056
    s_nop 0
    buffer_load_dwordx4 v9, s[16:19], s60 offen lds
    v_mfma_f32_16x16x32_bf16 v[68:71], a[40:43], a[64:67], v[68:71]
    v_mfma_f32_16x16x32_bf16 v[72:75], a[40:43], a[68:71], v[72:75]
    s_waitcnt vmcnt(4)
    s_waitcnt lgkmcnt(0)
    s_barrier
    v_mfma_f32_16x16x32_bf16 v[76:79], a[40:43], a[72:75], v[76:79]
    v_mfma_f32_16x16x32_bf16 v[80:83], a[40:43], a[76:79], v[80:83]
    v_mfma_f32_16x16x32_bf16 v[36:39], a[48:51], a[0:3], v[36:39]
    v_add_u32 v11, 33792, v18
    v_add_u32 v12, 50688, v18
    s_add_u32 s60, s62, 262144
    s_add_u32 m0, s65, 0
    s_nop 0
    buffer_load_dwordx4 v9, s[16:19], s60 offen lds
    v_mfma_f32_16x16x32_bf16 v[40:43], a[48:51], a[4:7], v[40:43]
    ds_read_b128 a[64:67], v17 offset:6144
    ds_read_b128 a[68:71], v17 offset:13312
    v_mfma_f32_16x16x32_bf16 v[44:47], a[48:51], a[8:11], v[44:47]
    ds_read_b128 a[72:75], v17 offset:20480
    ds_read_b128 a[76:79], v17 offset:27648
    v_mfma_f32_16x16x32_bf16 v[48:51], a[48:51], a[12:15], v[48:51]
    ds_read_b64_tr_b16 a[32:33], v11 offset:0
    s_add_u32 s60, s60, 8192
    s_add_u32 m0, m0, 1056
    s_nop 0
    buffer_load_dwordx4 v9, s[16:19], s60 offen lds
    v_mfma_f32_16x16x32_bf16 v[52:55], a[52:55], a[0:3], v[52:55]
    ds_read_b64_tr_b16 a[34:35], v12 offset:0
    ds_read_b64_tr_b16 a[36:37], v11 offset:32
    v_mfma_f32_16x16x32_bf16 v[56:59], a[52:55], a[4:7], v[56:59]
    ds_read_b64_tr_b16 a[38:39], v12 offset:32
    ds_read_b64_tr_b16 a[40:41], v11 offset:64
    s_add_u32 s60, s62, 294912
    s_add_u32 m0, s65, 16896
    s_nop 0
    buffer_load_dwordx4 v9, s[16:19], s60 offen lds
    v_mfma_f32_16x16x32_bf16 v[60:63], a[52:55], a[8:11], v[60:63]
    ds_read_b64_tr_b16 a[42:43], v12 offset:64
    v_mfma_f32_16x16x32_bf16 v[64:67], a[52:55], a[12:15], v[64:67]
    s_add_u32 s60, s60, 8192
    s_add_u32 m0, m0, 1056
    s_nop 0
    buffer_load_dwordx4 v9, s[16:19], s60 offen lds
    v_mfma_f32_16x16x32_bf16 v[68:71], a[56:59], a[0:3], v[68:71]
    v_mfma_f32_16x16x32_bf16 v[72:75], a[56:59], a[4:7], v[72:75]
    s_waitcnt vmcnt(4)
    s_waitcnt lgkmcnt(0)
    s_barrier
    v_mfma_f32_16x16x32_bf16 v[76:79], a[56:59], a[8:11], v[76:79]
    v_mfma_f32_16x16x32_bf16 v[80:83], a[56:59], a[12:15], v[80:83]
    v_mfma_f32_16x16x32_bf16 v[36:39], a[32:35], a[64:67], v[36:39]
    v_add_u32 v11, 67584, v19
    v_add_u32 v12, 84480, v19
    v_mfma_f32_16x16x32_bf16 v[40:43], a[32:35], a[68:71], v[40:43]
    ds_read_b64_tr_b16 a[48:49], v11 offset:0
    s_add_u32 s60, s62, 524288
    s_add_u32 m0, s65, 33792
    s_nop 0
    buffer_load_dwordx4 v9, s[16:19], s60 offen lds
    v_mfma_f32_16x16x32_bf16 v[44:47], a[32:35], a[72:75], v[44:47]
    ds_read_b64_tr_b16 a[50:51], v12 offset:0
    v_mfma_f32_16x16x32_bf16 v[48:51], a[32:35], a[76:79], v[48:51]
    ds_read_b64_tr_b16 a[52:53], v11 offset:32
    s_add_u32 s60, s60, 8192
    s_add_u32 m0, m0, 1056
    s_nop 0
    buffer_load_dwordx4 v9, s[16:19], s60 offen lds
    v_mfma_f32_16x16x32_bf16 v[52:55], a[36:39], a[64:67], v[52:55]
    ds_read_b64_tr_b16 a[54:55], v12 offset:32
    ds_read_b64_tr_b16 a[56:57], v11 offset:64
    v_mfma_f32_16x16x32_bf16 v[56:59], a[36:39], a[68:71], v[56:59]
    ds_read_b64_tr_b16 a[58:59], v12 offset:64
    v_mfma_f32_16x16x32_bf16 v[60:63], a[36:39], a[72:75], v[60:63]
    ds_read_b64_tr_b16 a[60:61], v11 offset:96
    s_add_u32 s60, s62, 557056
    s_add_u32 m0, s65, 50688
    s_nop 0
    buffer_load_dwordx4 v9, s[16:19], s60 offen lds
    v_mfma_f32_16x16x32_bf16 v[64:67], a[36:39], a[76:79], v[64:67]
    ds_read_b64_tr_b16 a[62:63], v12 offset:96
    v_mfma_f32_16x16x32_bf16 v[68:71], a[40:43], a[64:67], v[68:71]
    v_mfma_f32_16x16x32_bf16 v[72:75], a[40:43], a[68:71], v[72:75]
    s_add_u32 s60, s60, 8192
    s_add_u32 m0, m0, 1056
    s_nop 0
    buffer_load_dwordx4 v9, s[16:19], s60 offen lds
    v_mfma_f32_16x16x32_bf16 v[76:79], a[40:43], a[72:75], v[76:79]
    v_mfma_f32_16x16x32_bf16 v[80:83], a[40:43], a[76:79], v[80:83]
    v_accvgpr_read_b32 v8, a90
    s_nop 0
    ds_write_b128 v8, v[100:103] offset:0
    ds_write_b128 v8, v[104:107] offset:2048
    ds_write_b128 v8, v[108:111] offset:4096
    ds_write_b128 v8, v[112:115] offset:6144
    ds_write_b128 v8, v[116:119] offset:8192
    ds_write_b128 v8, v[120:123] offset:10240
    ds_write_b128 v8, v[124:127] offset:12288
    s_nop 1
    s_nop 7
    v_cvt_pk_bf16_f32 v100, v36, v37
    v_cvt_pk_bf16_f32 v101, v38, v39
    v_cvt_pk_bf16_f32 v102, v40, v41
    v_cvt_pk_bf16_f32 v103, v42, v43
    v_cvt_pk_bf16_f32 v104, v44, v45
    v_cvt_pk_bf16_f32 v105, v46, v47
    v_cvt_pk_bf16_f32 v106, v48, v49
    v_cvt_pk_bf16_f32 v107, v50, v51
    v_cvt_pk_bf16_f32 v108, v52, v53
    v_cvt_pk_bf16_f32 v109, v54, v55
    v_cvt_pk_bf16_f32 v110, v56, v57
    v_cvt_pk_bf16_f32 v111, v58, v59
    v_cvt_pk_bf16_f32 v112, v60, v61
    v_cvt_pk_bf16_f32 v113, v62, v63
    v_cvt_pk_bf16_f32 v114, v64, v65
    v_cvt_pk_bf16_f32 v115, v66, v67
    v_cvt_pk_bf16_f32 v116, v68, v69
    v_cvt_pk_bf16_f32 v117, v70, v71
    v_cvt_pk_bf16_f32 v118, v72, v73
    v_cvt_pk_bf16_f32 v119, v74, v75
    v_cvt_pk_bf16_f32 v120, v76, v77
    v_cvt_pk_bf16_f32 v121, v78, v79
    v_cvt_pk_bf16_f32 v122, v80, v81
    v_cvt_pk_bf16_f32 v123, v82, v83
L_mlpD:
    v_xor_b32 v5, v2, v3
    v_lshlrev_b32 v6, 8, v3
    v_xor_b32 v7, 12, v5
    v_lshl_add_u32 v15, v5, 4, v6
    v_lshl_add_u32 v16, v7, 4, v6
    v_add_u32 v15, 101376, v15
    v_add_u32 v16, 101376, v16
    s_waitcnt vmcnt(4)
    s_waitcnt lgkmcnt(0)
    s_barrier
    ds_read_b128 v[128:131], v15 offset:0
    ds_read_b128 v[132:135], v15 offset:14336
    ds_read_b128 v[136:139], v15 offset:28672
    ds_read_b128 v[140:143], v15 offset:43008
    s_waitcnt lgkmcnt(0)
    v_mfma_f32_16x16x32_bf16 v[36:39], a[48:51], v[128:131], 0
    v_add_u32 v11, 0, v19
    v_add_u32 v12, 16896, v19
    v_mfma_f32_16x16x32_bf16 v[40:43], a[48:51], v[132:135], 0
    ds_read_b128 v[144:147], v16 offset:1024
    ds_read_b128 v[148:151], v16 offset:15360
    s_add_u32 s60, s62, 786432
    s_add_u32 m0, s65, 67584
    s_nop 0
    buffer_load_dwordx4 v9, s[16:19], s60 offen lds
    v_mfma_f32_16x16x32_bf16 v[44:47], a[48:51], v[136:139], 0
    ds_read_b128 v[152:155], v16 offset:29696
    v_mfma_f32_16x16x32_bf16 v[48:51], a[48:51], v[140:143], 0
    ds_read_b128 v[156:159], v16 offset:44032
    ds_read_b64_tr_b16 a[32:33], v11 offset:0
    v_mfma_f32_16x16x32_bf16 v[52:55], a[52:55], v[128:131], 0
    ds_read_b64_tr_b16 a[34:35], v12 offset:0
    s_add_u32 s60, s60, 8192
    s_add_u32 m0, m0, 1056
    s_nop 0
    buffer_load_dwordx4 v9, s[16:19], s60 offen lds
    v_mfma_f32_16x16x32_bf16 v[56:59], a[52:55], v[132:135], 0
    ds_read_b64_tr_b16 a[36:37], v11 offset:32
    ds_read_b64_tr_b16 a[38:39], v12 offset:32
    v_mfma_f32_16x16x32_bf16 v[60:63], a[52:55], v[136:139], 0
    ds_read_b64_tr_b16 a[40:41], v11 offset:64
    v_mfma_f32_16x16x32_bf16 v[64:67], a[52:55], v[140:143], 0
    ds_read_b64_tr_b16 a[42:43], v12 offset:64
    ds_read_b64_tr_b16 a[44:45], v11 offset:96
    s_add_u32 s60, s62, 819200
    s_add_u32 m0, s65, 84480
    s_nop 0
    buffer_load_dwordx4 v9, s[16:19], s60 offen lds
    v_mfma_f32_16x16x32_bf16 v[68:71], a[56:59], v[128:131], 0
    ds_read_b64_tr_b16 a[46:47], v12 offset:96
    v_mfma_f32_16x16x32_bf16 v[72:75], a[56:59], v[132:135], 0
    v_mfma_f32_16x16x32_bf16 v[76:79], a[56:59], v[136:139], 0
    v_mfma_f32_16x16x32_bf16 v[80:83], a[56:59], v[140:143], 0
    s_add_u32 s60, s60, 8192
    s_add_u32 m0, m0, 1056
    s_nop 0
    buffer_load_dwordx4 v9, s[16:19], s60 offen lds
    v_mfma_f32_16x16x32_bf16 v[84:87], a[60:63], v[128:131], 0
    v_mfma_f32_16x16x32_bf16 v[88:91], a[60:63], v[132:135], 0
    s_waitcnt vmcnt(4)
    s_waitcnt lgkmcnt(0)
    s_barrier
    v_mfma_f32_16x16x32_bf16 v[92:95], a[60:63], v[136:139], 0
    v_mfma_f32_16x16x32_bf16 v[96:99], a[60:63], v[140:143], 0
    v_mfma_f32_16x16x32_bf16 v[36:39], a[32:35], v[144:147], v[36:39]
    v_add_u32 v11, 33792, v19
    v_add_u32 v12, 50688, v19
    v_mfma_f32_16x16x32_bf16 v[40:43], a[32:35], v[148:151], v[40:43]
    ds_read_b128 v[128:131], v15 offset:2048
    ds_read_b128 v[132:135], v15 offset:16384
    s_add_u32 s60, s62, 1048576
    s_add_u32 m0, s65, 0
    s_nop 0
    buffer_load_dwordx4 v9, s[16:19], s60 offen lds
    v_mfma_f32_16x16x32_bf16 v[44:47], a[32:35], v[152:155], v[44:47]
    ds_read_b128 v[136:139], v15 offset:30720
    v_mfma_f32_16x16x32_bf16 v[48:51], a[32:35], v[156:159], v[48:51]
    ds_read_b128 v[140:143], v15 offset:45056
    ds_read_b64_tr_b16 a[48:49], v11 offset:0
    v_mfma_f32_16x16x32_bf16 v[52:55], a[36:39], v[144:147], v[52:55]
    ds_read_b64_tr_b16 a[50:51], v12 offset:0
    s_add_u32 s60, s60, 8192
    s_add_u32 m0, m0, 1056
    s_nop 0
    buffer_load_dwordx4 v9, s[16:19], s60 offen lds
    v_mfma_f32_16x16x32_bf16 v[56:59], a[36:39], v[148:151], v[56:59]
    ds_read_b64_tr_b16 a[52:53], v11 offset:32
    ds_read_b64_tr_b16 a[54:55], v12 offset:32
    v_mfma_f32_16x16x32_bf16 v[60:63], a[36:39], v[152:155], v[60:63]
    ds_read_b64_tr_b16 a[56:57], v11 offset:64
    v_mfma_f32_16x16x32_bf16 v[64:67], a[36:39], v[156:159], v[64:67]
    ds_read_b64_tr_b16 a[58:59], v12 offset:64
    ds_read_b64_tr_b16 a[60:61], v11 offset:96
    s_add_u32 s60, s62, 1081344
    s_add_u32 m0, s65, 16896
    s_nop 0
    buffer_load_dwordx4 v9, s[16:19], s60 offen lds
    v_mfma_f32_16x16x32_bf16 v[68:71], a[40:43], v[144:147], v[68:71]
    ds_read_b64_tr_b16 a[62:63], v12 offset:96
    v_mfma_f32_16x16x32_bf16 v[72:75], a[40:43], v[148:151], v[72:75]
    v_mfma_f32_16x16x32_bf16 v[76:79], a[40:43], v[152:155], v[76:79]
    v_mfma_f32_16x16x32_bf16 v[80:83], a[40:43], v[156:159], v[80:83]
    s_add_u32 s60, s60, 8192
    s_add_u32 m0, m0, 1056
    s_nop 0
    buffer_load_dwordx4 v9, s[16:19], s60 offen lds
    v_mfma_f32_16x16x32_bf16 v[84:87], a[44:47], v[144:147], v[84:87]
    v_mfma_f32_16x16x32_bf16 v[88:91], a[44:47], v[148:151], v[88:91]
    s_waitcnt vmcnt(4)
    s_waitcnt lgkmcnt(0)
    s_barrier
    v_mfma_f32_16x16x32_bf16 v[92:95], a[44:47], v[152:155], v[92:95]
    v_mfma_f32_16x16x32_bf16 v[96:99], a[44:47], v[156:159], v[96:99]
    v_mfma_f32_16x16x32_bf16 v[36:39], a[48:51], v[128:131], v[36:39]
    v_add_u32 v11, 67584, v19
    v_add_u32 v12, 84480, v19
    v_mfma_f32_16x16x32_bf16 v[40:43], a[48:51], v[132:135], v[40:43]
    ds_read_b128 v[144:147], v16 offset:3072
    ds_read_b128 v[148:151], v16 offset:17408
    s_add_u32 s60, s62, 1310720
    s_add_u32 m0, s65, 33792
    s_nop 0
    buffer_load_dwordx4 v9, s[16:19], s60 offen lds
    v_mfma_f32_16x16x32_bf16 v[44:47], a[48:51], v[136:139], v[44:47]
    ds_read_b128 v[152:155], v16 offset:31744
    v_mfma_f32_16x16x32_bf16 v[48:51], a[48:51], v[140:143], v[48:51]
    ds_read_b128 v[156:159], v16 offset:46080
    ds_read_b64_tr_b16 a[32:33], v11 offset:0
    v_mfma_f32_16x16x32_bf16 v[52:55], a[52:55], v[128:131], v[52:55]
    ds_read_b64_tr_b16 a[34:35], v12 offset:0
    s_add_u32 s60, s60, 8192
    s_add_u32 m0, m0, 1056
    s_nop 0
    buffer_load_dwordx4 v9, s[16:19], s60 offen lds
    v_mfma_f32_16x16x32_bf16 v[56:59], a[52:55], v[132:135], v[56:59]
    ds_read_b64_tr_b16 a[36:37], v11 offset:32
    ds_read_b64_tr_b16 a[38:39], v12 offset:32
    v_mfma_f32_16x16x32_bf16 v[60:63], a[52:55], v[136:139], v[60:63]
    ds_read_b64_tr_b16 a[40:41], v11 offset:64
    v_mfma_f32_16x16x32_bf16 v[64:67], a[52:55], v[140:143], v[64:67]
    ds_read_b64_tr_b16 a[42:43], v12 offset:64
    ds_read_b64_tr_b16 a[44:45], v11 offset:96
    s_add_u32 s60, s62, 1343488
    s_add_u32 m0, s65, 50688
    s_nop 0
    buffer_load_dwordx4 v9, s[16:19], s60 offen lds
    v_mfma_f32_16x16x32_bf16 v[68:71], a[56:59], v[128:131], v[68:71]
    ds_read_b64_tr_b16 a[46:47], v12 offset:96
    v_mfma_f32_16x16x32_bf16 v[72:75], a[56:59], v[132:135], v[72:75]
    v_mfma_f32_16x16x32_bf16 v[76:79], a[56:59], v[136:139], v[76:79]
    v_mfma_f32_16x16x32_bf16 v[80:83], a[56:59], v[140:143], v[80:83]
    s_add_u32 s60, s60, 8192
    s_add_u32 m0, m0, 1056
    s_nop 0
    buffer_load_dwordx4 v9, s[16:19], s60 offen lds
    v_mfma_f32_16x16x32_bf16 v[84:87], a[60:63], v[128:131], v[84:87]
    v_mfma_f32_16x16x32_bf16 v[88:91], a[60:63], v[132:135], v[88:91]
    s_waitcnt vmcnt(4)
    s_waitcnt lgkmcnt(0)
    s_barrier
    v_mfma_f32_16x16x32_bf16 v[92:95], a[60:63], v[136:139], v[92:95]
    v_mfma_f32_16x16x32_bf16 v[96:99], a[60:63], v[140:143], v[96:99]
    v_mfma_f32_16x16x32_bf16 v[36:39], a[32:35], v[144:147], v[36:39]
    v_add_u32 v11, 0, v19
    v_add_u32 v12, 16896, v19
    v_mfma_f32_16x16x32_bf16 v[40:43], a[32:35], v[148:151], v[40:43]
    ds_read_b128 v[128:131], v15 offset:4096
    ds_read_b128 v[132:135], v15 offset:18432
    s_add_u32 s60, s62, 1572864
    s_add_u32 m0, s65, 67584
    s_nop 0
    buffer_load_dwordx4 v9, s[16:19], s60 offen lds
    v_mfma_f32_16x16x32_bf16 v[44:47], a[32:35], v[152:155], v[44:47]
    ds_read_b128 v[136:139], v15 offset:32768
    v_mfma_f32_16x16x32_bf16 v[48:51], a[32:35], v[156:159], v[48:51]
    ds_read_b128 v[140:143], v15 offset:47104
    ds_read_b64_tr_b16 a[48:49], v11 offset:0
    v_mfma_f32_16x16x32_bf16 v[52:55], a[36:39], v[144:147], v[52:55]
    ds_read_b64_tr_b16 a[50:51], v12 offset:0
    s_add_u32 s60, s60, 8192
    s_add_u32 m0, m0, 1056
    s_nop 0
    buffer_load_dwordx4 v9, s[16:19], s60 offen lds
    v_mfma_f32_16x16x32_bf16 v[56:59], a[36:39], v[148:151], v[56:59]
    ds_read_b64_tr_b16 a[52:53], v11 offset:32
    ds_read_b64_tr_b16 a[54:55], v12 offset:32
    v_mfma_f32_16x16x32_bf16 v[60:63], a[36:39], v[152:155], v[60:63]
    ds_read_b64_tr_b16 a[56:57], v11 offset:64
    v_mfma_f32_16x16x32_bf16 v[64:67], a[36:39], v[156:159], v[64:67]
    ds_read_b64_tr_b16 a[58:59], v12 offset:64
    ds_read_b64_tr_b16 a[60:61], v11 offset:96
    s_add_u32 s60, s62, 1605632
    s_add_u32 m0, s65, 84480
    s_nop 0
    buffer_load_dwordx4 v9, s[16:19], s60 offen lds
    v_mfma_f32_16x16x32_bf16 v[68:71], a[40:43], v[144:147], v[68:71]
    ds_read_b64_tr_b16 a[62:63], v12 offset:96
    v_mfma_f32_16x16x32_bf16 v[72:75], a[40:43], v[148:151], v[72:75]
    v_mfma_f32_16x16x32_bf16 v[76:79], a[40:43], v[152:155], v[76:79]
    v_mfma_f32_16x16x32_bf16 v[80:83], a[40:43], v[156:159], v[80:83]
    s_add_u32 s60, s60, 8192
    s_add_u32 m0, m0, 1056
    s_nop 0
    buffer_load_dwordx4 v9, s[16:19], s60 offen lds
    v_mfma_f32_16x16x32_bf16 v[84:87], a[44:47], v[144:147], v[84:87]
    v_mfma_f32_16x16x32_bf16 v[88:91], a[44:47], v[148:151], v[88:91]
    s_waitcnt vmcnt(4)
    s_waitcnt lgkmcnt(0)
    s_barrier
    v_mfma_f32_16x16x32_bf16 v[92:95], a[44:47], v[152:155], v[92:95]
    v_mfma_f32_16x16x32_bf16 v[96:99], a[44:47], v[156:159], v[96:99]
    v_mfma_f32_16x16x32_bf16 v[36:39], a[48:51], v[128:131], v[36:39]
    v_add_u32 v11, 33792, v19
    v_add_u32 v12, 50688, v19
    v_mfma_f32_16x16x32_bf16 v[40:43], a[48:51], v[132:135], v[40:43]
    ds_read_b128 v[144:147], v16 offset:5120
    ds_read_b128 v[148:151], v16 offset:19456
    s_add_u32 s60, s62, 1835008
    s_add_u32 m0, s65, 0
    s_nop 0
    buffer_load_dwordx4 v9, s[16:19], s60 offen lds
    v_mfma_f32_16x16x32_bf16 v[44:47], a[48:51], v[136:139], v[44:47]
    ds_read_b128 v[152:155], v16 offset:33792
    v_mfma_f32_16x16x32_bf16 v[48:51], a[48:51], v[140:143], v[48:51]
    ds_read_b128 v[156:159], v16 offset:48128
    ds_read_b64_tr_b16 a[32:33], v11 offset:0
    v_mfma_f32_16x16x32_bf16 v[52:55], a[52:55], v[128:131], v[52:55]
    ds_read_b64_tr_b16 a[34:35], v12 offset:0
    s_add_u32 s60, s60, 8192
    s_add_u32 m0, m0, 1056
    s_nop 0
    buffer_load_dwordx4 v9, s[16:19], s60 offen lds
    v_mfma_f32_16x16x32_bf16 v[56:59], a[52:55], v[132:135], v[56:59]
    ds_read_b64_tr_b16 a[36:37], v11 offset:32
    ds_read_b64_tr_b16 a[38:39], v12 offset:32
    v_mfma_f32_16x16x32_bf16 v[60:63], a[52:55], v[136:139], v[60:63]
    ds_read_b64_tr_b16 a[40:41], v11 offset:64
    v_mfma_f32_16x16x32_bf16 v[64:67], a[52:55], v[140:143], v[64:67]
    ds_read_b64_tr_b16 a[42:43], v12 offset:64
    ds_read_b64_tr_b16 a[44:45], v11 offset:96
    s_add_u32 s60, s62, 1867776
    s_add_u32 m0, s65, 16896
    s_nop 0
    buffer_load_dwordx4 v9, s[16:19], s60 offen lds
    v_mfma_f32_16x16x32_bf16 v[68:71], a[56:59], v[128:131], v[68:71]
    ds_read_b64_tr_b16 a[46:47], v12 offset:96
    v_mfma_f32_16x16x32_bf16 v[72:75], a[56:59], v[132:135], v[72:75]
    v_mfma_f32_16x16x32_bf16 v[76:79], a[56:59], v[136:139], v[76:79]
    v_mfma_f32_16x16x32_bf16 v[80:83], a[56:59], v[140:143], v[80:83]
    s_add_u32 s60, s60, 8192
    s_add_u32 m0, m0, 1056
    s_nop 0
    buffer_load_dwordx4 v9, s[16:19], s60 offen lds
    v_mfma_f32_16x16x32_bf16 v[84:87], a[60:63], v[128:131], v[84:87]
    v_mfma_f32_16x16x32_bf16 v[88:91], a[60:63], v[132:135], v[88:91]
    s_waitcnt vmcnt(4)
    s_waitcnt lgkmcnt(0)
    s_barrier
    v_mfma_f32_16x16x32_bf16 v[92:95], a[60:63], v[136:139], v[92:95]
    v_mfma_f32_16x16x32_bf16 v[96:99], a[60:63], v[140:143], v[96:99]
    v_mfma_f32_16x16x32_bf16 v[36:39], a[32:35], v[144:147], v[36:39]
    v_add_u32 v11, 67584, v19
    v_add_u32 v12, 84480, v19
    v_mfma_f32_16x16x32_bf16 v[40:43], a[32:35], v[148:151], v[40:43]
    ds_read_b128 v[128:131], v15 offset:6144
    ds_read_b128 v[132:135], v15 offset:20480
    s_add_u32 s60, s62, 2097152
    s_add_u32 m0, s65, 33792
    s_nop 0
    buffer_load_dwordx4 v9, s[16:19], s60 offen lds
    v_mfma_f32_16x16x32_bf16 v[44:47], a[32:35], v[152:155], v[44:47]
    ds_read_b128 v[136:139], v15 offset:34816
    v_mfma_f32_16x16x32_bf16 v[48:51], a[32:35], v[156:159], v[48:51]
    ds_read_b128 v[140:143], v15 offset:49152
    ds_read_b64_tr_b16 a[48:49], v11 offset:0
    v_mfma_f32_16x16x32_bf16 v[52:55], a[36:39], v[144:147], v[52:55]
    ds_read_b64_tr_b16 a[50:51], v12 offset:0
    s_add_u32 s60, s60, 8192
    s_add_u32 m0, m0, 1056
    s_nop 0
    buffer_load_dwordx4 v9, s[16:19], s60 offen lds
    v_mfma_f32_16x16x32_bf16 v[56:59], a[36:39], v[148:151], v[56:59]
    ds_read_b64_tr_b16 a[52:53], v11 offset:32
    ds_read_b64_tr_b16 a[54:55], v12 offset:32
    v_mfma_f32_16x16x32_bf16 v[60:63], a[36:39], v[152:155], v[60:63]
    ds_read_b64_tr_b16 a[56:57], v11 offset:64
    v_mfma_f32_16x16x32_bf16 v[64:67], a[36:39], v[156:159], v[64:67]
    ds_read_b64_tr_b16 a[58:59], v12 offset:64
    ds_read_b64_tr_b16 a[60:61], v11 offset:96
    s_add_u32 s60, s62, 2129920
    s_add_u32 m0, s65, 50688
    s_nop 0
    buffer_load_dwordx4 v9, s[16:19], s60 offen lds
    v_mfma_f32_16x16x32_bf16 v[68:71], a[40:43], v[144:147], v[68:71]
    ds_read_b64_tr_b16 a[62:63], v12 offset:96
    v_mfma_f32_16x16x32_bf16 v[72:75], a[40:43], v[148:151], v[72:75]
    v_mfma_f32_16x16x32_bf16 v[76:79], a[40:43], v[152:155], v[76:79]
    v_mfma_f32_16x16x32_bf16 v[80:83], a[40:43], v[156:159], v[80:83]
    s_add_u32 s60, s60, 8192
    s_add_u32 m0, m0, 1056
    s_nop 0
    buffer_load_dwordx4 v9, s[16:19], s60 offen lds
    v_mfma_f32_16x16x32_bf16 v[84:87], a[44:47], v[144:147], v[84:87]
    v_mfma_f32_16x16x32_bf16 v[88:91], a[44:47], v[148:151], v[88:91]
    s_waitcnt vmcnt(4)
    s_waitcnt lgkmcnt(0)
    s_barrier
    v_mfma_f32_16x16x32_bf16 v[92:95], a[44:47], v[152:155], v[92:95]
    v_mfma_f32_16x16x32_bf16 v[96:99], a[44:47], v[156:159], v[96:99]
    v_mfma_f32_16x16x32_bf16 v[36:39], a[48:51], v[128:131], v[36:39]
    v_add_u32 v11, 0, v19
    v_add_u32 v12, 16896, v19
    v_mfma_f32_16x16x32_bf16 v[40:43], a[48:51], v[132:135], v[40:43]
    ds_read_b128 v[144:147], v16 offset:7168
    ds_read_b128 v[148:151], v16 offset:21504
    s_add_u32 s60, s62, 2359296
    s_add_u32 m0, s65, 67584
    s_nop 0
    buffer_load_dwordx4 v9, s[16:19], s60 offen lds
    v_mfma_f32_16x16x32_bf16 v[44:47], a[48:51], v[136:139], v[44:47]
    ds_read_b128 v[152:155], v16 offset:35840
    v_mfma_f32_16x16x32_bf16 v[48:51], a[48:51], v[140:143], v[48:51]
    ds_read_b128 v[156:159], v16 offset:50176
    ds_read_b64_tr_b16 a[32:33], v11 offset:0
    v_mfma_f32_16x16x32_bf16 v[52:55], a[52:55], v[128:131], v[52:55]
    ds_read_b64_tr_b16 a[34:35], v12 offset:0
    s_add_u32 s60, s60, 8192
    s_add_u32 m0, m0, 1056
    s_nop 0
    buffer_load_dwordx4 v9, s[16:19], s60 offen lds
    v_mfma_f32_16x16x32_bf16 v[56:59], a[52:55], v[132:135], v[56:59]
    ds_read_b64_tr_b16 a[36:37], v11 offset:32
    ds_read_b64_tr_b16 a[38:39], v12 offset:32
    v_mfma_f32_16x16x32_bf16 v[60:63], a[52:55], v[136:139], v[60:63]
    ds_read_b64_tr_b16 a[40:41], v11 offset:64
    v_mfma_f32_16x16x32_bf16 v[64:67], a[52:55], v[140:143], v[64:67]
    ds_read_b64_tr_b16 a[42:43], v12 offset:64
    ds_read_b64_tr_b16 a[44:45], v11 offset:96
    s_add_u32 s60, s62, 2392064
    s_add_u32 m0, s65, 84480
    s_nop 0
    buffer_load_dwordx4 v9, s[16:19], s60 offen lds
    v_mfma_f32_16x16x32_bf16 v[68:71], a[56:59], v[128:131], v[68:71]
    ds_read_b64_tr_b16 a[46:47], v12 offset:96
    v_mfma_f32_16x16x32_bf16 v[72:75], a[56:59], v[132:135], v[72:75]
    v_mfma_f32_16x16x32_bf16 v[76:79], a[56:59], v[136:139], v[76:79]
    v_mfma_f32_16x16x32_bf16 v[80:83], a[56:59], v[140:143], v[80:83]
    s_add_u32 s60, s60, 8192
    s_add_u32 m0, m0, 1056
    s_nop 0
    buffer_load_dwordx4 v9, s[16:19], s60 offen lds
    v_mfma_f32_16x16x32_bf16 v[84:87], a[60:63], v[128:131], v[84:87]
    v_mfma_f32_16x16x32_bf16 v[88:91], a[60:63], v[132:135], v[88:91]
    s_waitcnt vmcnt(4)
    s_waitcnt lgkmcnt(0)
    s_barrier
    v_mfma_f32_16x16x32_bf16 v[92:95], a[60:63], v[136:139], v[92:95]
    v_mfma_f32_16x16x32_bf16 v[96:99], a[60:63], v[140:143], v[96:99]
    v_mfma_f32_16x16x32_bf16 v[36:39], a[32:35], v[144:147], v[36:39]
    v_add_u32 v11, 33792, v19
    v_add_u32 v12, 50688, v19
    v_mfma_f32_16x16x32_bf16 v[40:43], a[32:35], v[148:151], v[40:43]
    ds_read_b128 v[128:131], v15 offset:8192
    ds_read_b128 v[132:135], v15 offset:22528
    s_add_u32 s60, s62, 2621440
    s_add_u32 m0, s65, 0
    s_nop 0
    buffer_load_dwordx4 v9, s[16:19], s60 offen lds
    v_mfma_f32_16x16x32_bf16 v[44:47], a[32:35], v[152:155], v[44:47]
    ds_read_b128 v[136:139], v15 offset:36864
    v_mfma_f32_16x16x32_bf16 v[48:51], a[32:35], v[156:159], v[48:51]
    ds_read_b128 v[140:143], v15 offset:51200
    ds_read_b64_tr_b16 a[48:49], v11 offset:0
    v_mfma_f32_16x16x32_bf16 v[52:55], a[36:39], v[144:147], v[52:55]
    ds_read_b64_tr_b16 a[50:51], v12 offset:0
    s_add_u32 s60, s60, 8192
    s_add_u32 m0, m0, 1056
    s_nop 0
    buffer_load_dwordx4 v9, s[16:19], s60 offen lds
    v_mfma_f32_16x16x32_bf16 v[56:59], a[36:39], v[148:151], v[56:59]
    ds_read_b64_tr_b16 a[52:53], v11 offset:32
    ds_read_b64_tr_b16 a[54:55], v12 offset:32
    v_mfma_f32_16x16x32_bf16 v[60:63], a[36:39], v[152:155], v[60:63]
    ds_read_b64_tr_b16 a[56:57], v11 offset:64
    v_mfma_f32_16x16x32_bf16 v[64:67], a[36:39], v[156:159], v[64:67]
    ds_read_b64_tr_b16 a[58:59], v12 offset:64
    ds_read_b64_tr_b16 a[60:61], v11 offset:96
    s_add_u32 s60, s62, 2654208
    s_add_u32 m0, s65, 16896
    s_nop 0
    buffer_load_dwordx4 v9, s[16:19], s60 offen lds
    v_mfma_f32_16x16x32_bf16 v[68:71], a[40:43], v[144:147], v[68:71]
    ds_read_b64_tr_b16 a[62:63], v12 offset:96
    v_mfma_f32_16x16x32_bf16 v[72:75], a[40:43], v[148:151], v[72:75]
    v_mfma_f32_16x16x32_bf16 v[76:79], a[40:43], v[152:155], v[76:79]
    v_mfma_f32_16x16x32_bf16 v[80:83], a[40:43], v[156:159], v[80:83]
    s_add_u32 s60, s60, 8192
    s_add_u32 m0, m0, 1056
    s_nop 0
    buffer_load_dwordx4 v9, s[16:19], s60 offen lds
    v_mfma_f32_16x16x32_bf16 v[84:87], a[44:47], v[144:147], v[84:87]
    v_mfma_f32_16x16x32_bf16 v[88:91], a[44:47], v[148:151], v[88:91]
    s_waitcnt vmcnt(4)
    s_waitcnt lgkmcnt(0)
    s_barrier
    v_mfma_f32_16x16x32_bf16 v[92:95], a[44:47], v[152:155], v[92:95]
    v_mfma_f32_16x16x32_bf16 v[96:99], a[44:47], v[156:159], v[96:99]
    v_mfma_f32_16x16x32_bf16 v[36:39], a[48:51], v[128:131], v[36:39]
    v_add_u32 v11, 67584, v19
    v_add_u32 v12, 84480, v19
    v_mfma_f32_16x16x32_bf16 v[40:43], a[48:51], v[132:135], v[40:43]
    ds_read_b128 v[144:147], v16 offset:9216
    ds_read_b128 v[148:151], v16 offset:23552
    s_add_u32 s60, s62, 2883584
    s_add_u32 m0, s65, 33792
    s_nop 0
    buffer_load_dwordx4 v9, s[16:19], s60 offen lds
    v_mfma_f32_16x16x32_bf16 v[44:47], a[48:51], v[136:139], v[44:47]
    ds_read_b128 v[152:155], v16 offset:37888
    v_mfma_f32_16x16x32_bf16 v[48:51], a[48:51], v[140:143], v[48:51]
    ds_read_b128 v[156:159], v16 offset:52224
    ds_read_b64_tr_b16 a[32:33], v11 offset:0
    v_mfma_f32_16x16x32_bf16 v[52:55], a[52:55], v[128:131], v[52:55]
    ds_read_b64_tr_b16 a[34:35], v12 offset:0
    s_add_u32 s60, s60, 8192
    s_add_u32 m0, m0, 1056
    s_nop 0
    buffer_load_dwordx4 v9, s[16:19], s60 offen lds
    v_mfma_f32_16x16x32_bf16 v[56:59], a[52:55], v[132:135], v[56:59]
    ds_read_b64_tr_b16 a[36:37], v11 offset:32
    ds_read_b64_tr_b16 a[38:39], v12 offset:32
    v_mfma_f32_16x16x32_bf16 v[60:63], a[52:55], v[136:139], v[60:63]
    ds_read_b64_tr_b16 a[40:41], v11 offset:64
    v_mfma_f32_16x16x32_bf16 v[64:67], a[52:55], v[140:143], v[64:67]
    ds_read_b64_tr_b16 a[42:43], v12 offset:64
    ds_read_b64_tr_b16 a[44:45], v11 offset:96
    s_add_u32 s60, s62, 2916352
    s_add_u32 m0, s65, 50688
    s_nop 0
    buffer_load_dwordx4 v9, s[16:19], s60 offen lds
    v_mfma_f32_16x16x32_bf16 v[68:71], a[56:59], v[128:131], v[68:71]
    ds_read_b64_tr_b16 a[46:47], v12 offset:96
    v_mfma_f32_16x16x32_bf16 v[72:75], a[56:59], v[132:135], v[72:75]
    v_mfma_f32_16x16x32_bf16 v[76:79], a[56:59], v[136:139], v[76:79]
    v_mfma_f32_16x16x32_bf16 v[80:83], a[56:59], v[140:143], v[80:83]
    s_add_u32 s60, s60, 8192
    s_add_u32 m0, m0, 1056
    s_nop 0
    buffer_load_dwordx4 v9, s[16:19], s60 offen lds
    v_mfma_f32_16x16x32_bf16 v[84:87], a[60:63], v[128:131], v[84:87]
    v_mfma_f32_16x16x32_bf16 v[88:91], a[60:63], v[132:135], v[88:91]
    s_waitcnt vmcnt(4)
    s_waitcnt lgkmcnt(0)
    s_barrier
    v_mfma_f32_16x16x32_bf16 v[92:95], a[60:63], v[136:139], v[92:95]
    v_mfma_f32_16x16x32_bf16 v[96:99], a[60:63], v[140:143], v[96:99]
    v_mfma_f32_16x16x32_bf16 v[36:39], a[32:35], v[144:147], v[36:39]
    v_add_u32 v11, 0, v19
    v_add_u32 v12, 16896, v19
    v_mfma_f32_16x16x32_bf16 v[40:43], a[32:35], v[148:151], v[40:43]
    ds_read_b128 v[128:131], v15 offset:10240
    ds_read_b128 v[132:135], v15 offset:24576
    s_add_u32 s60, s62, 3145728
    s_add_u32 m0, s65, 67584
    s_nop 0
    buffer_load_dwordx4 v9, s[16:19], s60 offen lds
    v_mfma_f32_16x16x32_bf16 v[44:47], a[32:35], v[152:155], v[44:47]
    ds_read_b128 v[136:139], v15 offset:38912
    v_mfma_f32_16x16x32_bf16 v[48:51], a[32:35], v[156:159], v[48:51]
    ds_read_b128 v[140:143], v15 offset:53248
    ds_read_b64_tr_b16 a[48:49], v11 offset:0
    v_mfma_f32_16x16x32_bf16 v[52:55], a[36:39], v[144:147], v[52:55]
    ds_read_b64_tr_b16 a[50:51], v12 offset:0
    s_add_u32 s60, s60, 8192
    s_add_u32 m0, m0, 1056
    s_nop 0
    buffer_load_dwordx4 v9, s[16:19], s60 offen lds
    v_mfma_f32_16x16x32_bf16 v[56:59], a[36:39], v[148:151], v[56:59]
    ds_read_b64_tr_b16 a[52:53], v11 offset:32
    ds_read_b64_tr_b16 a[54:55], v12 offset:32
    v_mfma_f32_16x16x32_bf16 v[60:63], a[36:39], v[152:155], v[60:63]
    ds_read_b64_tr_b16 a[56:57], v11 offset:64
    v_mfma_f32_16x16x32_bf16 v[64:67], a[36:39], v[156:159], v[64:67]
    ds_read_b64_tr_b16 a[58:59], v12 offset:64
    ds_read_b64_tr_b16 a[60:61], v11 offset:96
    s_add_u32 s60, s62, 3178496
    s_add_u32 m0, s65, 84480
    s_nop 0
    buffer_load_dwordx4 v9, s[16:19], s60 offen lds
    v_mfma_f32_16x16x32_bf16 v[68:71], a[40:43], v[144:147], v[68:71]
    ds_read_b64_tr_b16 a[62:63], v12 offset:96
    v_mfma_f32_16x16x32_bf16 v[72:75], a[40:43], v[148:151], v[72:75]
    v_mfma_f32_16x16x32_bf16 v[76:79], a[40:43], v[152:155], v[76:79]
    v_mfma_f32_16x16x32_bf16 v[80:83], a[40:43], v[156:159], v[80:83]
    s_add_u32 s60, s60, 8192
    s_add_u32 m0, m0, 1056
    s_nop 0
    buffer_load_dwordx4 v9, s[16:19], s60 offen lds
    v_mfma_f32_16x16x32_bf16 v[84:87], a[44:47], v[144:147], v[84:87]
    v_mfma_f32_16x16x32_bf16 v[88:91], a[44:47], v[148:151], v[88:91]
    s_waitcnt vmcnt(4)
    s_waitcnt lgkmcnt(0)
    s_barrier
    v_mfma_f32_16x16x32_bf16 v[92:95], a[44:47], v[152:155], v[92:95]
    v_mfma_f32_16x16x32_bf16 v[96:99], a[44:47], v[156:159], v[96:99]
    v_mfma_f32_16x16x32_bf16 v[36:39], a[48:51], v[128:131], v[36:39]
    v_add_u32 v11, 33792, v19
    v_add_u32 v12, 50688, v19
    v_mfma_f32_16x16x32_bf16 v[40:43], a[48:51], v[132:135], v[40:43]
    ds_read_b128 v[144:147], v16 offset:11264
    ds_read_b128 v[148:151], v16 offset:25600
    s_add_u32 s60, s62, 3407872
    s_add_u32 m0, s65, 0
    s_nop 0
    buffer_load_dwordx4 v9, s[16:19], s60 offen lds
    v_mfma_f32_16x16x32_bf16 v[44:47], a[48:51], v[136:139], v[44:47]
    ds_read_b128 v[152:155], v16 offset:39936
    v_mfma_f32_16x16x32_bf16 v[48:51], a[48:51], v[140:143], v[48:51]
    ds_read_b128 v[156:159], v16 offset:54272
    ds_read_b64_tr_b16 a[32:33], v11 offset:0
    v_mfma_f32_16x16x32_bf16 v[52:55], a[52:55], v[128:131], v[52:55]
    ds_read_b64_tr_b16 a[34:35], v12 offset:0
    s_add_u32 s60, s60, 8192
    s_add_u32 m0, m0, 1056
    s_nop 0
    buffer_load_dwordx4 v9, s[16:19], s60 offen lds
    v_mfma_f32_16x16x32_bf16 v[56:59], a[52:55], v[132:135], v[56:59]
    ds_read_b64_tr_b16 a[36:37], v11 offset:32
    ds_read_b64_tr_b16 a[38:39], v12 offset:32
    v_mfma_f32_16x16x32_bf16 v[60:63], a[52:55], v[136:139], v[60:63]
    ds_read_b64_tr_b16 a[40:41], v11 offset:64
    v_mfma_f32_16x16x32_bf16 v[64:67], a[52:55], v[140:143], v[64:67]
    ds_read_b64_tr_b16 a[42:43], v12 offset:64
    ds_read_b64_tr_b16 a[44:45], v11 offset:96
    s_add_u32 s60, s62, 3440640
    s_add_u32 m0, s65, 16896
    s_nop 0
    buffer_load_dwordx4 v9, s[16:19], s60 offen lds
    v_mfma_f32_16x16x32_bf16 v[68:71], a[56:59], v[128:131], v[68:71]
    ds_read_b64_tr_b16 a[46:47], v12 offset:96
    v_mfma_f32_16x16x32_bf16 v[72:75], a[56:59], v[132:135], v[72:75]
    v_mfma_f32_16x16x32_bf16 v[76:79], a[56:59], v[136:139], v[76:79]
    v_mfma_f32_16x16x32_bf16 v[80:83], a[56:59], v[140:143], v[80:83]
    s_add_u32 s60, s60, 8192
    s_add_u32 m0, m0, 1056
    s_nop 0
    buffer_load_dwordx4 v9, s[16:19], s60 offen lds
    v_mfma_f32_16x16x32_bf16 v[84:87], a[60:63], v[128:131], v[84:87]
    v_mfma_f32_16x16x32_bf16 v[88:91], a[60:63], v[132:135], v[88:91]
    s_waitcnt vmcnt(4)
    s_waitcnt lgkmcnt(0)
    s_barrier
    v_mfma_f32_16x16x32_bf16 v[92:95], a[60:63], v[136:139], v[92:95]
    v_mfma_f32_16x16x32_bf16 v[96:99], a[60:63], v[140:143], v[96:99]
    v_mfma_f32_16x16x32_bf16 v[36:39], a[32:35], v[144:147], v[36:39]
    v_add_u32 v11, 67584, v19
    v_add_u32 v12, 84480, v19
    v_mfma_f32_16x16x32_bf16 v[40:43], a[32:35], v[148:151], v[40:43]
    ds_read_b128 v[128:131], v15 offset:12288
    ds_read_b128 v[132:135], v15 offset:26624
    s_add_u32 s60, s66, 0
    s_add_u32 m0, s65, 33792
    s_nop 0
    buffer_load_dwordx4 v13, s[20:23], s60 offen lds
    v_mfma_f32_16x16x32_bf16 v[44:47], a[32:35], v[152:155], v[44:47]
    ds_read_b128 v[136:139], v15 offset:40960
    v_mfma_f32_16x16x32_bf16 v[48:51], a[32:35], v[156:159], v[48:51]
    ds_read_b128 v[140:143], v15 offset:55296
    ds_read_b64_tr_b16 a[48:49], v11 offset:0
    v_mfma_f32_16x16x32_bf16 v[52:55], a[36:39], v[144:147], v[52:55]
    ds_read_b64_tr_b16 a[50:51], v12 offset:0
    s_add_u32 s60, s60, 512
    s_add_u32 m0, m0, 1056
    s_nop 0
    buffer_load_dwordx4 v13, s[20:23], s60 offen lds
    v_mfma_f32_16x16x32_bf16 v[56:59], a[36:39], v[148:151], v[56:59]
    ds_read_b64_tr_b16 a[52:53], v11 offset:32
    ds_read_b64_tr_b16 a[54:55], v12 offset:32
    v_mfma_f32_16x16x32_bf16 v[60:63], a[36:39], v[152:155], v[60:63]
    ds_read_b64_tr_b16 a[56:57], v11 offset:64
    v_mfma_f32_16x16x32_bf16 v[64:67], a[36:39], v[156:159], v[64:67]
    ds_read_b64_tr_b16 a[58:59], v12 offset:64
    ds_read_b64_tr_b16 a[60:61], v11 offset:96
    s_add_u32 s60, s66, 16384
    s_add_u32 m0, s65, 50688
    s_nop 0
    buffer_load_dwordx4 v13, s[20:23], s60 offen lds
    v_mfma_f32_16x16x32_bf16 v[68:71], a[40:43], v[144:147], v[68:71]
    ds_read_b64_tr_b16 a[62:63], v12 offset:96
    v_mfma_f32_16x16x32_bf16 v[72:75], a[40:43], v[148:151], v[72:75]
    v_mfma_f32_16x16x32_bf16 v[76:79], a[40:43], v[152:155], v[76:79]
    v_mfma_f32_16x16x32_bf16 v[80:83], a[40:43], v[156:159], v[80:83]
    s_add_u32 s60, s60, 512
    s_add_u32 m0, m0, 1056
    s_nop 0
    buffer_load_dwordx4 v13, s[20:23], s60 offen lds
    v_mfma_f32_16x16x32_bf16 v[84:87], a[44:47], v[144:147], v[84:87]
    v_mfma_f32_16x16x32_bf16 v[88:91], a[44:47], v[148:151], v[88:91]
    s_waitcnt vmcnt(4)
    s_waitcnt lgkmcnt(0)
    s_barrier
    v_mfma_f32_16x16x32_bf16 v[92:95], a[44:47], v[152:155], v[92:95]
    v_mfma_f32_16x16x32_bf16 v[96:99], a[44:47], v[156:159], v[96:99]
    v_mfma_f32_16x16x32_bf16 v[36:39], a[48:51], v[128:131], v[36:39]
    v_add_u32 v11, 0, v19
    v_add_u32 v12, 16896, v19
    v_mfma_f32_16x16x32_bf16 v[40:43], a[48:51], v[132:135], v[40:43]
    ds_read_b128 v[144:147], v16 offset:13312
    ds_read_b128 v[148:151], v16 offset:27648
    v_mfma_f32_16x16x32_bf16 v[44:47], a[48:51], v[136:139], v[44:47]
    ds_read_b128 v[152:155], v16 offset:41984
    s_add_u32 s60, s66, 0
    s_add_u32 m0, s65, 67584
    s_nop 0
    buffer_load_dwordx4 v13, s[24:27], s60 offen lds
    v_mfma_f32_16x16x32_bf16 v[48:51], a[48:51], v[140:143], v[48:51]
    ds_read_b128 v[156:159], v16 offset:56320
    ds_read_b64_tr_b16 a[32:33], v11 offset:0
    v_mfma_f32_16x16x32_bf16 v[52:55], a[52:55], v[128:131], v[52:55]
    ds_read_b64_tr_b16 a[34:35], v12 offset:0
    v_mfma_f32_16x16x32_bf16 v[56:59], a[52:55], v[132:135], v[56:59]
    ds_read_b64_tr_b16 a[36:37], v11 offset:32
    ds_read_b64_tr_b16 a[38:39], v12 offset:32
    v_mfma_f32_16x16x32_bf16 v[60:63], a[52:55], v[136:139], v[60:63]
    ds_read_b64_tr_b16 a[40:41], v11 offset:64
    v_mfma_f32_16x16x32_bf16 v[64:67], a[52:55], v[140:143], v[64:67]
    ds_read_b64_tr_b16 a[42:43], v12 offset:64
    ds_read_b64_tr_b16 a[44:45], v11 offset:96
    v_mfma_f32_16x16x32_bf16 v[68:71], a[56:59], v[128:131], v[68:71]
    ds_read_b64_tr_b16 a[46:47], v12 offset:96
    v_mfma_f32_16x16x32_bf16 v[72:75], a[56:59], v[132:135], v[72:75]
    s_add_u32 s60, s60, 512
    s_add_u32 m0, m0, 1056
    s_nop 0
    buffer_load_dwordx4 v13, s[24:27], s60 offen lds
    v_mfma_f32_16x16x32_bf16 v[76:79], a[56:59], v[136:139], v[76:79]
    v_mfma_f32_16x16x32_bf16 v[80:83], a[56:59], v[140:143], v[80:83]
    v_mfma_f32_16x16x32_bf16 v[84:87], a[60:63], v[128:131], v[84:87]
    v_mfma_f32_16x16x32_bf16 v[88:91], a[60:63], v[132:135], v[88:91]
    s_waitcnt lgkmcnt(0)
    s_barrier
    v_mfma_f32_16x16x32_bf16 v[92:95], a[60:63], v[136:139], v[92:95]
    v_mfma_f32_16x16x32_bf16 v[96:99], a[60:63], v[140:143], v[96:99]
    v_mfma_f32_16x16x32_bf16 v[36:39], a[32:35], v[144:147], v[36:39]
    v_mfma_f32_16x16x32_bf16 v[40:43], a[32:35], v[148:151], v[40:43]
    s_add_u32 s60, s66, 32768
    s_add_u32 m0, s65, 0
    s_nop 0
    buffer_load_dwordx4 v13, s[20:23], s60 offen lds
    v_mfma_f32_16x16x32_bf16 v[44:47], a[32:35], v[152:155], v[44:47]
    v_mfma_f32_16x16x32_bf16 v[48:51], a[32:35], v[156:159], v[48:51]
    v_mfma_f32_16x16x32_bf16 v[52:55], a[36:39], v[144:147], v[52:55]
    v_mfma_f32_16x16x32_bf16 v[56:59], a[36:39], v[148:151], v[56:59]
    s_add_u32 s60, s60, 512
    s_add_u32 m0, m0, 1056
    s_nop 0
    buffer_load_dwordx4 v13, s[20:23], s60 offen lds
    v_mfma_f32_16x16x32_bf16 v[60:63], a[36:39], v[152:155], v[60:63]
    v_mfma_f32_16x16x32_bf16 v[64:67], a[36:39], v[156:159], v[64:67]
    v_mfma_f32_16x16x32_bf16 v[68:71], a[40:43], v[144:147], v[68:71]
    v_mfma_f32_16x16x32_bf16 v[72:75], a[40:43], v[148:151], v[72:75]
    s_add_u32 s60, s66, 49152
    s_add_u32 m0, s65, 16896
    s_nop 0
    buffer_load_dwordx4 v13, s[20:23], s60 offen lds
    v_mfma_f32_16x16x32_bf16 v[76:79], a[40:43], v[152:155], v[76:79]
    v_mfma_f32_16x16x32_bf16 v[80:83], a[40:43], v[156:159], v[80:83]
    v_mfma_f32_16x16x32_bf16 v[84:87], a[44:47], v[144:147], v[84:87]
    s_add_u32 s60, s60, 512
    s_add_u32 m0, m0, 1056
    s_nop 0
    buffer_load_dwordx4 v13, s[20:23], s60 offen lds
    v_mfma_f32_16x16x32_bf16 v[88:91], a[44:47], v[148:151], v[88:91]
    v_mfma_f32_16x16x32_bf16 v[92:95], a[44:47], v[152:155], v[92:95]
    v_mfma_f32_16x16x32_bf16 v[96:99], a[44:47], v[156:159], v[96:99]
    s_mov_b32 s73, 0x3db8aa3b
    s_mul_i32 s54, s44, 33792
    s_lshl_b32 s55, s43, 7
    s_add_u32 s54, s54, s55
    s_add_u32 s54, s54, 84480
    v_mul_u32_u24 v5, 528, v2
    v_lshlrev_b32 v6, 3, v3
    v_add3_u32 v7, v5, v6, s54
    s_nop 4
    v_mul_f32 v36, s73, v36
    v_mul_f32 v37, s73, v37
    v_mul_f32 v38, s73, v38
    v_mul_f32 v39, s73, v39
    v_cvt_pk_bf16_f32 v36, v36, v37
    v_cvt_pk_bf16_f32 v37, v38, v39
    ds_write_b64 v7, v[36:37] offset:0
    v_mul_f32 v40, s73, v40
    v_mul_f32 v41, s73, v41
    v_mul_f32 v42, s73, v42
    v_mul_f32 v43, s73, v43
    v_cvt_pk_bf16_f32 v40, v40, v41
    v_cvt_pk_bf16_f32 v41, v42, v43
    ds_write_b64 v7, v[40:41] offset:8448
    v_mul_f32 v44, s73, v44
    v_mul_f32 v45, s73, v45
    v_mul_f32 v46, s73, v46
    v_mul_f32 v47, s73, v47
    v_cvt_pk_bf16_f32 v44, v44, v45
    v_cvt_pk_bf16_f32 v45, v46, v47
    ds_write_b64 v7, v[44:45] offset:16896
    v_mul_f32 v48, s73, v48
    v_mul_f32 v49, s73, v49
    v_mul_f32 v50, s73, v50
    v_mul_f32 v51, s73, v51
    v_cvt_pk_bf16_f32 v48, v48, v49
    v_cvt_pk_bf16_f32 v49, v50, v51
    ds_write_b64 v7, v[48:49] offset:25344
    v_mul_f32 v52, s73, v52
    v_mul_f32 v53, s73, v53
    v_mul_f32 v54, s73, v54
    v_mul_f32 v55, s73, v55
    v_cvt_pk_bf16_f32 v52, v52, v53
    v_cvt_pk_bf16_f32 v53, v54, v55
    ds_write_b64 v7, v[52:53] offset:32
    v_mul_f32 v56, s73, v56
    v_mul_f32 v57, s73, v57
    v_mul_f32 v58, s73, v58
    v_mul_f32 v59, s73, v59
    v_cvt_pk_bf16_f32 v56, v56, v57
    v_cvt_pk_bf16_f32 v57, v58, v59
    ds_write_b64 v7, v[56:57] offset:8480
    v_mul_f32 v60, s73, v60
    v_mul_f32 v61, s73, v61
    v_mul_f32 v62, s73, v62
    v_mul_f32 v63, s73, v63
    v_cvt_pk_bf16_f32 v60, v60, v61
    v_cvt_pk_bf16_f32 v61, v62, v63
    ds_write_b64 v7, v[60:61] offset:16928
    v_mul_f32 v64, s73, v64
    v_mul_f32 v65, s73, v65
    v_mul_f32 v66, s73, v66
    v_mul_f32 v67, s73, v67
    v_cvt_pk_bf16_f32 v64, v64, v65
    v_cvt_pk_bf16_f32 v65, v66, v67
    ds_write_b64 v7, v[64:65] offset:25376
    v_mul_f32 v68, s73, v68
    v_mul_f32 v69, s73, v69
    v_mul_f32 v70, s73, v70
    v_mul_f32 v71, s73, v71
    v_cvt_pk_bf16_f32 v68, v68, v69
    v_cvt_pk_bf16_f32 v69, v70, v71
    ds_write_b64 v7, v[68:69] offset:64
    v_mul_f32 v72, s73, v72
    v_mul_f32 v73, s73, v73
    v_mul_f32 v74, s73, v74
    v_mul_f32 v75, s73, v75
    v_cvt_pk_bf16_f32 v72, v72, v73
    v_cvt_pk_bf16_f32 v73, v74, v75
    ds_write_b64 v7, v[72:73] offset:8512
    v_mul_f32 v76, s73, v76
    v_mul_f32 v77, s73, v77
    v_mul_f32 v78, s73, v78
    v_mul_f32 v79, s73, v79
    v_cvt_pk_bf16_f32 v76, v76, v77
    v_cvt_pk_bf16_f32 v77, v78, v79
    ds_write_b64 v7, v[76:77] offset:16960
    v_mul_f32 v80, s73, v80
    v_mul_f32 v81, s73, v81
    v_mul_f32 v82, s73, v82
    v_mul_f32 v83, s73, v83
    v_cvt_pk_bf16_f32 v80, v80, v81
    v_cvt_pk_bf16_f32 v81, v82, v83
    ds_write_b64 v7, v[80:81] offset:25408
    v_mul_f32 v84, s73, v84
    v_mul_f32 v85, s73, v85
    v_mul_f32 v86, s73, v86
    v_mul_f32 v87, s73, v87
    v_cvt_pk_bf16_f32 v84, v84, v85
    v_cvt_pk_bf16_f32 v85, v86, v87
    ds_write_b64 v7, v[84:85] offset:96
    v_mul_f32 v88, s73, v88
    v_mul_f32 v89, s73, v89
    v_mul_f32 v90, s73, v90
    v_mul_f32 v91, s73, v91
    v_cvt_pk_bf16_f32 v88, v88, v89
    v_cvt_pk_bf16_f32 v89, v90, v91
    ds_write_b64 v7, v[88:89] offset:8544
    v_mul_f32 v92, s73, v92
    v_mul_f32 v93, s73, v93
    v_mul_f32 v94, s73, v94
    v_mul_f32 v95, s73, v95
    v_cvt_pk_bf16_f32 v92, v92, v93
    v_cvt_pk_bf16_f32 v93, v94, v95
    ds_write_b64 v7, v[92:93] offset:16992
    v_mul_f32 v96, s73, v96
    v_mul_f32 v97, s73, v97
    v_mul_f32 v98, s73, v98
    v_mul_f32 v99, s73, v99
    v_cvt_pk_bf16_f32 v96, v96, v97
    v_cvt_pk_bf16_f32 v97, v98, v99
    s_waitcnt lgkmcnt(8)
    ds_write_b64 v7, v[96:97] offset:25440
    s_lshr_b32 s54, s43, 1
    s_lshl_b32 s54, s54, 6
    s_and_b32 s55, s43, 1
    s_lshl_b32 s55, s55, 5
    s_add_u32 s54, s54, s55
    s_mul_i32 s54, s54, 528
    s_add_u32 s54, s54, 84480
    v_lshlrev_b32 v6, 4, v3
    v_add3_u32 v8, v5, v6, s54
    s_waitcnt lgkmcnt(0)
    s_barrier
    ds_read_b128 a[0:3], v8 offset:0
    ds_read_b128 a[4:7], v8 offset:8448
    ds_read_b128 a[8:11], v8 offset:64
    ds_read_b128 a[12:15], v8 offset:8512
    ds_read_b128 a[16:19], v8 offset:128
    ds_read_b128 a[20:23], v8 offset:8576
    ds_read_b128 a[24:27], v8 offset:192
    ds_read_b128 a[28:31], v8 offset:8640
    ds_read_b128 a[32:35], v8 offset:256
    ds_read_b128 a[36:39], v8 offset:8704
    ds_read_b128 a[40:43], v8 offset:320
    ds_read_b128 a[44:47], v8 offset:8768
    ds_read_b128 a[48:51], v8 offset:384
    ds_read_b128 a[52:55], v8 offset:8832
    ds_read_b128 a[56:59], v8 offset:448
    s_waitcnt lgkmcnt(8)
    ds_read_b128 a[60:63], v8 offset:8896
    v_mul_u32_u24 v5, 1056, v2
    v_lshlrev_b32 v6, 4, v3
    v_add_u32 v20, v5, v6
    v_add_u32 v21, 67584, v4
    s_lshl_b32 s54, s43, 11
    v_add_u32 v22, s54, v13
    v_mov_b32 v23, v0
    s_add_u32 s48, s44, 2
    s_mul_i32 s48, s48, 16896
    s_add_u32 s50, s44, 1
    s_mul_i32 s50, s50, 33792
    s_mul_i32 s49, s44, 16896
    s_add_u32 s45, s44, 4
    s_lshl_b32 s45, s45, 14
    s_add_u32 s46, s44, 3
    s_lshl_b32 s46, s46, 14
    s_mov_b32 s51, 0
    s_mov_b32 s53, 0x41c00000
    s_waitcnt lgkmcnt(0)
    s_cmp_eq_u32 s44, 0
    s_cbranch_scc0 L_gstA
    s_lshl_b32 s54, s41, 5
    s_add_u32 s54, s54, s42
    s_mul_i32 s54, s54, 57344
    s_add_u32 s54, s54, s71
    s_add_u32 s54, s54, 0
    buffer_store_dwordx4 v[100:103], v9, s[36:39], s54 offen offset:0 sc1
    buffer_store_dwordx4 v[104:107], v9, s[36:39], s54 offen offset:1024 sc1
    buffer_store_dwordx4 v[108:111], v9, s[36:39], s54 offen offset:2048 sc1
    buffer_store_dwordx4 v[112:115], v9, s[36:39], s54 offen offset:3072 sc1
    s_add_u32 s54, s54, 4096
    buffer_store_dwordx4 v[116:119], v9, s[36:39], s54 offen offset:0 sc1
    buffer_store_dwordx4 v[120:123], v9, s[36:39], s54 offen offset:1024 sc1
    buffer_store_dwordx4 v[124:127], v9, s[36:39], s54 offen offset:2048 sc1
    buffer_store_dwordx4 v[160:163], v9, s[36:39], s54 offen offset:3072 sc1
    s_waitcnt vmcnt(14)
    s_branch L_gstA2
L_gstA:
    s_waitcnt vmcnt(6)
L_gstA2:
    s_barrier
    s_add_u32 s60, s66, 16384
    s_add_u32 m0, s65, 84480
    s_nop 0
    buffer_load_dwordx4 v13, s[24:27], s60 offen lds
    s_add_u32 s60, s60, 512
    s_add_u32 m0, m0, 1056
    s_nop 0
    buffer_load_dwordx4 v13, s[24:27], s60 offen lds
    s_add_u32 s60, s66, 32768
    s_add_u32 m0, s65, 101376
    s_nop 0
    buffer_load_dwordx4 v13, s[24:27], s60 offen lds
    s_add_u32 s60, s60, 512
    s_add_u32 m0, m0, 1056
    s_nop 0
    buffer_load_dwordx4 v13, s[24:27], s60 offen lds
    s_cmp_eq_u32 s44, 0
    s_cbranch_scc1 L_gstB
    s_lshl_b32 s54, s41, 5
    s_add_u32 s54, s54, s42
    s_mul_i32 s54, s54, 57344
    s_add_u32 s54, s54, s71
    s_add_u32 s54, s54, 0
    buffer_store_dwordx4 v[100:103], v9, s[36:39], s54 offen offset:0 sc1
    buffer_store_dwordx4 v[104:107], v9, s[36:39], s54 offen offset:1024 sc1
    buffer_store_dwordx4 v[108:111], v9, s[36:39], s54 offen offset:2048 sc1
    buffer_store_dwordx4 v[112:115], v9, s[36:39], s54 offen offset:3072 sc1
    s_add_u32 s54, s54, 4096
    buffer_store_dwordx4 v[116:119], v9, s[36:39], s54 offen offset:0 sc1
    buffer_store_dwordx4 v[120:123], v9, s[36:39], s54 offen offset:1024 sc1
L_gstB:
    v_add_u32 v1, s48, v20
    v_mov_b32 v2, v21
    v_mov_b32 v3, v22
    v_mov_b32 v4, v23
    v_mov_b64 v[36:37], 0
    v_mov_b64 v[38:39], 0
    v_mov_b64 v[40:41], 0
    v_mov_b64 v[42:43], 0
    v_mov_b64 v[44:45], 0
    v_mov_b64 v[46:47], 0
    v_mov_b64 v[48:49], 0
    v_mov_b64 v[50:51], 0
    v_mov_b64 v[52:53], 0
    v_mov_b64 v[54:55], 0
    v_mov_b64 v[56:57], 0
    v_mov_b64 v[58:59], 0
    v_mov_b64 v[60:61], 0
    v_mov_b64 v[62:63], 0
    v_mov_b64 v[64:65], 0
    v_mov_b64 v[66:67], 0
    v_mov_b64 v[68:69], 0
    v_mov_b64 v[70:71], 0
    v_mov_b64 v[72:73], 0
    v_mov_b64 v[74:75], 0
    v_mov_b64 v[76:77], 0
    v_mov_b64 v[78:79], 0
    v_mov_b64 v[80:81], 0
    v_mov_b64 v[82:83], 0
    v_mov_b64 v[84:85], 0
    v_mov_b64 v[86:87], 0
    v_mov_b64 v[88:89], 0
    v_mov_b64 v[90:91], 0
    v_mov_b64 v[92:93], 0
    v_mov_b64 v[94:95], 0
    v_mov_b64 v[96:97], 0
    v_mov_b64 v[98:99], 0
    v_mov_b64 v[100:101], 0
    v_mov_b64 v[102:103], 0
    v_mov_b64 v[104:105], 0
    v_mov_b64 v[106:107], 0
    v_mov_b64 v[108:109], 0
    v_mov_b64 v[110:111], 0
    v_mov_b64 v[112:113], 0
    v_mov_b64 v[114:115], 0
    v_mov_b64 v[116:117], 0
    v_mov_b64 v[118:119], 0
    v_mov_b64 v[120:121], 0
    v_mov_b64 v[122:123], 0
    v_mov_b64 v[124:125], 0
    v_mov_b64 v[126:127], 0
    v_mov_b64 v[128:129], 0
    v_mov_b64 v[130:131], 0
    v_mov_b64 v[132:133], 0
    v_mov_b64 v[134:135], 0
    v_mov_b64 v[136:137], 0
    v_mov_b64 v[138:139], 0
    v_mov_b64 v[140:141], 0
    v_mov_b64 v[142:143], 0
    v_mov_b64 v[144:145], 0
    v_mov_b64 v[146:147], 0
    v_mov_b64 v[148:149], 0
    v_mov_b64 v[150:151], 0
    v_mov_b64 v[152:153], 0
    v_mov_b64 v[154:155], 0
    v_mov_b64 v[156:157], 0
    v_mov_b64 v[158:159], 0
    v_mov_b64 v[160:161], 0
    v_mov_b64 v[162:163], 0
    v_mov_b64 v[28:29], 0
    v_mov_b64 v[30:31], 0
    v_mov_b64 v[32:33], 0
    v_mov_b64 v[34:35], 0
    v_mov_b32 v5, 0
    v_mov_b32 v6, 0
    s_cmp_eq_u32 s44, 0
    s_cbranch_scc1 L_setA
    s_waitcnt vmcnt(10)
    s_barrier
L_setA:
    ds_read_b128 a[72:75], v1 offset:0
    ds_read_b128 a[76:79], v1 offset:512
    ds_read_b128 a[80:83], v1 offset:64
    ds_read_b128 a[84:87], v1 offset:576
    ds_read_b128 a[88:91], v1 offset:128
    s_waitcnt lgkmcnt(3)
    v_mfma_f32_16x16x32_bf16 v[12:15], a[72:75], a[0:3], v[28:31]
    ds_read_b128 a[64:67], v1 offset:640
    v_mfma_f32_16x16x32_bf16 v[20:23], a[72:75], a[4:7], v[32:35]
    v_mfma_f32_16x16x32_bf16 v[16:19], a[76:79], a[0:3], v[28:31]
    ds_read_b128 a[68:71], v1 offset:192
    v_mfma_f32_16x16x32_bf16 v[24:27], a[76:79], a[4:7], v[32:35]
    s_waitcnt lgkmcnt(3)
    v_mfma_f32_16x16x32_bf16 v[12:15], a[80:83], a[8:11], v[12:15]
    ds_read_b128 a[72:75], v1 offset:704
    v_mfma_f32_16x16x32_bf16 v[20:23], a[80:83], a[12:15], v[20:23]
    v_mfma_f32_16x16x32_bf16 v[16:19], a[84:87], a[8:11], v[16:19]
    ds_read_b128 a[76:79], v1 offset:256
    v_mfma_f32_16x16x32_bf16 v[24:27], a[84:87], a[12:15], v[24:27]
    s_waitcnt lgkmcnt(3)
    v_mfma_f32_16x16x32_bf16 v[12:15], a[88:91], a[16:19], v[12:15]
    ds_read_b128 a[80:83], v1 offset:768
    v_mfma_f32_16x16x32_bf16 v[20:23], a[88:91], a[20:23], v[20:23]
    v_mfma_f32_16x16x32_bf16 v[16:19], a[64:67], a[16:19], v[16:19]
    ds_read_b128 a[84:87], v1 offset:320
    v_mfma_f32_16x16x32_bf16 v[24:27], a[64:67], a[20:23], v[24:27]
    s_waitcnt lgkmcnt(3)
    v_mfma_f32_16x16x32_bf16 v[12:15], a[68:71], a[24:27], v[12:15]
    ds_read_b128 a[88:91], v1 offset:832
    v_mfma_f32_16x16x32_bf16 v[20:23], a[68:71], a[28:31], v[20:23]
    v_mfma_f32_16x16x32_bf16 v[16:19], a[72:75], a[24:27], v[16:19]
    ds_read_b128 a[64:67], v1 offset:384
    v_mfma_f32_16x16x32_bf16 v[24:27], a[72:75], a[28:31], v[24:27]
    s_waitcnt lgkmcnt(3)
    v_mfma_f32_16x16x32_bf16 v[12:15], a[76:79], a[32:35], v[12:15]
    ds_read_b128 a[68:71], v1 offset:896
    v_mfma_f32_16x16x32_bf16 v[20:23], a[76:79], a[36:39], v[20:23]
    v_mfma_f32_16x16x32_bf16 v[16:19], a[80:83], a[32:35], v[16:19]
    ds_read_b128 a[72:75], v1 offset:448
    v_mfma_f32_16x16x32_bf16 v[24:27], a[80:83], a[36:39], v[24:27]
    s_waitcnt lgkmcnt(3)
    v_mfma_f32_16x16x32_bf16 v[12:15], a[84:87], a[40:43], v[12:15]
    ds_read_b128 a[76:79], v1 offset:960
    v_mfma_f32_16x16x32_bf16 v[20:23], a[84:87], a[44:47], v[20:23]
    v_mfma_f32_16x16x32_bf16 v[16:19], a[88:91], a[40:43], v[16:19]
    v_mfma_f32_16x16x32_bf16 v[24:27], a[88:91], a[44:47], v[24:27]
    s_waitcnt lgkmcnt(2)
    v_mfma_f32_16x16x32_bf16 v[12:15], a[64:67], a[48:51], v[12:15]
    v_mfma_f32_16x16x32_bf16 v[20:23], a[64:67], a[52:55], v[20:23]
    v_mfma_f32_16x16x32_bf16 v[16:19], a[68:71], a[48:51], v[16:19]
    v_mfma_f32_16x16x32_bf16 v[24:27], a[68:71], a[52:55], v[24:27]
    s_waitcnt lgkmcnt(0)
    v_mfma_f32_16x16x32_bf16 v[12:15], a[72:75], a[56:59], v[12:15]
    v_mfma_f32_16x16x32_bf16 v[20:23], a[72:75], a[60:63], v[20:23]
    s_cmp_eq_u32 s44, 0
    s_cbranch_scc1 L_fa
    s_waitcnt vmcnt(0)
L_fa:
    s_waitcnt vmcnt(4)
    s_barrier
    v_mfma_f32_16x16x32_bf16 v[16:19], a[76:79], a[56:59], v[16:19]
    v_mfma_f32_16x16x32_bf16 v[24:27], a[76:79], a[60:63], v[24:27]
    s_setprio 1
    s_sub_u32 s54, s50, s48
    s_sub_u32 s55, s54, s48
    v_add_u32 v1, s55, v1
    s_sub_u32 s55, s49, s51
    v_add_u32 v2, s55, v2
    s_nop 2
    v_max3_f32 v7, v12, v13, v14
    v_max3_f32 v7, v7, v15, v16
    v_max3_f32 v7, v7, v17, v18
    v_max_f32 v7, v7, v19
    v_mov_b32 v9, v7
    v_mov_b32 v10, v7
    s_nop 1
    v_permlane32_swap_b32 v9, v10
    s_nop 1
    v_max_f32 v9, v9, v10
    v_mov_b32 v10, v9
    s_nop 1
    v_permlane16_swap_b32 v9, v10
    s_nop 1
    v_max_f32 v7, v9, v10
    v_sub_f32 v12, v12, v7
    v_sub_f32 v13, v13, v7
    v_sub_f32 v14, v14, v7
    v_sub_f32 v15, v15, v7
    v_sub_f32 v16, v16, v7
    v_sub_f32 v17, v17, v7
    v_sub_f32 v18, v18, v7
    v_sub_f32 v19, v19, v7
    v_sub_f32 v28, 0, v7
    v_sub_f32 v29, 0, v7
    v_sub_f32 v30, 0, v7
    v_sub_f32 v31, 0, v7
    v_max3_f32 v7, v20, v21, v22
    v_max3_f32 v7, v7, v23, v24
    v_max3_f32 v7, v7, v25, v26
    v_max_f32 v7, v7, v27
    v_mov_b32 v9, v7
    v_mov_b32 v10, v7
    s_nop 1
    v_permlane32_swap_b32 v9, v10
    s_nop 1
    v_max_f32 v9, v9, v10
    v_mov_b32 v10, v9
    s_nop 1
    v_permlane16_swap_b32 v9, v10
    s_nop 1
    v_max_f32 v7, v9, v10
    v_sub_f32 v20, v20, v7
    v_sub_f32 v21, v21, v7
    v_sub_f32 v22, v22, v7
    v_sub_f32 v23, v23, v7
    v_sub_f32 v24, v24, v7
    v_sub_f32 v25, v25, v7
    v_sub_f32 v26, v26, v7
    v_sub_f32 v27, v27, v7
    v_sub_f32 v32, 0, v7
    v_sub_f32 v33, 0, v7
    v_sub_f32 v34, 0, v7
    v_sub_f32 v35, 0, v7
    v_exp_f32 v12, v12
    s_add_u32 s56, s48, s52
    v_exp_f32 v13, v13
    s_mov_b32 m0, s56
    v_exp_f32 v14, v14
    buffer_load_dwordx4 v3, s[20:23], s45 offen offset:0 lds
    s_add_u32 m0, m0, 544
    v_exp_f32 v15, v15
    buffer_load_dwordx4 v3, s[20:23], s45 offen offset:512 lds
    v_exp_f32 v16, v16
    s_add_u32 m0, m0, 544
    v_exp_f32 v17, v17
    buffer_load_dwordx4 v3, s[20:23], s45 offen offset:1024 lds
    s_add_u32 m0, m0, 544
    v_exp_f32 v18, v18
    buffer_load_dwordx4 v3, s[20:23], s45 offen offset:1536 lds
    v_exp_f32 v19, v19
    s_add_u32 s56, s44, 3
    s_mul_i32 s56, s56, 16896
    v_exp_f32 v20, v20
    s_add_u32 s56, s56, s52
    v_exp_f32 v21, v21
    s_add_u32 s56, s56, 67584
    v_exp_f32 v22, v22
    s_mov_b32 m0, s56
    s_nop 0
    buffer_load_dwordx4 v3, s[24:27], s46 offen offset:0 lds
    v_exp_f32 v23, v23
    s_add_u32 m0, m0, 544
    v_exp_f32 v24, v24
    buffer_load_dwordx4 v3, s[24:27], s46 offen offset:512 lds
    s_add_u32 m0, m0, 544
    v_exp_f32 v25, v25
    buffer_load_dwordx4 v3, s[24:27], s46 offen offset:1024 lds
    v_exp_f32 v26, v26
    s_add_u32 m0, m0, 544
    v_exp_f32 v27, v27
    buffer_load_dwordx4 v3, s[24:27], s46 offen offset:1536 lds
    s_add_u32 s45, s45, 32768
    v_add_f32 v5, v5, v12
    v_add_f32 v5, v5, v13
    s_add_u32 s46, s46, 32768
    v_add_f32 v5, v5, v14
    v_add_f32 v5, v5, v15
    s_sub_u32 s48, s50, s48
    s_mov_b32 s51, s49
    v_add_f32 v5, v5, v16
    v_add_f32 v5, v5, v17
    s_add_u32 s49, s49, 33792
    v_add_f32 v5, v5, v18
    v_add_f32 v5, v5, v19
    s_cmp_ge_u32 s49, 84480
    v_add_f32 v6, v6, v20
    v_add_f32 v6, v6, v21
    s_cselect_b32 s54, 84480, 0
    s_sub_u32 s49, s49, s54
    v_add_f32 v6, v6, v22
    v_add_f32 v6, v6, v23
    ds_read_b64_tr_b16 a[64:65], v2 offset:0
    v_add_f32 v6, v6, v24
    v_add_f32 v6, v6, v25
    ds_read_b64_tr_b16 a[66:67], v2 offset:512
    ds_read_b64_tr_b16 a[68:69], v2 offset:32
    v_add_f32 v6, v6, v26
    v_add_f32 v6, v6, v27
    ds_read_b64_tr_b16 a[70:71], v2 offset:544
    v_cvt_pk_bf16_f32 v12, v12, v13
    v_cvt_pk_bf16_f32 v13, v14, v15
    ds_read_b64_tr_b16 a[72:73], v2 offset:64
    v_cvt_pk_bf16_f32 v14, v16, v17
    v_cvt_pk_bf16_f32 v15, v18, v19
    ds_read_b64_tr_b16 a[74:75], v2 offset:576
    ds_read_b64_tr_b16 a[76:77], v2 offset:96
    v_cvt_pk_bf16_f32 v20, v20, v21
    v_cvt_pk_bf16_f32 v21, v22, v23
    ds_read_b64_tr_b16 a[78:79], v2 offset:608
    v_cvt_pk_bf16_f32 v22, v24, v25
    v_cvt_pk_bf16_f32 v23, v26, v27
    ds_read_b64_tr_b16 a[80:81], v2 offset:128
    ds_read_b64_tr_b16 a[82:83], v2 offset:640
    s_waitcnt vmcnt(8)
    s_setprio 0
    s_barrier
    s_cmp_eq_u32 s40, 0
    s_cbranch_scc0 L_gsig
    s_lshl_b32 s54, s42, 2
    s_add_u32 s54, s54, 128
    v_mov_b32 v7, 0
    v_mov_b32 v8, 1
    s_mov_b64 exec, 1
    buffer_atomic_add v8, v7, s[32:35], s54 offen sc1
    s_mov_b64 exec, -1
L_gsig:
    v_mbcnt_lo_u32_b32 v7, -1, 0
    v_mbcnt_hi_u32_b32 v7, -1, v7
    s_lshl_b32 s54, s40, 6
    v_add_u32 v7, s54, v7
    v_lshlrev_b32 v7, 7, v7
    s_mul_i32 s54, s42, 14336
    v_cmp_gt_u32 vcc, 14336, v7
    v_mov_b32 v8, 0x7fffffff
    v_add_u32 v7, s54, v7
    v_cndmask_b32 v7, v8, v7, vcc
    buffer_load_dword v11, v7, s[28:31], 0 offen
    s_mov_b32 s47, 29
.p2align 6
L_loop:
    s_waitcnt lgkmcnt(6)
    v_mfma_f32_16x16x32_bf16 v[36:39], a[64:67], v[12:15], v[36:39]
    ds_read_b64_tr_b16 a[84:85], v2 offset:160
    v_mfma_f32_16x16x32_bf16 v[40:43], a[64:67], v[20:23], v[40:43]
    ds_read_b64_tr_b16 a[86:87], v2 offset:672
    v_mfma_f32_16x16x32_bf16 v[44:47], a[68:71], v[12:15], v[44:47]
    ds_read_b64_tr_b16 a[88:89], v2 offset:192
    v_mfma_f32_16x16x32_bf16 v[48:51], a[68:71], v[20:23], v[48:51]
    ds_read_b64_tr_b16 a[90:91], v2 offset:704
    s_waitcnt lgkmcnt(6)
    v_mfma_f32_16x16x32_bf16 v[52:55], a[72:75], v[12:15], v[52:55]
    ds_read_b64_tr_b16 a[64:65], v2 offset:224
    v_mfma_f32_16x16x32_bf16 v[56:59], a[72:75], v[20:23], v[56:59]
    ds_read_b64_tr_b16 a[66:67], v2 offset:736
    v_mfma_f32_16x16x32_bf16 v[60:63], a[76:79], v[12:15], v[60:63]
    ds_read_b64_tr_b16 a[68:69], v2 offset:256
    v_mfma_f32_16x16x32_bf16 v[64:67], a[76:79], v[20:23], v[64:67]
    ds_read_b64_tr_b16 a[70:71], v2 offset:768
    s_waitcnt lgkmcnt(6)
    v_mfma_f32_16x16x32_bf16 v[68:71], a[80:83], v[12:15], v[68:71]
    ds_read_b64_tr_b16 a[72:73], v2 offset:288
    v_mfma_f32_16x16x32_bf16 v[72:75], a[80:83], v[20:23], v[72:75]
    ds_read_b64_tr_b16 a[74:75], v2 offset:800
    v_mfma_f32_16x16x32_bf16 v[76:79], a[84:87], v[12:15], v[76:79]
    ds_read_b64_tr_b16 a[76:77], v2 offset:320
    v_mfma_f32_16x16x32_bf16 v[80:83], a[84:87], v[20:23], v[80:83]
    ds_read_b64_tr_b16 a[78:79], v2 offset:832
    s_waitcnt lgkmcnt(6)
    v_mfma_f32_16x16x32_bf16 v[84:87], a[88:91], v[12:15], v[84:87]
    ds_read_b64_tr_b16 a[80:81], v2 offset:352
    v_mfma_f32_16x16x32_bf16 v[88:91], a[88:91], v[20:23], v[88:91]
    ds_read_b64_tr_b16 a[82:83], v2 offset:864
    v_mfma_f32_16x16x32_bf16 v[92:95], a[64:67], v[12:15], v[92:95]
    ds_read_b64_tr_b16 a[84:85], v2 offset:384
    v_mfma_f32_16x16x32_bf16 v[96:99], a[64:67], v[20:23], v[96:99]
    ds_read_b64_tr_b16 a[86:87], v2 offset:896
    s_waitcnt lgkmcnt(6)
    v_mfma_f32_16x16x32_bf16 v[100:103], a[68:71], v[12:15], v[100:103]
    ds_read_b64_tr_b16 a[88:89], v2 offset:416
    v_mfma_f32_16x16x32_bf16 v[104:107], a[68:71], v[20:23], v[104:107]
    ds_read_b64_tr_b16 a[90:91], v2 offset:928
    v_mfma_f32_16x16x32_bf16 v[108:111], a[72:75], v[12:15], v[108:111]
    ds_read_b64_tr_b16 a[64:65], v2 offset:448
    v_mfma_f32_16x16x32_bf16 v[112:115], a[72:75], v[20:23], v[112:115]
    ds_read_b64_tr_b16 a[66:67], v2 offset:960
    s_waitcnt lgkmcnt(6)
    v_mfma_f32_16x16x32_bf16 v[116:119], a[76:79], v[12:15], v[116:119]
    ds_read_b64_tr_b16 a[68:69], v2 offset:480
    v_mfma_f32_16x16x32_bf16 v[120:123], a[76:79], v[20:23], v[120:123]
    ds_read_b64_tr_b16 a[70:71], v2 offset:992
    v_mfma_f32_16x16x32_bf16 v[124:127], a[80:83], v[12:15], v[124:127]
    ds_read_b128 a[72:75], v1 offset:0
    v_mfma_f32_16x16x32_bf16 v[128:131], a[80:83], v[20:23], v[128:131]
    s_waitcnt lgkmcnt(5)
    v_mfma_f32_16x16x32_bf16 v[132:135], a[84:87], v[12:15], v[132:135]
    ds_read_b128 a[76:79], v1 offset:512
    v_mfma_f32_16x16x32_bf16 v[136:139], a[84:87], v[20:23], v[136:139]
    v_mfma_f32_16x16x32_bf16 v[140:143], a[88:91], v[12:15], v[140:143]
    ds_read_b128 a[80:83], v1 offset:64
    v_mfma_f32_16x16x32_bf16 v[144:147], a[88:91], v[20:23], v[144:147]
    s_waitcnt lgkmcnt(3)
    v_mfma_f32_16x16x32_bf16 v[148:151], a[64:67], v[12:15], v[148:151]
    ds_read_b128 a[84:87], v1 offset:576
    v_mfma_f32_16x16x32_bf16 v[152:155], a[64:67], v[20:23], v[152:155]
    v_mfma_f32_16x16x32_bf16 v[156:159], a[68:71], v[12:15], v[156:159]
    ds_read_b128 a[88:91], v1 offset:128
    v_mfma_f32_16x16x32_bf16 v[160:163], a[68:71], v[20:23], v[160:163]
    s_waitcnt lgkmcnt(3)
    v_mfma_f32_16x16x32_bf16 v[12:15], a[72:75], a[0:3], v[28:31]
    ds_read_b128 a[64:67], v1 offset:640
    v_mfma_f32_16x16x32_bf16 v[20:23], a[72:75], a[4:7], v[32:35]
    v_mfma_f32_16x16x32_bf16 v[16:19], a[76:79], a[0:3], v[28:31]
    ds_read_b128 a[68:71], v1 offset:192
    v_mfma_f32_16x16x32_bf16 v[24:27], a[76:79], a[4:7], v[32:35]
    s_waitcnt lgkmcnt(3)
    v_mfma_f32_16x16x32_bf16 v[12:15], a[80:83], a[8:11], v[12:15]
    ds_read_b128 a[72:75], v1 offset:704
    v_mfma_f32_16x16x32_bf16 v[20:23], a[80:83], a[12:15], v[20:23]
    v_mfma_f32_16x16x32_bf16 v[16:19], a[84:87], a[8:11], v[16:19]
    ds_read_b128 a[76:79], v1 offset:256
    v_mfma_f32_16x16x32_bf16 v[24:27], a[84:87], a[12:15], v[24:27]
    s_waitcnt lgkmcnt(3)
    v_mfma_f32_16x16x32_bf16 v[12:15], a[88:91], a[16:19], v[12:15]
    ds_read_b128 a[80:83], v1 offset:768
    v_mfma_f32_16x16x32_bf16 v[20:23], a[88:91], a[20:23], v[20:23]
    v_mfma_f32_16x16x32_bf16 v[16:19], a[64:67], a[16:19], v[16:19]
    ds_read_b128 a[84:87], v1 offset:320
    v_mfma_f32_16x16x32_bf16 v[24:27], a[64:67], a[20:23], v[24:27]
    s_waitcnt lgkmcnt(3)
    v_mfma_f32_16x16x32_bf16 v[12:15], a[68:71], a[24:27], v[12:15]
    ds_read_b128 a[88:91], v1 offset:832
    v_mfma_f32_16x16x32_bf16 v[20:23], a[68:71], a[28:31], v[20:23]
    v_mfma_f32_16x16x32_bf16 v[16:19], a[72:75], a[24:27], v[16:19]
    ds_read_b128 a[64:67], v1 offset:384
    v_mfma_f32_16x16x32_bf16 v[24:27], a[72:75], a[28:31], v[24:27]
    s_waitcnt lgkmcnt(3)
    v_mfma_f32_16x16x32_bf16 v[12:15], a[76:79], a[32:35], v[12:15]
    ds_read_b128 a[68:71], v1 offset:896
    v_mfma_f32_16x16x32_bf16 v[20:23], a[76:79], a[36:39], v[20:23]
    v_mfma_f32_16x16x32_bf16 v[16:19], a[80:83], a[32:35], v[16:19]
    ds_read_b128 a[72:75], v1 offset:448
    v_mfma_f32_16x16x32_bf16 v[24:27], a[80:83], a[36:39], v[24:27]
    s_waitcnt lgkmcnt(3)
    v_mfma_f32_16x16x32_bf16 v[12:15], a[84:87], a[40:43], v[12:15]
    ds_read_b128 a[76:79], v1 offset:960
    v_mfma_f32_16x16x32_bf16 v[20:23], a[84:87], a[44:47], v[20:23]
    v_mfma_f32_16x16x32_bf16 v[16:19], a[88:91], a[40:43], v[16:19]
    v_mfma_f32_16x16x32_bf16 v[24:27], a[88:91], a[44:47], v[24:27]
    s_waitcnt lgkmcnt(2)
    v_mfma_f32_16x16x32_bf16 v[12:15], a[64:67], a[48:51], v[12:15]
    v_mfma_f32_16x16x32_bf16 v[20:23], a[64:67], a[52:55], v[20:23]
    v_mfma_f32_16x16x32_bf16 v[16:19], a[68:71], a[48:51], v[16:19]
    v_mfma_f32_16x16x32_bf16 v[24:27], a[68:71], a[52:55], v[24:27]
    s_waitcnt lgkmcnt(0)
    v_mfma_f32_16x16x32_bf16 v[12:15], a[72:75], a[56:59], v[12:15]
    v_mfma_f32_16x16x32_bf16 v[20:23], a[72:75], a[60:63], v[20:23]
    s_barrier
    v_mfma_f32_16x16x32_bf16 v[16:19], a[76:79], a[56:59], v[16:19]
    v_mfma_f32_16x16x32_bf16 v[24:27], a[76:79], a[60:63], v[24:27]
    s_setprio 1
    s_sub_u32 s54, s50, s48
    s_sub_u32 s55, s54, s48
    v_add_u32 v1, s55, v1
    s_sub_u32 s55, s49, s51
    v_add_u32 v2, s55, v2
    s_nop 2
    v_max3_f32 v7, v12, v13, v14
    v_max3_f32 v7, v7, v15, v16
    v_max3_f32 v7, v7, v17, v18
    v_max3_f32 v7, v7, v19, v20
    v_max3_f32 v7, v7, v21, v22
    v_max3_f32 v7, v7, v23, v24
    v_max3_f32 v7, v7, v25, v26
    v_max_f32 v7, v7, v27
    v_cmp_lt_f32 vcc, s53, v7
    s_nop 1
    s_cbranch_vccnz L_rareL
L_backL:
    v_exp_f32 v12, v12
    s_add_u32 s56, s48, s52
    v_exp_f32 v13, v13
    s_mov_b32 m0, s56
    v_exp_f32 v14, v14
    buffer_load_dwordx4 v3, s[20:23], s45 offen offset:0 lds
    v_exp_f32 v15, v15
    s_add_u32 m0, m0, 544
    s_nop 0
    buffer_load_dwordx4 v3, s[20:23], s45 offen offset:512 lds
    v_exp_f32 v16, v16
    s_add_u32 m0, m0, 544
    v_exp_f32 v17, v17
    buffer_load_dwordx4 v3, s[20:23], s45 offen offset:1024 lds
    v_exp_f32 v18, v18
    s_add_u32 m0, m0, 544
    s_nop 0
    buffer_load_dwordx4 v3, s[20:23], s45 offen offset:1536 lds
    v_exp_f32 v19, v19
    s_add_u32 s56, s51, s52
    v_exp_f32 v20, v20
    s_add_u32 s56, s56, 67584
    v_exp_f32 v21, v21
    s_mov_b32 m0, s56
    s_nop 0
    buffer_load_dwordx4 v3, s[24:27], s46 offen offset:0 lds
    v_exp_f32 v22, v22
    s_add_u32 m0, m0, 544
    v_exp_f32 v23, v23
    buffer_load_dwordx4 v3, s[24:27], s46 offen offset:512 lds
    v_exp_f32 v24, v24
    s_add_u32 m0, m0, 544
    s_nop 0
    buffer_load_dwordx4 v3, s[24:27], s46 offen offset:1024 lds
    v_exp_f32 v25, v25
    s_add_u32 m0, m0, 544
    v_exp_f32 v26, v26
    buffer_load_dwordx4 v3, s[24:27], s46 offen offset:1536 lds
    v_exp_f32 v27, v27
    s_add_u32 s45, s45, 32768
    s_add_u32 s46, s46, 32768
    v_add_f32 v5, v5, v12
    v_add_f32 v5, v5, v13
    s_sub_u32 s48, s50, s48
    v_add_f32 v5, v5, v14
    v_add_f32 v5, v5, v15
    s_mov_b32 s51, s49
    v_add_f32 v5, v5, v16
    v_add_f32 v5, v5, v17
    s_add_u32 s49, s49, 33792
    s_cmp_ge_u32 s49, 84480
    v_add_f32 v5, v5, v18
    v_add_f32 v5, v5, v19
    s_cselect_b32 s54, 84480, 0
    v_add_f32 v6, v6, v20
    v_add_f32 v6, v6, v21
    s_sub_u32 s49, s49, s54
    v_add_f32 v6, v6, v22
    v_add_f32 v6, v6, v23
    ds_read_b64_tr_b16 a[64:65], v2 offset:0
    ds_read_b64_tr_b16 a[66:67], v2 offset:512
    v_add_f32 v6, v6, v24
    v_add_f32 v6, v6, v25
    ds_read_b64_tr_b16 a[68:69], v2 offset:32
    v_add_f32 v6, v6, v26
    v_add_f32 v6, v6, v27
    ds_read_b64_tr_b16 a[70:71], v2 offset:544
    v_cvt_pk_bf16_f32 v12, v12, v13
    v_cvt_pk_bf16_f32 v13, v14, v15
    ds_read_b64_tr_b16 a[72:73], v2 offset:64
    ds_read_b64_tr_b16 a[74:75], v2 offset:576
    v_cvt_pk_bf16_f32 v14, v16, v17
    v_cvt_pk_bf16_f32 v15, v18, v19
    ds_read_b64_tr_b16 a[76:77], v2 offset:96
    v_cvt_pk_bf16_f32 v20, v20, v21
    v_cvt_pk_bf16_f32 v21, v22, v23
    ds_read_b64_tr_b16 a[78:79], v2 offset:608
    v_cvt_pk_bf16_f32 v22, v24, v25
    v_cvt_pk_bf16_f32 v23, v26, v27
    ds_read_b64_tr_b16 a[80:81], v2 offset:128
    ds_read_b64_tr_b16 a[82:83], v2 offset:640
    s_waitcnt vmcnt(8)
    s_setprio 0
    s_barrier
    s_sub_u32 s47, s47, 1
    s_cmp_lg_u32 s47, 0
    s_cbranch_scc1 L_loop
    s_mul_i32 s59, s44, 14336
    s_waitcnt lgkmcnt(6)
    v_mfma_f32_16x16x32_bf16 v[36:39], a[64:67], v[12:15], v[36:39]
    ds_read_b64_tr_b16 a[84:85], v2 offset:160
    v_mfma_f32_16x16x32_bf16 v[40:43], a[64:67], v[20:23], v[40:43]
    ds_read_b64_tr_b16 a[86:87], v2 offset:672
    v_mfma_f32_16x16x32_bf16 v[44:47], a[68:71], v[12:15], v[44:47]
    ds_read_b64_tr_b16 a[88:89], v2 offset:192
    v_mfma_f32_16x16x32_bf16 v[48:51], a[68:71], v[20:23], v[48:51]
    ds_read_b64_tr_b16 a[90:91], v2 offset:704
    s_waitcnt lgkmcnt(6)
    v_mfma_f32_16x16x32_bf16 v[52:55], a[72:75], v[12:15], v[52:55]
    ds_read_b64_tr_b16 a[64:65], v2 offset:224
    v_mfma_f32_16x16x32_bf16 v[56:59], a[72:75], v[20:23], v[56:59]
    ds_read_b64_tr_b16 a[66:67], v2 offset:736
    v_mfma_f32_16x16x32_bf16 v[60:63], a[76:79], v[12:15], v[60:63]
    ds_read_b64_tr_b16 a[68:69], v2 offset:256
    v_mfma_f32_16x16x32_bf16 v[64:67], a[76:79], v[20:23], v[64:67]
    ds_read_b64_tr_b16 a[70:71], v2 offset:768
    s_waitcnt lgkmcnt(6)
    v_mfma_f32_16x16x32_bf16 v[68:71], a[80:83], v[12:15], v[68:71]
    ds_read_b64_tr_b16 a[72:73], v2 offset:288
    v_mfma_f32_16x16x32_bf16 v[72:75], a[80:83], v[20:23], v[72:75]
    ds_read_b64_tr_b16 a[74:75], v2 offset:800
    v_mfma_f32_16x16x32_bf16 v[76:79], a[84:87], v[12:15], v[76:79]
    ds_read_b64_tr_b16 a[76:77], v2 offset:320
    v_mfma_f32_16x16x32_bf16 v[80:83], a[84:87], v[20:23], v[80:83]
    ds_read_b64_tr_b16 a[78:79], v2 offset:832
    s_waitcnt lgkmcnt(6)
    v_mfma_f32_16x16x32_bf16 v[84:87], a[88:91], v[12:15], v[84:87]
    ds_read_b64_tr_b16 a[80:81], v2 offset:352
    v_mfma_f32_16x16x32_bf16 v[88:91], a[88:91], v[20:23], v[88:91]
    ds_read_b64_tr_b16 a[82:83], v2 offset:864
    v_mfma_f32_16x16x32_bf16 v[92:95], a[64:67], v[12:15], v[92:95]
    ds_read_b64_tr_b16 a[84:85], v2 offset:384
    v_mfma_f32_16x16x32_bf16 v[96:99], a[64:67], v[20:23], v[96:99]
    ds_read_b64_tr_b16 a[86:87], v2 offset:896
    s_waitcnt lgkmcnt(6)
    v_mfma_f32_16x16x32_bf16 v[100:103], a[68:71], v[12:15], v[100:103]
    ds_read_b64_tr_b16 a[88:89], v2 offset:416
    v_mfma_f32_16x16x32_bf16 v[104:107], a[68:71], v[20:23], v[104:107]
    ds_read_b64_tr_b16 a[90:91], v2 offset:928
    v_mfma_f32_16x16x32_bf16 v[108:111], a[72:75], v[12:15], v[108:111]
    ds_read_b64_tr_b16 a[64:65], v2 offset:448
    v_mfma_f32_16x16x32_bf16 v[112:115], a[72:75], v[20:23], v[112:115]
    ds_read_b64_tr_b16 a[66:67], v2 offset:960
    s_waitcnt lgkmcnt(6)
    v_mfma_f32_16x16x32_bf16 v[116:119], a[76:79], v[12:15], v[116:119]
    ds_read_b64_tr_b16 a[68:69], v2 offset:480
    v_mfma_f32_16x16x32_bf16 v[120:123], a[76:79], v[20:23], v[120:123]
    ds_read_b64_tr_b16 a[70:71], v2 offset:992
    v_mfma_f32_16x16x32_bf16 v[124:127], a[80:83], v[12:15], v[124:127]
    ds_read_b128 a[72:75], v1 offset:0
    v_mfma_f32_16x16x32_bf16 v[128:131], a[80:83], v[20:23], v[128:131]
    s_waitcnt lgkmcnt(5)
    v_mfma_f32_16x16x32_bf16 v[132:135], a[84:87], v[12:15], v[132:135]
    ds_read_b128 a[76:79], v1 offset:512
    v_mfma_f32_16x16x32_bf16 v[136:139], a[84:87], v[20:23], v[136:139]
    v_mfma_f32_16x16x32_bf16 v[140:143], a[88:91], v[12:15], v[140:143]
    ds_read_b128 a[80:83], v1 offset:64
    v_mfma_f32_16x16x32_bf16 v[144:147], a[88:91], v[20:23], v[144:147]
    s_waitcnt lgkmcnt(3)
    v_mfma_f32_16x16x32_bf16 v[148:151], a[64:67], v[12:15], v[148:151]
    ds_read_b128 a[84:87], v1 offset:576
    v_mfma_f32_16x16x32_bf16 v[152:155], a[64:67], v[20:23], v[152:155]
    v_mfma_f32_16x16x32_bf16 v[156:159], a[68:71], v[12:15], v[156:159]
    ds_read_b128 a[88:91], v1 offset:128
    v_mfma_f32_16x16x32_bf16 v[160:163], a[68:71], v[20:23], v[160:163]
    s_waitcnt lgkmcnt(3)
    v_mfma_f32_16x16x32_bf16 v[12:15], a[72:75], a[0:3], v[28:31]
    ds_read_b128 a[64:67], v1 offset:640
    v_mfma_f32_16x16x32_bf16 v[20:23], a[72:75], a[4:7], v[32:35]
    v_mfma_f32_16x16x32_bf16 v[16:19], a[76:79], a[0:3], v[28:31]
    ds_read_b128 a[68:71], v1 offset:192
    v_mfma_f32_16x16x32_bf16 v[24:27], a[76:79], a[4:7], v[32:35]
    s_waitcnt lgkmcnt(3)
    v_mfma_f32_16x16x32_bf16 v[12:15], a[80:83], a[8:11], v[12:15]
    ds_read_b128 a[72:75], v1 offset:704
    v_mfma_f32_16x16x32_bf16 v[20:23], a[80:83], a[12:15], v[20:23]
    v_mfma_f32_16x16x32_bf16 v[16:19], a[84:87], a[8:11], v[16:19]
    ds_read_b128 a[76:79], v1 offset:256
    v_mfma_f32_16x16x32_bf16 v[24:27], a[84:87], a[12:15], v[24:27]
    s_waitcnt lgkmcnt(3)
    v_mfma_f32_16x16x32_bf16 v[12:15], a[88:91], a[16:19], v[12:15]
    ds_read_b128 a[80:83], v1 offset:768
    v_mfma_f32_16x16x32_bf16 v[20:23], a[88:91], a[20:23], v[20:23]
    v_mfma_f32_16x16x32_bf16 v[16:19], a[64:67], a[16:19], v[16:19]
    ds_read_b128 a[84:87], v1 offset:320
    v_mfma_f32_16x16x32_bf16 v[24:27], a[64:67], a[20:23], v[24:27]
    s_waitcnt lgkmcnt(3)
    v_mfma_f32_16x16x32_bf16 v[12:15], a[68:71], a[24:27], v[12:15]
    ds_read_b128 a[88:91], v1 offset:832
    v_mfma_f32_16x16x32_bf16 v[20:23], a[68:71], a[28:31], v[20:23]
    v_mfma_f32_16x16x32_bf16 v[16:19], a[72:75], a[24:27], v[16:19]
    ds_read_b128 a[64:67], v1 offset:384
    v_mfma_f32_16x16x32_bf16 v[24:27], a[72:75], a[28:31], v[24:27]
    s_waitcnt lgkmcnt(3)
    v_mfma_f32_16x16x32_bf16 v[12:15], a[76:79], a[32:35], v[12:15]
    ds_read_b128 a[68:71], v1 offset:896
    v_mfma_f32_16x16x32_bf16 v[20:23], a[76:79], a[36:39], v[20:23]
    v_mfma_f32_16x16x32_bf16 v[16:19], a[80:83], a[32:35], v[16:19]
    ds_read_b128 a[72:75], v1 offset:448
    v_mfma_f32_16x16x32_bf16 v[24:27], a[80:83], a[36:39], v[24:27]
    s_waitcnt lgkmcnt(3)
    v_mfma_f32_16x16x32_bf16 v[12:15], a[84:87], a[40:43], v[12:15]
    ds_read_b128 a[76:79], v1 offset:960
    v_mfma_f32_16x16x32_bf16 v[20:23], a[84:87], a[44:47], v[20:23]
    v_mfma_f32_16x16x32_bf16 v[16:19], a[88:91], a[40:43], v[16:19]
    v_mfma_f32_16x16x32_bf16 v[24:27], a[88:91], a[44:47], v[24:27]
    s_waitcnt lgkmcnt(2)
    v_mfma_f32_16x16x32_bf16 v[12:15], a[64:67], a[48:51], v[12:15]
    v_mfma_f32_16x16x32_bf16 v[20:23], a[64:67], a[52:55], v[20:23]
    v_mfma_f32_16x16x32_bf16 v[16:19], a[68:71], a[48:51], v[16:19]
    v_mfma_f32_16x16x32_bf16 v[24:27], a[68:71], a[52:55], v[24:27]
    s_waitcnt lgkmcnt(0)
    v_mfma_f32_16x16x32_bf16 v[12:15], a[72:75], a[56:59], v[12:15]
    v_mfma_f32_16x16x32_bf16 v[20:23], a[72:75], a[60:63], v[20:23]
    s_barrier
    v_mfma_f32_16x16x32_bf16 v[16:19], a[76:79], a[56:59], v[16:19]
    v_mfma_f32_16x16x32_bf16 v[24:27], a[76:79], a[60:63], v[24:27]
    s_setprio 1
    s_sub_u32 s54, s50, s48
    s_sub_u32 s55, s54, s48
    v_add_u32 v1, s55, v1
    s_sub_u32 s55, s49, s51
    v_add_u32 v2, s55, v2
    s_nop 2
    v_max3_f32 v7, v12, v13, v14
    v_max3_f32 v7, v7, v15, v16
    v_max3_f32 v7, v7, v17, v18
    v_max3_f32 v7, v7, v19, v20
    v_max3_f32 v7, v7, v21, v22
    v_max3_f32 v7, v7, v23, v24
    v_max3_f32 v7, v7, v25, v26
    v_max_f32 v7, v7, v27
    v_cmp_lt_f32 vcc, s53, v7
    s_nop 1
    s_cbranch_vccnz L_rareP1
L_backP1:
    v_exp_f32 v12, v12
    s_add_u32 s56, s48, s52
    v_exp_f32 v13, v13
    s_mov_b32 m0, s56
    v_exp_f32 v14, v14
    s_add_u32 s57, s69, s59
    buffer_load_dwordx4 v4, s[28:31], s57 offen offset:0 lds
    v_exp_f32 v15, v15
    s_add_u32 m0, m0, 160
    v_exp_f32 v16, v16
    buffer_load_dwordx4 v4, s[28:31], s57 offen offset:896 lds
    v_exp_f32 v17, v17
    s_add_u32 m0, m0, 160
    s_nop 0
    buffer_load_dwordx4 v4, s[28:31], s57 offen offset:1792 lds
    v_exp_f32 v18, v18
    s_add_u32 m0, m0, 160
    v_exp_f32 v19, v19
    buffer_load_dwordx4 v4, s[28:31], s57 offen offset:2688 lds
    v_exp_f32 v20, v20
    s_add_u32 s56, s51, s52
    s_add_u32 s56, s56, 67584
    v_exp_f32 v21, v21
    s_mov_b32 m0, s56
    v_exp_f32 v22, v22
    buffer_load_dwordx4 v3, s[24:27], s46 offen offset:0 lds
    v_exp_f32 v23, v23
    s_add_u32 m0, m0, 544
    s_nop 0
    buffer_load_dwordx4 v3, s[24:27], s46 offen offset:512 lds
    v_exp_f32 v24, v24
    s_add_u32 m0, m0, 544
    v_exp_f32 v25, v25
    buffer_load_dwordx4 v3, s[24:27], s46 offen offset:1024 lds
    s_add_u32 m0, m0, 544
    v_exp_f32 v26, v26
    buffer_load_dwordx4 v3, s[24:27], s46 offen offset:1536 lds
    v_exp_f32 v27, v27
    s_add_u32 s45, s45, 32768
    v_add_f32 v5, v5, v12
    v_add_f32 v5, v5, v13
    s_add_u32 s46, s46, 32768
    s_sub_u32 s48, s50, s48
    v_add_f32 v5, v5, v14
    v_add_f32 v5, v5, v15
    s_mov_b32 s51, s49
    v_add_f32 v5, v5, v16
    v_add_f32 v5, v5, v17
    s_add_u32 s49, s49, 33792
    v_add_f32 v5, v5, v18
    v_add_f32 v5, v5, v19
    s_cmp_ge_u32 s49, 84480
    s_cselect_b32 s54, 84480, 0
    v_add_f32 v6, v6, v20
    v_add_f32 v6, v6, v21
    s_sub_u32 s49, s49, s54
    v_add_f32 v6, v6, v22
    v_add_f32 v6, v6, v23
    ds_read_b64_tr_b16 a[64:65], v2 offset:0
    v_add_f32 v6, v6, v24
    v_add_f32 v6, v6, v25
    ds_read_b64_tr_b16 a[66:67], v2 offset:512
    ds_read_b64_tr_b16 a[68:69], v2 offset:32
    v_add_f32 v6, v6, v26
    v_add_f32 v6, v6, v27
    ds_read_b64_tr_b16 a[70:71], v2 offset:544
    v_cvt_pk_bf16_f32 v12, v12, v13
    v_cvt_pk_bf16_f32 v13, v14, v15
    ds_read_b64_tr_b16 a[72:73], v2 offset:64
    v_cvt_pk_bf16_f32 v14, v16, v17
    v_cvt_pk_bf16_f32 v15, v18, v19
    ds_read_b64_tr_b16 a[74:75], v2 offset:576
    ds_read_b64_tr_b16 a[76:77], v2 offset:96
    v_cvt_pk_bf16_f32 v20, v20, v21
    v_cvt_pk_bf16_f32 v21, v22, v23
    ds_read_b64_tr_b16 a[78:79], v2 offset:608
    v_cvt_pk_bf16_f32 v22, v24, v25
    v_cvt_pk_bf16_f32 v23, v26, v27
    ds_read_b64_tr_b16 a[80:81], v2 offset:128
    ds_read_b64_tr_b16 a[82:83], v2 offset:640
    s_waitcnt vmcnt(8)
    s_setprio 0
    s_barrier
    s_add_u32 s59, s44, 2
    s_mul_i32 s59, s59, 14336
    s_mul_i32 s58, s44, 1048576
    s_add_u32 s58, s58, 57344
    s_waitcnt lgkmcnt(6)
    v_mfma_f32_16x16x32_bf16 v[36:39], a[64:67], v[12:15], v[36:39]
    ds_read_b64_tr_b16 a[84:85], v2 offset:160
    v_mfma_f32_16x16x32_bf16 v[40:43], a[64:67], v[20:23], v[40:43]
    ds_read_b64_tr_b16 a[86:87], v2 offset:672
    v_mfma_f32_16x16x32_bf16 v[44:47], a[68:71], v[12:15], v[44:47]
    ds_read_b64_tr_b16 a[88:89], v2 offset:192
    v_mfma_f32_16x16x32_bf16 v[48:51], a[68:71], v[20:23], v[48:51]
    ds_read_b64_tr_b16 a[90:91], v2 offset:704
    s_waitcnt lgkmcnt(6)
    v_mfma_f32_16x16x32_bf16 v[52:55], a[72:75], v[12:15], v[52:55]
    ds_read_b64_tr_b16 a[64:65], v2 offset:224
    v_mfma_f32_16x16x32_bf16 v[56:59], a[72:75], v[20:23], v[56:59]
    ds_read_b64_tr_b16 a[66:67], v2 offset:736
    v_mfma_f32_16x16x32_bf16 v[60:63], a[76:79], v[12:15], v[60:63]
    ds_read_b64_tr_b16 a[68:69], v2 offset:256
    v_mfma_f32_16x16x32_bf16 v[64:67], a[76:79], v[20:23], v[64:67]
    ds_read_b64_tr_b16 a[70:71], v2 offset:768
    s_waitcnt lgkmcnt(6)
    v_mfma_f32_16x16x32_bf16 v[68:71], a[80:83], v[12:15], v[68:71]
    ds_read_b64_tr_b16 a[72:73], v2 offset:288
    v_mfma_f32_16x16x32_bf16 v[72:75], a[80:83], v[20:23], v[72:75]
    ds_read_b64_tr_b16 a[74:75], v2 offset:800
    v_mfma_f32_16x16x32_bf16 v[76:79], a[84:87], v[12:15], v[76:79]
    ds_read_b64_tr_b16 a[76:77], v2 offset:320
    v_mfma_f32_16x16x32_bf16 v[80:83], a[84:87], v[20:23], v[80:83]
    ds_read_b64_tr_b16 a[78:79], v2 offset:832
    s_waitcnt lgkmcnt(6)
    v_mfma_f32_16x16x32_bf16 v[84:87], a[88:91], v[12:15], v[84:87]
    ds_read_b64_tr_b16 a[80:81], v2 offset:352
    v_mfma_f32_16x16x32_bf16 v[88:91], a[88:91], v[20:23], v[88:91]
    ds_read_b64_tr_b16 a[82:83], v2 offset:864
    v_mfma_f32_16x16x32_bf16 v[92:95], a[64:67], v[12:15], v[92:95]
    ds_read_b64_tr_b16 a[84:85], v2 offset:384
    v_mfma_f32_16x16x32_bf16 v[96:99], a[64:67], v[20:23], v[96:99]
    ds_read_b64_tr_b16 a[86:87], v2 offset:896
    s_waitcnt lgkmcnt(6)
    v_mfma_f32_16x16x32_bf16 v[100:103], a[68:71], v[12:15], v[100:103]
    ds_read_b64_tr_b16 a[88:89], v2 offset:416
    v_mfma_f32_16x16x32_bf16 v[104:107], a[68:71], v[20:23], v[104:107]
    ds_read_b64_tr_b16 a[90:91], v2 offset:928
    v_mfma_f32_16x16x32_bf16 v[108:111], a[72:75], v[12:15], v[108:111]
    ds_read_b64_tr_b16 a[64:65], v2 offset:448
    v_mfma_f32_16x16x32_bf16 v[112:115], a[72:75], v[20:23], v[112:115]
    ds_read_b64_tr_b16 a[66:67], v2 offset:960
    s_waitcnt lgkmcnt(6)
    v_mfma_f32_16x16x32_bf16 v[116:119], a[76:79], v[12:15], v[116:119]
    ds_read_b64_tr_b16 a[68:69], v2 offset:480
    v_mfma_f32_16x16x32_bf16 v[120:123], a[76:79], v[20:23], v[120:123]
    ds_read_b64_tr_b16 a[70:71], v2 offset:992
    v_mfma_f32_16x16x32_bf16 v[124:127], a[80:83], v[12:15], v[124:127]
    ds_read_b128 a[72:75], v1 offset:0
    v_mfma_f32_16x16x32_bf16 v[128:131], a[80:83], v[20:23], v[128:131]
    s_waitcnt lgkmcnt(5)
    v_mfma_f32_16x16x32_bf16 v[132:135], a[84:87], v[12:15], v[132:135]
    ds_read_b128 a[76:79], v1 offset:512
    v_mfma_f32_16x16x32_bf16 v[136:139], a[84:87], v[20:23], v[136:139]
    v_mfma_f32_16x16x32_bf16 v[140:143], a[88:91], v[12:15], v[140:143]
    ds_read_b128 a[80:83], v1 offset:64
    v_mfma_f32_16x16x32_bf16 v[144:147], a[88:91], v[20:23], v[144:147]
    s_waitcnt lgkmcnt(3)
    v_mfma_f32_16x16x32_bf16 v[148:151], a[64:67], v[12:15], v[148:151]
    ds_read_b128 a[84:87], v1 offset:576
    v_mfma_f32_16x16x32_bf16 v[152:155], a[64:67], v[20:23], v[152:155]
    v_mfma_f32_16x16x32_bf16 v[156:159], a[68:71], v[12:15], v[156:159]
    ds_read_b128 a[88:91], v1 offset:128
    v_mfma_f32_16x16x32_bf16 v[160:163], a[68:71], v[20:23], v[160:163]
    s_waitcnt lgkmcnt(3)
    v_mfma_f32_16x16x32_bf16 v[12:15], a[72:75], a[0:3], v[28:31]
    ds_read_b128 a[64:67], v1 offset:640
    v_mfma_f32_16x16x32_bf16 v[20:23], a[72:75], a[4:7], v[32:35]
    v_mfma_f32_16x16x32_bf16 v[16:19], a[76:79], a[0:3], v[28:31]
    ds_read_b128 a[68:71], v1 offset:192
    v_mfma_f32_16x16x32_bf16 v[24:27], a[76:79], a[4:7], v[32:35]
    s_waitcnt lgkmcnt(3)
    v_mfma_f32_16x16x32_bf16 v[12:15], a[80:83], a[8:11], v[12:15]
    ds_read_b128 a[72:75], v1 offset:704
    v_mfma_f32_16x16x32_bf16 v[20:23], a[80:83], a[12:15], v[20:23]
    v_mfma_f32_16x16x32_bf16 v[16:19], a[84:87], a[8:11], v[16:19]
    ds_read_b128 a[76:79], v1 offset:256
    v_mfma_f32_16x16x32_bf16 v[24:27], a[84:87], a[12:15], v[24:27]
    s_waitcnt lgkmcnt(3)
    v_mfma_f32_16x16x32_bf16 v[12:15], a[88:91], a[16:19], v[12:15]
    ds_read_b128 a[80:83], v1 offset:768
    v_mfma_f32_16x16x32_bf16 v[20:23], a[88:91], a[20:23], v[20:23]
    v_mfma_f32_16x16x32_bf16 v[16:19], a[64:67], a[16:19], v[16:19]
    ds_read_b128 a[84:87], v1 offset:320
    v_mfma_f32_16x16x32_bf16 v[24:27], a[64:67], a[20:23], v[24:27]
    s_waitcnt lgkmcnt(3)
    v_mfma_f32_16x16x32_bf16 v[12:15], a[68:71], a[24:27], v[12:15]
    ds_read_b128 a[88:91], v1 offset:832
    v_mfma_f32_16x16x32_bf16 v[20:23], a[68:71], a[28:31], v[20:23]
    v_mfma_f32_16x16x32_bf16 v[16:19], a[72:75], a[24:27], v[16:19]
    ds_read_b128 a[64:67], v1 offset:384
    v_mfma_f32_16x16x32_bf16 v[24:27], a[72:75], a[28:31], v[24:27]
    s_waitcnt lgkmcnt(3)
    v_mfma_f32_16x16x32_bf16 v[12:15], a[76:79], a[32:35], v[12:15]
    ds_read_b128 a[68:71], v1 offset:896
    v_mfma_f32_16x16x32_bf16 v[20:23], a[76:79], a[36:39], v[20:23]
    v_mfma_f32_16x16x32_bf16 v[16:19], a[80:83], a[32:35], v[16:19]
    ds_read_b128 a[72:75], v1 offset:448
    v_mfma_f32_16x16x32_bf16 v[24:27], a[80:83], a[36:39], v[24:27]
    s_waitcnt lgkmcnt(3)
    v_mfma_f32_16x16x32_bf16 v[12:15], a[84:87], a[40:43], v[12:15]
    ds_read_b128 a[76:79], v1 offset:960
    v_mfma_f32_16x16x32_bf16 v[20:23], a[84:87], a[44:47], v[20:23]
    v_mfma_f32_16x16x32_bf16 v[16:19], a[88:91], a[40:43], v[16:19]
    v_mfma_f32_16x16x32_bf16 v[24:27], a[88:91], a[44:47], v[24:27]
    s_waitcnt lgkmcnt(2)
    v_mfma_f32_16x16x32_bf16 v[12:15], a[64:67], a[48:51], v[12:15]
    v_mfma_f32_16x16x32_bf16 v[20:23], a[64:67], a[52:55], v[20:23]
    v_mfma_f32_16x16x32_bf16 v[16:19], a[68:71], a[48:51], v[16:19]
    v_mfma_f32_16x16x32_bf16 v[24:27], a[68:71], a[52:55], v[24:27]
    s_waitcnt lgkmcnt(0)
    v_mfma_f32_16x16x32_bf16 v[12:15], a[72:75], a[56:59], v[12:15]
    v_mfma_f32_16x16x32_bf16 v[20:23], a[72:75], a[60:63], v[20:23]
    s_barrier
    v_mfma_f32_16x16x32_bf16 v[16:19], a[76:79], a[56:59], v[16:19]
    v_mfma_f32_16x16x32_bf16 v[24:27], a[76:79], a[60:63], v[24:27]
    s_setprio 1
    s_sub_u32 s54, s50, s48
    s_sub_u32 s55, s54, s48
    v_add_u32 v1, s55, v1
    s_sub_u32 s55, s49, s51
    v_add_u32 v2, s55, v2
    s_nop 2
    v_max3_f32 v7, v12, v13, v14
    v_max3_f32 v7, v7, v15, v16
    v_max3_f32 v7, v7, v17, v18
    v_max3_f32 v7, v7, v19, v20
    v_max3_f32 v7, v7, v21, v22
    v_max3_f32 v7, v7, v23, v24
    v_max3_f32 v7, v7, v25, v26
    v_max_f32 v7, v7, v27
    v_cmp_lt_f32 vcc, s53, v7
    s_nop 1
    s_cbranch_vccnz L_rareP2
L_backP2:
    v_exp_f32 v12, v12
    s_add_u32 s56, s48, s52
    v_exp_f32 v13, v13
    s_mov_b32 m0, s56
    v_exp_f32 v14, v14
    s_add_u32 s57, s69, s59
    buffer_load_dwordx4 v4, s[28:31], s57 offen offset:0 lds
    v_exp_f32 v15, v15
    s_add_u32 m0, m0, 160
    v_exp_f32 v16, v16
    buffer_load_dwordx4 v4, s[28:31], s57 offen offset:896 lds
    v_exp_f32 v17, v17
    s_add_u32 m0, m0, 160
    s_nop 0
    buffer_load_dwordx4 v4, s[28:31], s57 offen offset:1792 lds
    v_exp_f32 v18, v18
    s_add_u32 m0, m0, 160
    v_exp_f32 v19, v19
    buffer_load_dwordx4 v4, s[28:31], s57 offen offset:2688 lds
    s_add_u32 s56, s51, s52
    v_exp_f32 v20, v20
    s_add_u32 s56, s56, 67584
    v_exp_f32 v21, v21
    s_mov_b32 m0, s56
    v_exp_f32 v22, v22
    s_add_u32 s57, s69, s58
    buffer_load_dwordx4 v4, s[28:31], s57 offen offset:0 lds
    v_exp_f32 v23, v23
    s_add_u32 m0, m0, 160
    v_exp_f32 v24, v24
    buffer_load_dwordx4 v4, s[28:31], s57 offen offset:896 lds
    s_add_u32 m0, m0, 160
    v_exp_f32 v25, v25
    buffer_load_dwordx4 v4, s[28:31], s57 offen offset:1792 lds
    v_exp_f32 v26, v26
    s_add_u32 m0, m0, 160
    v_exp_f32 v27, v27
    buffer_load_dwordx4 v4, s[28:31], s57 offen offset:2688 lds
    s_add_u32 s45, s45, 32768
    v_add_f32 v5, v5, v12
    v_add_f32 v5, v5, v13
    s_add_u32 s46, s46, 32768
    v_add_f32 v5, v5, v14
    v_add_f32 v5, v5, v15
    s_sub_u32 s48, s50, s48
    s_mov_b32 s51, s49
    v_add_f32 v5, v5, v16
    v_add_f32 v5, v5, v17
    s_add_u32 s49, s49, 33792
    v_add_f32 v5, v5, v18
    v_add_f32 v5, v5, v19
    s_cmp_ge_u32 s49, 84480
    v_add_f32 v6, v6, v20
    v_add_f32 v6, v6, v21
    s_cselect_b32 s54, 84480, 0
    s_sub_u32 s49, s49, s54
    v_add_f32 v6, v6, v22
    v_add_f32 v6, v6, v23
    ds_read_b64_tr_b16 a[64:65], v2 offset:0
    v_add_f32 v6, v6, v24
    v_add_f32 v6, v6, v25
    ds_read_b64_tr_b16 a[66:67], v2 offset:512
    ds_read_b64_tr_b16 a[68:69], v2 offset:32
    v_add_f32 v6, v6, v26
    v_add_f32 v6, v6, v27
    ds_read_b64_tr_b16 a[70:71], v2 offset:544
    v_cvt_pk_bf16_f32 v12, v12, v13
    v_cvt_pk_bf16_f32 v13, v14, v15
    ds_read_b64_tr_b16 a[72:73], v2 offset:64
    v_cvt_pk_bf16_f32 v14, v16, v17
    v_cvt_pk_bf16_f32 v15, v18, v19
    ds_read_b64_tr_b16 a[74:75], v2 offset:576
    ds_read_b64_tr_b16 a[76:77], v2 offset:96
    v_cvt_pk_bf16_f32 v20, v20, v21
    v_cvt_pk_bf16_f32 v21, v22, v23
    ds_read_b64_tr_b16 a[78:79], v2 offset:608
    v_cvt_pk_bf16_f32 v22, v24, v25
    v_cvt_pk_bf16_f32 v23, v26, v27
    ds_read_b64_tr_b16 a[80:81], v2 offset:128
    ds_read_b64_tr_b16 a[82:83], v2 offset:640
    s_waitcnt vmcnt(8)
    s_setprio 0
    s_barrier
    s_waitcnt lgkmcnt(6)
    v_mfma_f32_16x16x32_bf16 v[36:39], a[64:67], v[12:15], v[36:39]
    ds_read_b64_tr_b16 a[84:85], v2 offset:160
    v_mfma_f32_16x16x32_bf16 v[40:43], a[64:67], v[20:23], v[40:43]
    ds_read_b64_tr_b16 a[86:87], v2 offset:672
    v_mfma_f32_16x16x32_bf16 v[44:47], a[68:71], v[12:15], v[44:47]
    ds_read_b64_tr_b16 a[88:89], v2 offset:192
    v_mfma_f32_16x16x32_bf16 v[48:51], a[68:71], v[20:23], v[48:51]
    ds_read_b64_tr_b16 a[90:91], v2 offset:704
    s_waitcnt lgkmcnt(6)
    v_mfma_f32_16x16x32_bf16 v[52:55], a[72:75], v[12:15], v[52:55]
    ds_read_b64_tr_b16 a[64:65], v2 offset:224
    v_mfma_f32_16x16x32_bf16 v[56:59], a[72:75], v[20:23], v[56:59]
    ds_read_b64_tr_b16 a[66:67], v2 offset:736
    v_mfma_f32_16x16x32_bf16 v[60:63], a[76:79], v[12:15], v[60:63]
    ds_read_b64_tr_b16 a[68:69], v2 offset:256
    v_mfma_f32_16x16x32_bf16 v[64:67], a[76:79], v[20:23], v[64:67]
    ds_read_b64_tr_b16 a[70:71], v2 offset:768
    s_waitcnt lgkmcnt(6)
    v_mfma_f32_16x16x32_bf16 v[68:71], a[80:83], v[12:15], v[68:71]
    ds_read_b64_tr_b16 a[72:73], v2 offset:288
    v_mfma_f32_16x16x32_bf16 v[72:75], a[80:83], v[20:23], v[72:75]
    ds_read_b64_tr_b16 a[74:75], v2 offset:800
    v_mfma_f32_16x16x32_bf16 v[76:79], a[84:87], v[12:15], v[76:79]
    ds_read_b64_tr_b16 a[76:77], v2 offset:320
    v_mfma_f32_16x16x32_bf16 v[80:83], a[84:87], v[20:23], v[80:83]
    ds_read_b64_tr_b16 a[78:79], v2 offset:832
    s_waitcnt lgkmcnt(6)
    v_mfma_f32_16x16x32_bf16 v[84:87], a[88:91], v[12:15], v[84:87]
    ds_read_b64_tr_b16 a[80:81], v2 offset:352
    v_mfma_f32_16x16x32_bf16 v[88:91], a[88:91], v[20:23], v[88:91]
    ds_read_b64_tr_b16 a[82:83], v2 offset:864
    v_mfma_f32_16x16x32_bf16 v[92:95], a[64:67], v[12:15], v[92:95]
    ds_read_b64_tr_b16 a[84:85], v2 offset:384
    v_mfma_f32_16x16x32_bf16 v[96:99], a[64:67], v[20:23], v[96:99]
    ds_read_b64_tr_b16 a[86:87], v2 offset:896
    s_waitcnt lgkmcnt(6)
    v_mfma_f32_16x16x32_bf16 v[100:103], a[68:71], v[12:15], v[100:103]
    ds_read_b64_tr_b16 a[88:89], v2 offset:416
    v_mfma_f32_16x16x32_bf16 v[104:107], a[68:71], v[20:23], v[104:107]
    ds_read_b64_tr_b16 a[90:91], v2 offset:928
    v_mfma_f32_16x16x32_bf16 v[108:111], a[72:75], v[12:15], v[108:111]
    ds_read_b64_tr_b16 a[64:65], v2 offset:448
    v_mfma_f32_16x16x32_bf16 v[112:115], a[72:75], v[20:23], v[112:115]
    ds_read_b64_tr_b16 a[66:67], v2 offset:960
    s_waitcnt lgkmcnt(6)
    v_mfma_f32_16x16x32_bf16 v[116:119], a[76:79], v[12:15], v[116:119]
    ds_read_b64_tr_b16 a[68:69], v2 offset:480
    v_mfma_f32_16x16x32_bf16 v[120:123], a[76:79], v[20:23], v[120:123]
    ds_read_b64_tr_b16 a[70:71], v2 offset:992
    v_mfma_f32_16x16x32_bf16 v[124:127], a[80:83], v[12:15], v[124:127]
    v_mfma_f32_16x16x32_bf16 v[128:131], a[80:83], v[20:23], v[128:131]
    s_waitcnt lgkmcnt(4)
    v_mfma_f32_16x16x32_bf16 v[132:135], a[84:87], v[12:15], v[132:135]
    v_mfma_f32_16x16x32_bf16 v[136:139], a[84:87], v[20:23], v[136:139]
    v_mfma_f32_16x16x32_bf16 v[140:143], a[88:91], v[12:15], v[140:143]
    v_mfma_f32_16x16x32_bf16 v[144:147], a[88:91], v[20:23], v[144:147]
    s_waitcnt lgkmcnt(0)
    v_mfma_f32_16x16x32_bf16 v[148:151], a[64:67], v[12:15], v[148:151]
    v_mfma_f32_16x16x32_bf16 v[152:155], a[64:67], v[20:23], v[152:155]
    s_barrier
    v_mfma_f32_16x16x32_bf16 v[156:159], a[68:71], v[12:15], v[156:159]
    v_mfma_f32_16x16x32_bf16 v[160:163], a[68:71], v[20:23], v[160:163]
    s_cmp_eq_u32 s44, 0
    s_cbranch_scc0 L_setB2
    s_barrier
L_setB2:
    s_nop 7
    s_nop 7
    v_mov_b32 v9, v5
    v_mov_b32 v10, v5
    s_nop 1
    v_permlane32_swap_b32 v9, v10
    s_nop 1
    v_add_f32 v9, v9, v10
    v_mov_b32 v10, v9
    s_nop 1
    v_permlane16_swap_b32 v9, v10
    s_nop 1
    v_add_f32 v12, v9, v10
    v_mov_b32 v9, v6
    v_mov_b32 v10, v6
    s_nop 1
    v_permlane32_swap_b32 v9, v10
    s_nop 1
    v_add_f32 v9, v9, v10
    v_mov_b32 v10, v9
    s_nop 1
    v_permlane16_swap_b32 v9, v10
    s_nop 1
    v_add_f32 v13, v9, v10
    v_mbcnt_lo_u32_b32 v14, -1, 0
    v_mbcnt_hi_u32_b32 v14, -1, v14
    v_and_b32 v15, 15, v14
    s_lshl_b32 s54, s40, 8
    s_add_u32 s54, s54, 158720
    v_lshlrev_b32 v17, 3, v15
    v_add_u32 v18, s54, v17
    v_mov_b32 v20, v28
    v_mov_b32 v21, v12
    v_mov_b32 v22, v32
    v_mov_b32 v23, v13
    ds_write_b64 v18, v[20:21]
    ds_write_b64 v18, v[22:23] offset:128
    s_load_dwordx4 s[96:99], s[0:1], 72
    s_lshl_b32 s58, s42, 2
    s_add_u32 s58, s58, 128
    v_mov_b32 v19, 0
    s_cmp_eq_u32 s40, 0
    s_cbranch_scc0 L_gp0
    buffer_load_dword v11, v19, s[32:35], s58 offen sc1
L_gp0:
    s_waitcnt vmcnt(0)
    s_cmp_eq_u32 s40, 0
    s_cbranch_scc0 L_gp2
    s_mov_b32 s59, 0
L_gp1:
    v_readfirstlane_b32 s54, v11
    s_nop 3
    s_cmp_ge_u32 s54, 8
    s_cbranch_scc1 L_gp2
    s_add_u32 s59, s59, 1
    s_cmp_ge_u32 s59, 40000
    s_cbranch_scc1 L_gp2
    s_sleep 2
    buffer_load_dword v11, v19, s[32:35], s58 offen sc1
    s_waitcnt vmcnt(0)
    s_branch L_gp1
L_gp2:
    s_waitcnt lgkmcnt(0)
    s_barrier
    s_xor_b32 s54, s40, 4
    s_lshl_b32 s54, s54, 8
    s_add_u32 s54, s54, 158720
    v_add_u32 v18, s54, v17
    ds_read_b64 v[24:25], v18
    ds_read_b64 v[26:27], v18 offset:128
    s_waitcnt lgkmcnt(0)
    v_min_f32 v17, v20, v24
    v_sub_f32 v18, v17, v20
    v_sub_f32 v19, v17, v24
    v_exp_f32 v18, v18
    v_exp_f32 v19, v19
    s_nop 0
    v_mul_f32 v21, v21, v18
    v_fma_f32 v21, v25, v19, v21
    v_rcp_f32 v21, v21
    s_nop 0
    v_mul_f32 v28, v18, v21
    v_mov_b32 v29, v28
    v_min_f32 v17, v22, v26
    v_sub_f32 v18, v17, v22
    v_sub_f32 v19, v17, v26
    v_exp_f32 v18, v18
    v_exp_f32 v19, v19
    s_nop 0
    v_mul_f32 v23, v23, v18
    v_fma_f32 v23, v27, v19, v23
    v_rcp_f32 v23, v23
    s_nop 0
    v_mul_f32 v30, v18, v23
    v_mov_b32 v31, v30
    v_lshlrev_b32 v17, 4, v14
    s_xor_b32 s54, s40, 4
    s_lshl_b32 s54, s54, 13
    s_add_u32 s54, s54, 84480
    v_add_u32 v18, s54, v17
    s_lshl_b32 s54, s40, 13
    s_add_u32 s54, s54, 84480
    v_add_u32 v19, s54, v17
    s_cmp_eq_u32 s44, 0
    s_cbranch_scc0 L_mergeB
    v_pk_mul_f32 v[100:101], v[100:101], v[28:29]
    v_pk_mul_f32 v[102:103], v[102:103], v[28:29]
    v_pk_mul_f32 v[108:109], v[108:109], v[28:29]
    v_pk_mul_f32 v[110:111], v[110:111], v[28:29]
    v_cvt_pk_bf16_f32 v20, v100, v101
    v_cvt_pk_bf16_f32 v21, v102, v103
    v_cvt_pk_bf16_f32 v22, v108, v109
    v_cvt_pk_bf16_f32 v23, v110, v111
    ds_write_b128 v18, v[20:23] offset:0
    v_pk_mul_f32 v[104:105], v[104:105], v[30:31]
    v_pk_mul_f32 v[106:107], v[106:107], v[30:31]
    v_pk_mul_f32 v[112:113], v[112:113], v[30:31]
    v_pk_mul_f32 v[114:115], v[114:115], v[30:31]
    v_cvt_pk_bf16_f32 v24, v104, v105
    v_cvt_pk_bf16_f32 v25, v106, v107
    v_cvt_pk_bf16_f32 v26, v112, v113
    v_cvt_pk_bf16_f32 v27, v114, v115
    ds_write_b128 v18, v[24:27] offset:1024
    s_waitcnt lgkmcnt(1)
    v_pk_mul_f32 v[116:117], v[116:117], v[28:29]
    v_pk_mul_f32 v[118:119], v[118:119], v[28:29]
    v_pk_mul_f32 v[124:125], v[124:125], v[28:29]
    v_pk_mul_f32 v[126:127], v[126:127], v[28:29]
    v_cvt_pk_bf16_f32 v20, v116, v117
    v_cvt_pk_bf16_f32 v21, v118, v119
    v_cvt_pk_bf16_f32 v22, v124, v125
    v_cvt_pk_bf16_f32 v23, v126, v127
    ds_write_b128 v18, v[20:23] offset:2048
    v_pk_mul_f32 v[120:121], v[120:121], v[30:31]
    v_pk_mul_f32 v[122:123], v[122:123], v[30:31]
    v_pk_mul_f32 v[128:129], v[128:129], v[30:31]
    v_pk_mul_f32 v[130:131], v[130:131], v[30:31]
    v_cvt_pk_bf16_f32 v24, v120, v121
    v_cvt_pk_bf16_f32 v25, v122, v123
    v_cvt_pk_bf16_f32 v26, v128, v129
    v_cvt_pk_bf16_f32 v27, v130, v131
    ds_write_b128 v18, v[24:27] offset:3072
    s_waitcnt lgkmcnt(1)
    v_pk_mul_f32 v[132:133], v[132:133], v[28:29]
    v_pk_mul_f32 v[134:135], v[134:135], v[28:29]
    v_pk_mul_f32 v[140:141], v[140:141], v[28:29]
    v_pk_mul_f32 v[142:143], v[142:143], v[28:29]
    v_cvt_pk_bf16_f32 v20, v132, v133
    v_cvt_pk_bf16_f32 v21, v134, v135
    v_cvt_pk_bf16_f32 v22, v140, v141
    v_cvt_pk_bf16_f32 v23, v142, v143
    ds_write_b128 v18, v[20:23] offset:4096
    v_pk_mul_f32 v[136:137], v[136:137], v[30:31]
    v_pk_mul_f32 v[138:139], v[138:139], v[30:31]
    v_pk_mul_f32 v[144:145], v[144:145], v[30:31]
    v_pk_mul_f32 v[146:147], v[146:147], v[30:31]
    v_cvt_pk_bf16_f32 v24, v136, v137
    v_cvt_pk_bf16_f32 v25, v138, v139
    v_cvt_pk_bf16_f32 v26, v144, v145
    v_cvt_pk_bf16_f32 v27, v146, v147
    ds_write_b128 v18, v[24:27] offset:5120
    s_waitcnt lgkmcnt(1)
    v_pk_mul_f32 v[148:149], v[148:149], v[28:29]
    v_pk_mul_f32 v[150:151], v[150:151], v[28:29]
    v_pk_mul_f32 v[156:157], v[156:157], v[28:29]
    v_pk_mul_f32 v[158:159], v[158:159], v[28:29]
    v_cvt_pk_bf16_f32 v20, v148, v149
    v_cvt_pk_bf16_f32 v21, v150, v151
    v_cvt_pk_bf16_f32 v22, v156, v157
    v_cvt_pk_bf16_f32 v23, v158, v159
    ds_write_b128 v18, v[20:23] offset:6144
    v_pk_mul_f32 v[152:153], v[152:153], v[30:31]
    v_pk_mul_f32 v[154:155], v[154:155], v[30:31]
    v_pk_mul_f32 v[160:161], v[160:161], v[30:31]
    v_pk_mul_f32 v[162:163], v[162:163], v[30:31]
    v_cvt_pk_bf16_f32 v24, v152, v153
    v_cvt_pk_bf16_f32 v25, v154, v155
    v_cvt_pk_bf16_f32 v26, v160, v161
    v_cvt_pk_bf16_f32 v27, v162, v163
    ds_write_b128 v18, v[24:27] offset:7168
    s_waitcnt lgkmcnt(1)
    s_waitcnt lgkmcnt(0)
    s_barrier
    ds_read_b128 v[100:103], v19 offset:0
    ds_read_b128 v[104:107], v19 offset:1024
    ds_read_b128 v[108:111], v19 offset:2048
    ds_read_b128 v[112:115], v19 offset:3072
    ds_read_b128 v[116:119], v19 offset:4096
    ds_read_b128 v[120:123], v19 offset:5120
    ds_read_b128 v[124:127], v19 offset:6144
    ds_read_b128 v[128:131], v19 offset:7168
    s_waitcnt lgkmcnt(7)
    v_lshlrev_b32 v132, 16, v100
    v_and_b32 v133, 0xffff0000, v100
    v_lshlrev_b32 v134, 16, v101
    v_and_b32 v135, 0xffff0000, v101
    v_lshlrev_b32 v136, 16, v102
    v_and_b32 v137, 0xffff0000, v102
    v_lshlrev_b32 v138, 16, v103
    v_and_b32 v139, 0xffff0000, v103
    v_pk_fma_f32 v[36:37], v[36:37], v[28:29], v[132:133]
    v_pk_fma_f32 v[38:39], v[38:39], v[28:29], v[134:135]
    v_pk_fma_f32 v[44:45], v[44:45], v[28:29], v[136:137]
    v_pk_fma_f32 v[46:47], v[46:47], v[28:29], v[138:139]
    v_cvt_pk_bf16_f32 v100, v36, v37
    v_cvt_pk_bf16_f32 v101, v38, v39
    v_cvt_pk_bf16_f32 v102, v44, v45
    v_cvt_pk_bf16_f32 v103, v46, v47
    s_waitcnt lgkmcnt(6)
    v_lshlrev_b32 v140, 16, v104
    v_and_b32 v141, 0xffff0000, v104
    v_lshlrev_b32 v142, 16, v105
    v_and_b32 v143, 0xffff0000, v105
    v_lshlrev_b32 v144, 16, v106
    v_and_b32 v145, 0xffff0000, v106
    v_lshlrev_b32 v146, 16, v107
    v_and_b32 v147, 0xffff0000, v107
    v_pk_fma_f32 v[40:41], v[40:41], v[30:31], v[140:141]
    v_pk_fma_f32 v[42:43], v[42:43], v[30:31], v[142:143]
    v_pk_fma_f32 v[48:49], v[48:49], v[30:31], v[144:145]
    v_pk_fma_f32 v[50:51], v[50:51], v[30:31], v[146:147]
    v_cvt_pk_bf16_f32 v104, v40, v41
    v_cvt_pk_bf16_f32 v105, v42, v43
    v_cvt_pk_bf16_f32 v106, v48, v49
    v_cvt_pk_bf16_f32 v107, v50, v51
    s_waitcnt lgkmcnt(5)
    v_lshlrev_b32 v132, 16, v108
    v_and_b32 v133, 0xffff0000, v108
    v_lshlrev_b32 v134, 16, v109
    v_and_b32 v135, 0xffff0000, v109
    v_lshlrev_b32 v136, 16, v110
    v_and_b32 v137, 0xffff0000, v110
    v_lshlrev_b32 v138, 16, v111
    v_and_b32 v139, 0xffff0000, v111
    v_pk_fma_f32 v[52:53], v[52:53], v[28:29], v[132:133]
    v_pk_fma_f32 v[54:55], v[54:55], v[28:29], v[134:135]
    v_pk_fma_f32 v[60:61], v[60:61], v[28:29], v[136:137]
    v_pk_fma_f32 v[62:63], v[62:63], v[28:29], v[138:139]
    v_cvt_pk_bf16_f32 v108, v52, v53
    v_cvt_pk_bf16_f32 v109, v54, v55
    v_cvt_pk_bf16_f32 v110, v60, v61
    v_cvt_pk_bf16_f32 v111, v62, v63
    s_waitcnt lgkmcnt(4)
    v_lshlrev_b32 v140, 16, v112
    v_and_b32 v141, 0xffff0000, v112
    v_lshlrev_b32 v142, 16, v113
    v_and_b32 v143, 0xffff0000, v113
    v_lshlrev_b32 v144, 16, v114
    v_and_b32 v145, 0xffff0000, v114
    v_lshlrev_b32 v146, 16, v115
    v_and_b32 v147, 0xffff0000, v115
    v_pk_fma_f32 v[56:57], v[56:57], v[30:31], v[140:141]
    v_pk_fma_f32 v[58:59], v[58:59], v[30:31], v[142:143]
    v_pk_fma_f32 v[64:65], v[64:65], v[30:31], v[144:145]
    v_pk_fma_f32 v[66:67], v[66:67], v[30:31], v[146:147]
    v_cvt_pk_bf16_f32 v112, v56, v57
    v_cvt_pk_bf16_f32 v113, v58, v59
    v_cvt_pk_bf16_f32 v114, v64, v65
    v_cvt_pk_bf16_f32 v115, v66, v67
    s_waitcnt lgkmcnt(3)
    v_lshlrev_b32 v132, 16, v116
    v_and_b32 v133, 0xffff0000, v116
    v_lshlrev_b32 v134, 16, v117
    v_and_b32 v135, 0xffff0000, v117
    v_lshlrev_b32 v136, 16, v118
    v_and_b32 v137, 0xffff0000, v118
    v_lshlrev_b32 v138, 16, v119
    v_and_b32 v139, 0xffff0000, v119
    v_pk_fma_f32 v[68:69], v[68:69], v[28:29], v[132:133]
    v_pk_fma_f32 v[70:71], v[70:71], v[28:29], v[134:135]
    v_pk_fma_f32 v[76:77], v[76:77], v[28:29], v[136:137]
    v_pk_fma_f32 v[78:79], v[78:79], v[28:29], v[138:139]
    v_cvt_pk_bf16_f32 v116, v68, v69
    v_cvt_pk_bf16_f32 v117, v70, v71
    v_cvt_pk_bf16_f32 v118, v76, v77
    v_cvt_pk_bf16_f32 v119, v78, v79
    s_waitcnt lgkmcnt(2)
    v_lshlrev_b32 v140, 16, v120
    v_and_b32 v141, 0xffff0000, v120
    v_lshlrev_b32 v142, 16, v121
    v_and_b32 v143, 0xffff0000, v121
    v_lshlrev_b32 v144, 16, v122
    v_and_b32 v145, 0xffff0000, v122
    v_lshlrev_b32 v146, 16, v123
    v_and_b32 v147, 0xffff0000, v123
    v_pk_fma_f32 v[72:73], v[72:73], v[30:31], v[140:141]
    v_pk_fma_f32 v[74:75], v[74:75], v[30:31], v[142:143]
    v_pk_fma_f32 v[80:81], v[80:81], v[30:31], v[144:145]
    v_pk_fma_f32 v[82:83], v[82:83], v[30:31], v[146:147]
    v_cvt_pk_bf16_f32 v120, v72, v73
    v_cvt_pk_bf16_f32 v121, v74, v75
    v_cvt_pk_bf16_f32 v122, v80, v81
    v_cvt_pk_bf16_f32 v123, v82, v83
    s_waitcnt lgkmcnt(1)
    v_lshlrev_b32 v132, 16, v124
    v_and_b32 v133, 0xffff0000, v124
    v_lshlrev_b32 v134, 16, v125
    v_and_b32 v135, 0xffff0000, v125
    v_lshlrev_b32 v136, 16, v126
    v_and_b32 v137, 0xffff0000, v126
    v_lshlrev_b32 v138, 16, v127
    v_and_b32 v139, 0xffff0000, v127
    v_pk_fma_f32 v[84:85], v[84:85], v[28:29], v[132:133]
    v_pk_fma_f32 v[86:87], v[86:87], v[28:29], v[134:135]
    v_pk_fma_f32 v[92:93], v[92:93], v[28:29], v[136:137]
    v_pk_fma_f32 v[94:95], v[94:95], v[28:29], v[138:139]
    v_cvt_pk_bf16_f32 v124, v84, v85
    v_cvt_pk_bf16_f32 v125, v86, v87
    v_cvt_pk_bf16_f32 v126, v92, v93
    v_cvt_pk_bf16_f32 v127, v94, v95
    s_waitcnt lgkmcnt(0)
    v_lshlrev_b32 v140, 16, v128
    v_and_b32 v141, 0xffff0000, v128
    v_lshlrev_b32 v142, 16, v129
    v_and_b32 v143, 0xffff0000, v129
    v_lshlrev_b32 v144, 16, v130
    v_and_b32 v145, 0xffff0000, v130
    v_lshlrev_b32 v146, 16, v131
    v_and_b32 v147, 0xffff0000, v131
    v_pk_fma_f32 v[88:89], v[88:89], v[30:31], v[140:141]
    v_pk_fma_f32 v[90:91], v[90:91], v[30:31], v[142:143]
    v_pk_fma_f32 v[96:97], v[96:97], v[30:31], v[144:145]
    v_pk_fma_f32 v[98:99], v[98:99], v[30:31], v[146:147]
    v_cvt_pk_bf16_f32 v128, v88, v89
    v_cvt_pk_bf16_f32 v129, v90, v91
    v_cvt_pk_bf16_f32 v130, v96, v97
    v_cvt_pk_bf16_f32 v131, v98, v99
    v_mov_b32 v159, v131
    v_mov_b32 v158, v130
    v_mov_b32 v157, v129
    v_mov_b32 v156, v128
    v_mov_b32 v155, v127
    v_mov_b32 v154, v126
    v_mov_b32 v153, v125
    v_mov_b32 v152, v124
    v_mov_b32 v151, v123
    v_mov_b32 v150, v122
    v_mov_b32 v149, v121
    v_mov_b32 v148, v120
    v_mov_b32 v147, v119
    v_mov_b32 v146, v118
    v_mov_b32 v145, v117
    v_mov_b32 v144, v116
    v_mov_b32 v143, v115
    v_mov_b32 v142, v114
    v_mov_b32 v141, v113
    v_mov_b32 v140, v112
    v_mov_b32 v139, v111
    v_mov_b32 v138, v110
    v_mov_b32 v137, v109
    v_mov_b32 v136, v108
    v_mov_b32 v135, v107
    v_mov_b32 v134, v106
    v_mov_b32 v133, v105
    v_mov_b32 v132, v104
    v_mov_b32 v131, v103
    v_mov_b32 v130, v102
    v_mov_b32 v129, v101
    v_mov_b32 v128, v100
    s_branch L_mergeD
L_mergeB:
    v_pk_mul_f32 v[36:37], v[36:37], v[28:29]
    v_pk_mul_f32 v[38:39], v[38:39], v[28:29]
    v_pk_mul_f32 v[44:45], v[44:45], v[28:29]
    v_pk_mul_f32 v[46:47], v[46:47], v[28:29]
    v_cvt_pk_bf16_f32 v20, v36, v37
    v_cvt_pk_bf16_f32 v21, v38, v39
    v_cvt_pk_bf16_f32 v22, v44, v45
    v_cvt_pk_bf16_f32 v23, v46, v47
    ds_write_b128 v18, v[20:23] offset:0
    v_pk_mul_f32 v[40:41], v[40:41], v[30:31]
    v_pk_mul_f32 v[42:43], v[42:43], v[30:31]
    v_pk_mul_f32 v[48:49], v[48:49], v[30:31]
    v_pk_mul_f32 v[50:51], v[50:51], v[30:31]
    v_cvt_pk_bf16_f32 v24, v40, v41
    v_cvt_pk_bf16_f32 v25, v42, v43
    v_cvt_pk_bf16_f32 v26, v48, v49
    v_cvt_pk_bf16_f32 v27, v50, v51
    ds_write_b128 v18, v[24:27] offset:1024
    s_waitcnt lgkmcnt(1)
    v_pk_mul_f32 v[52:53], v[52:53], v[28:29]
    v_pk_mul_f32 v[54:55], v[54:55], v[28:29]
    v_pk_mul_f32 v[60:61], v[60:61], v[28:29]
    v_pk_mul_f32 v[62:63], v[62:63], v[28:29]
    v_cvt_pk_bf16_f32 v20, v52, v53
    v_cvt_pk_bf16_f32 v21, v54, v55
    v_cvt_pk_bf16_f32 v22, v60, v61
    v_cvt_pk_bf16_f32 v23, v62, v63
    ds_write_b128 v18, v[20:23] offset:2048
    v_pk_mul_f32 v[56:57], v[56:57], v[30:31]
    v_pk_mul_f32 v[58:59], v[58:59], v[30:31]
    v_pk_mul_f32 v[64:65], v[64:65], v[30:31]
    v_pk_mul_f32 v[66:67], v[66:67], v[30:31]
    v_cvt_pk_bf16_f32 v24, v56, v57
    v_cvt_pk_bf16_f32 v25, v58, v59
    v_cvt_pk_bf16_f32 v26, v64, v65
    v_cvt_pk_bf16_f32 v27, v66, v67
    ds_write_b128 v18, v[24:27] offset:3072
    s_waitcnt lgkmcnt(1)
    v_pk_mul_f32 v[68:69], v[68:69], v[28:29]
    v_pk_mul_f32 v[70:71], v[70:71], v[28:29]
    v_pk_mul_f32 v[76:77], v[76:77], v[28:29]
    v_pk_mul_f32 v[78:79], v[78:79], v[28:29]
    v_cvt_pk_bf16_f32 v20, v68, v69
    v_cvt_pk_bf16_f32 v21, v70, v71
    v_cvt_pk_bf16_f32 v22, v76, v77
    v_cvt_pk_bf16_f32 v23, v78, v79
    ds_write_b128 v18, v[20:23] offset:4096
    v_pk_mul_f32 v[72:73], v[72:73], v[30:31]
    v_pk_mul_f32 v[74:75], v[74:75], v[30:31]
    v_pk_mul_f32 v[80:81], v[80:81], v[30:31]
    v_pk_mul_f32 v[82:83], v[82:83], v[30:31]
    v_cvt_pk_bf16_f32 v24, v72, v73
    v_cvt_pk_bf16_f32 v25, v74, v75
    v_cvt_pk_bf16_f32 v26, v80, v81
    v_cvt_pk_bf16_f32 v27, v82, v83
    ds_write_b128 v18, v[24:27] offset:5120
    s_waitcnt lgkmcnt(1)
    v_pk_mul_f32 v[84:85], v[84:85], v[28:29]
    v_pk_mul_f32 v[86:87], v[86:87], v[28:29]
    v_pk_mul_f32 v[92:93], v[92:93], v[28:29]
    v_pk_mul_f32 v[94:95], v[94:95], v[28:29]
    v_cvt_pk_bf16_f32 v20, v84, v85
    v_cvt_pk_bf16_f32 v21, v86, v87
    v_cvt_pk_bf16_f32 v22, v92, v93
    v_cvt_pk_bf16_f32 v23, v94, v95
    ds_write_b128 v18, v[20:23] offset:6144
    v_pk_mul_f32 v[88:89], v[88:89], v[30:31]
    v_pk_mul_f32 v[90:91], v[90:91], v[30:31]
    v_pk_mul_f32 v[96:97], v[96:97], v[30:31]
    v_pk_mul_f32 v[98:99], v[98:99], v[30:31]
    v_cvt_pk_bf16_f32 v24, v88, v89
    v_cvt_pk_bf16_f32 v25, v90, v91
    v_cvt_pk_bf16_f32 v26, v96, v97
    v_cvt_pk_bf16_f32 v27, v98, v99
    ds_write_b128 v18, v[24:27] offset:7168
    s_waitcnt lgkmcnt(1)
    s_waitcnt lgkmcnt(0)
    s_barrier
    ds_read_b128 v[36:39], v19 offset:0
    ds_read_b128 v[40:43], v19 offset:1024
    ds_read_b128 v[44:47], v19 offset:2048
    ds_read_b128 v[48:51], v19 offset:3072
    ds_read_b128 v[52:55], v19 offset:4096
    ds_read_b128 v[56:59], v19 offset:5120
    ds_read_b128 v[60:63], v19 offset:6144
    ds_read_b128 v[64:67], v19 offset:7168
    s_waitcnt lgkmcnt(7)
    v_lshlrev_b32 v68, 16, v36
    v_and_b32 v69, 0xffff0000, v36
    v_lshlrev_b32 v70, 16, v37
    v_and_b32 v71, 0xffff0000, v37
    v_lshlrev_b32 v72, 16, v38
    v_and_b32 v73, 0xffff0000, v38
    v_lshlrev_b32 v74, 16, v39
    v_and_b32 v75, 0xffff0000, v39
    v_pk_fma_f32 v[100:101], v[100:101], v[28:29], v[68:69]
    v_pk_fma_f32 v[102:103], v[102:103], v[28:29], v[70:71]
    v_pk_fma_f32 v[108:109], v[108:109], v[28:29], v[72:73]
    v_pk_fma_f32 v[110:111], v[110:111], v[28:29], v[74:75]
    v_cvt_pk_bf16_f32 v36, v100, v101
    v_cvt_pk_bf16_f32 v37, v102, v103
    v_cvt_pk_bf16_f32 v38, v108, v109
    v_cvt_pk_bf16_f32 v39, v110, v111
    s_waitcnt lgkmcnt(6)
    v_lshlrev_b32 v76, 16, v40
    v_and_b32 v77, 0xffff0000, v40
    v_lshlrev_b32 v78, 16, v41
    v_and_b32 v79, 0xffff0000, v41
    v_lshlrev_b32 v80, 16, v42
    v_and_b32 v81, 0xffff0000, v42
    v_lshlrev_b32 v82, 16, v43
    v_and_b32 v83, 0xffff0000, v43
    v_pk_fma_f32 v[104:105], v[104:105], v[30:31], v[76:77]
    v_pk_fma_f32 v[106:107], v[106:107], v[30:31], v[78:79]
    v_pk_fma_f32 v[112:113], v[112:113], v[30:31], v[80:81]
    v_pk_fma_f32 v[114:115], v[114:115], v[30:31], v[82:83]
    v_cvt_pk_bf16_f32 v40, v104, v105
    v_cvt_pk_bf16_f32 v41, v106, v107
    v_cvt_pk_bf16_f32 v42, v112, v113
    v_cvt_pk_bf16_f32 v43, v114, v115
    s_waitcnt lgkmcnt(5)
    v_lshlrev_b32 v68, 16, v44
    v_and_b32 v69, 0xffff0000, v44
    v_lshlrev_b32 v70, 16, v45
    v_and_b32 v71, 0xffff0000, v45
    v_lshlrev_b32 v72, 16, v46
    v_and_b32 v73, 0xffff0000, v46
    v_lshlrev_b32 v74, 16, v47
    v_and_b32 v75, 0xffff0000, v47
    v_pk_fma_f32 v[116:117], v[116:117], v[28:29], v[68:69]
    v_pk_fma_f32 v[118:119], v[118:119], v[28:29], v[70:71]
    v_pk_fma_f32 v[124:125], v[124:125], v[28:29], v[72:73]
    v_pk_fma_f32 v[126:127], v[126:127], v[28:29], v[74:75]
    v_cvt_pk_bf16_f32 v44, v116, v117
    v_cvt_pk_bf16_f32 v45, v118, v119
    v_cvt_pk_bf16_f32 v46, v124, v125
    v_cvt_pk_bf16_f32 v47, v126, v127
    s_waitcnt lgkmcnt(4)
    v_lshlrev_b32 v76, 16, v48
    v_and_b32 v77, 0xffff0000, v48
    v_lshlrev_b32 v78, 16, v49
    v_and_b32 v79, 0xffff0000, v49
    v_lshlrev_b32 v80, 16, v50
    v_and_b32 v81, 0xffff0000, v50
    v_lshlrev_b32 v82, 16, v51
    v_and_b32 v83, 0xffff0000, v51
    v_pk_fma_f32 v[120:121], v[120:121], v[30:31], v[76:77]
    v_pk_fma_f32 v[122:123], v[122:123], v[30:31], v[78:79]
    v_pk_fma_f32 v[128:129], v[128:129], v[30:31], v[80:81]
    v_pk_fma_f32 v[130:131], v[130:131], v[30:31], v[82:83]
    v_cvt_pk_bf16_f32 v48, v120, v121
    v_cvt_pk_bf16_f32 v49, v122, v123
    v_cvt_pk_bf16_f32 v50, v128, v129
    v_cvt_pk_bf16_f32 v51, v130, v131
    s_waitcnt lgkmcnt(3)
    v_lshlrev_b32 v68, 16, v52
    v_and_b32 v69, 0xffff0000, v52
    v_lshlrev_b32 v70, 16, v53
    v_and_b32 v71, 0xffff0000, v53
    v_lshlrev_b32 v72, 16, v54
    v_and_b32 v73, 0xffff0000, v54
    v_lshlrev_b32 v74, 16, v55
    v_and_b32 v75, 0xffff0000, v55
    v_pk_fma_f32 v[132:133], v[132:133], v[28:29], v[68:69]
    v_pk_fma_f32 v[134:135], v[134:135], v[28:29], v[70:71]
    v_pk_fma_f32 v[140:141], v[140:141], v[28:29], v[72:73]
    v_pk_fma_f32 v[142:143], v[142:143], v[28:29], v[74:75]
    v_cvt_pk_bf16_f32 v52, v132, v133
    v_cvt_pk_bf16_f32 v53, v134, v135
    v_cvt_pk_bf16_f32 v54, v140, v141
    v_cvt_pk_bf16_f32 v55, v142, v143
    s_waitcnt lgkmcnt(2)
    v_lshlrev_b32 v76, 16, v56
    v_and_b32 v77, 0xffff0000, v56
    v_lshlrev_b32 v78, 16, v57
    v_and_b32 v79, 0xffff0000, v57
    v_lshlrev_b32 v80, 16, v58
    v_and_b32 v81, 0xffff0000, v58
    v_lshlrev_b32 v82, 16, v59
    v_and_b32 v83, 0xffff0000, v59
    v_pk_fma_f32 v[136:137], v[136:137], v[30:31], v[76:77]
    v_pk_fma_f32 v[138:139], v[138:139], v[30:31], v[78:79]
    v_pk_fma_f32 v[144:145], v[144:145], v[30:31], v[80:81]
    v_pk_fma_f32 v[146:147], v[146:147], v[30:31], v[82:83]
    v_cvt_pk_bf16_f32 v56, v136, v137
    v_cvt_pk_bf16_f32 v57, v138, v139
    v_cvt_pk_bf16_f32 v58, v144, v145
    v_cvt_pk_bf16_f32 v59, v146, v147
    s_waitcnt lgkmcnt(1)
    v_lshlrev_b32 v68, 16, v60
    v_and_b32 v69, 0xffff0000, v60
    v_lshlrev_b32 v70, 16, v61
    v_and_b32 v71, 0xffff0000, v61
    v_lshlrev_b32 v72, 16, v62
    v_and_b32 v73, 0xffff0000, v62
    v_lshlrev_b32 v74, 16, v63
    v_and_b32 v75, 0xffff0000, v63
    v_pk_fma_f32 v[148:149], v[148:149], v[28:29], v[68:69]
    v_pk_fma_f32 v[150:151], v[150:151], v[28:29], v[70:71]
    v_pk_fma_f32 v[156:157], v[156:157], v[28:29], v[72:73]
    v_pk_fma_f32 v[158:159], v[158:159], v[28:29], v[74:75]
    v_cvt_pk_bf16_f32 v60, v148, v149
    v_cvt_pk_bf16_f32 v61, v150, v151
    v_cvt_pk_bf16_f32 v62, v156, v157
    v_cvt_pk_bf16_f32 v63, v158, v159
    s_waitcnt lgkmcnt(0)
    v_lshlrev_b32 v76, 16, v64
    v_and_b32 v77, 0xffff0000, v64
    v_lshlrev_b32 v78, 16, v65
    v_and_b32 v79, 0xffff0000, v65
    v_lshlrev_b32 v80, 16, v66
    v_and_b32 v81, 0xffff0000, v66
    v_lshlrev_b32 v82, 16, v67
    v_and_b32 v83, 0xffff0000, v67
    v_pk_fma_f32 v[152:153], v[152:153], v[30:31], v[76:77]
    v_pk_fma_f32 v[154:155], v[154:155], v[30:31], v[78:79]
    v_pk_fma_f32 v[160:161], v[160:161], v[30:31], v[80:81]
    v_pk_fma_f32 v[162:163], v[162:163], v[30:31], v[82:83]
    v_cvt_pk_bf16_f32 v64, v152, v153
    v_cvt_pk_bf16_f32 v65, v154, v155
    v_cvt_pk_bf16_f32 v66, v160, v161
    v_cvt_pk_bf16_f32 v67, v162, v163
    v_mov_b32 v159, v67
    v_mov_b32 v158, v66
    v_mov_b32 v157, v65
    v_mov_b32 v156, v64
    v_mov_b32 v155, v63
    v_mov_b32 v154, v62
    v_mov_b32 v153, v61
    v_mov_b32 v152, v60
    v_mov_b32 v151, v59
    v_mov_b32 v150, v58
    v_mov_b32 v149, v57
    v_mov_b32 v148, v56
    v_mov_b32 v147, v55
    v_mov_b32 v146, v54
    v_mov_b32 v145, v53
    v_mov_b32 v144, v52
    v_mov_b32 v143, v51
    v_mov_b32 v142, v50
    v_mov_b32 v141, v49
    v_mov_b32 v140, v48
    v_mov_b32 v139, v47
    v_mov_b32 v138, v46
    v_mov_b32 v137, v45
    v_mov_b32 v136, v44
    v_mov_b32 v135, v43
    v_mov_b32 v134, v42
    v_mov_b32 v133, v41
    v_mov_b32 v132, v40
    v_mov_b32 v131, v39
    v_mov_b32 v130, v38
    v_mov_b32 v129, v37
    v_mov_b32 v128, v36
L_mergeD:
    s_barrier
    v_mov_b32 v1, v14
    v_and_b32 v2, 15, v1
    v_lshrrev_b32 v3, 4, v1
    v_bfe_u32 v5, v1, 2, 2
    v_lshl_add_u32 v5, v3, 2, v5
    v_mul_u32_u24 v5, 1056, v5
    v_and_b32 v6, 3, v1
    v_lshlrev_b32 v6, 3, v6
    v_add_u32 v4, v5, v6
    v_lshlrev_b32 v9, 4, v1
    v_cmp_gt_u32 vcc, 56, v1
    v_mov_b32 v6, 0x7fffffff
    s_nop 0
    v_cndmask_b32 v0, v6, v9, vcc
    s_and_b32 s54, s43, 1
    s_lshl_b32 s55, s44, 12
    s_lshl_b32 s56, s54, 14
    s_add_u32 s56, s56, s55
    s_add_u32 s56, s56, 101376
    s_mul_i32 s57, s54, 14336
    s_add_u32 s57, s57, s55
    s_add_u32 s57, s57, 134144
    v_add_u32 v20, s56, v9
    v_add_u32 v21, s57, v9
    s_cmp_lt_u32 s43, 2
    s_cbranch_scc0 L_of0b
    ds_write_b128 v20, v[128:131] offset:0
    ds_write_b128 v20, v[132:135] offset:8192
    ds_write_b128 v20, v[136:139] offset:1024
    ds_write_b128 v20, v[140:143] offset:9216
    ds_write_b128 v20, v[144:147] offset:2048
    ds_write_b128 v20, v[148:151] offset:10240
    ds_write_b128 v20, v[152:155] offset:3072
    ds_write_b128 v20, v[156:159] offset:11264
    s_branch L_of0
L_of0b:
    ds_write_b128 v21, v[128:131] offset:0
    ds_write_b128 v21, v[132:135] offset:7168
    ds_write_b128 v21, v[136:139] offset:1024
    ds_write_b128 v21, v[140:143] offset:8192
    ds_write_b128 v21, v[144:147] offset:2048
    ds_write_b128 v21, v[148:151] offset:9216
    s_cmp_eq_u32 s44, 0
    s_cbranch_scc0 L_of1x
    ds_write_b128 v21, v[152:155] offset:3072
    ds_write_b128 v21, v[156:159] offset:10240
L_of1x:
L_of0:
    s_add_u32 s60, s63, 71680
    s_add_u32 m0, s65, 84480
    s_nop 0
    buffer_load_dwordx4 v0, s[28:31], s60 offen lds
    s_add_u32 s60, s60, 896
    s_add_u32 m0, m0, 1056
    s_nop 0
    buffer_load_dwordx4 v0, s[28:31], s60 offen lds
    s_lshr_b32 s54, s71, 6
    v_add_u32 v18, s54, v4
    v_add_u32 v15, 101376, v9
    s_cmp_lt_u32 s40, 4
    s_cbranch_scc0 L_opB
    v_add_u32 v11, 33792, v18
    v_add_u32 v12, 50688, v18
    ds_read_b64_tr_b16 a[0:1], v11 offset:0
    ds_read_b64_tr_b16 a[2:3], v12 offset:0
    ds_read_b64_tr_b16 a[4:5], v11 offset:32
    ds_read_b64_tr_b16 a[6:7], v12 offset:32
    ds_read_b64_tr_b16 a[8:9], v11 offset:64
    ds_read_b64_tr_b16 a[10:11], v12 offset:64
    ds_read_b64_tr_b16 a[12:13], v11 offset:96
    ds_read_b64_tr_b16 a[14:15], v12 offset:96
    s_waitcnt lgkmcnt(0)
    s_barrier
    ds_read_b128 a[32:35], v15 offset:0
    ds_read_b128 a[36:39], v15 offset:8192
    ds_read_b128 a[40:43], v15 offset:16384
    ds_read_b128 a[44:47], v15 offset:24576
    s_waitcnt lgkmcnt(0)
    v_mfma_f32_16x16x32_bf16 v[36:39], a[0:3], a[32:35], 0
    v_add_u32 v11, 0, v18
    v_add_u32 v12, 16896, v18
    v_mfma_f32_16x16x32_bf16 v[40:43], a[0:3], a[36:39], 0
    ds_read_b128 a[48:51], v15 offset:1024
    ds_read_b128 a[52:55], v15 offset:9216
    s_add_u32 s60, s63, 86016
    s_add_u32 m0, s65, 33792
    s_nop 0
    buffer_load_dwordx4 v0, s[28:31], s60 offen lds
    v_mfma_f32_16x16x32_bf16 v[44:47], a[0:3], a[40:43], 0
    ds_read_b128 a[56:59], v15 offset:17408
    v_mfma_f32_16x16x32_bf16 v[48:51], a[0:3], a[44:47], 0
    ds_read_b128 a[60:63], v15 offset:25600
    ds_read_b64_tr_b16 a[16:17], v11 offset:0
    v_mfma_f32_16x16x32_bf16 v[52:55], a[4:7], a[32:35], 0
    ds_read_b64_tr_b16 a[18:19], v12 offset:0
    s_add_u32 s60, s60, 896
    s_add_u32 m0, m0, 1056
    s_nop 0
    buffer_load_dwordx4 v0, s[28:31], s60 offen lds
    v_mfma_f32_16x16x32_bf16 v[56:59], a[4:7], a[36:39], 0
    ds_read_b64_tr_b16 a[20:21], v11 offset:32
    ds_read_b64_tr_b16 a[22:23], v12 offset:32
    v_mfma_f32_16x16x32_bf16 v[60:63], a[4:7], a[40:43], 0
    ds_read_b64_tr_b16 a[24:25], v11 offset:64
    v_mfma_f32_16x16x32_bf16 v[64:67], a[4:7], a[44:47], 0
    ds_read_b64_tr_b16 a[26:27], v12 offset:64
    ds_read_b64_tr_b16 a[28:29], v11 offset:96
    s_add_u32 s60, s63, 100352
    s_add_u32 m0, s65, 50688
    s_nop 0
    buffer_load_dwordx4 v0, s[28:31], s60 offen lds
    v_mfma_f32_16x16x32_bf16 v[68:71], a[8:11], a[32:35], 0
    ds_read_b64_tr_b16 a[30:31], v12 offset:96
    v_mfma_f32_16x16x32_bf16 v[72:75], a[8:11], a[36:39], 0
    v_mfma_f32_16x16x32_bf16 v[76:79], a[8:11], a[40:43], 0
    v_mfma_f32_16x16x32_bf16 v[80:83], a[8:11], a[44:47], 0
    s_add_u32 s60, s60, 896
    s_add_u32 m0, m0, 1056
    s_nop 0
    buffer_load_dwordx4 v0, s[28:31], s60 offen lds
    v_mfma_f32_16x16x32_bf16 v[84:87], a[12:15], a[32:35], 0
    v_mfma_f32_16x16x32_bf16 v[88:91], a[12:15], a[36:39], 0
    s_waitcnt vmcnt(4)
    s_waitcnt lgkmcnt(0)
    s_barrier
    v_mfma_f32_16x16x32_bf16 v[92:95], a[12:15], a[40:43], 0
    v_mfma_f32_16x16x32_bf16 v[96:99], a[12:15], a[44:47], 0
    v_mfma_f32_16x16x32_bf16 v[36:39], a[16:19], a[48:51], v[36:39]
    v_add_u32 v11, 67584, v18
    v_add_u32 v12, 84480, v18
    v_mfma_f32_16x16x32_bf16 v[40:43], a[16:19], a[52:55], v[40:43]
    ds_read_b128 a[32:35], v15 offset:2048
    ds_read_b128 a[36:39], v15 offset:10240
    s_add_u32 s60, s63, 114688
    s_add_u32 m0, s65, 0
    s_nop 0
    buffer_load_dwordx4 v0, s[28:31], s60 offen lds
    v_mfma_f32_16x16x32_bf16 v[44:47], a[16:19], a[56:59], v[44:47]
    ds_read_b128 a[40:43], v15 offset:18432
    v_mfma_f32_16x16x32_bf16 v[48:51], a[16:19], a[60:63], v[48:51]
    ds_read_b128 a[44:47], v15 offset:26624
    ds_read_b64_tr_b16 a[0:1], v11 offset:0
    v_mfma_f32_16x16x32_bf16 v[52:55], a[20:23], a[48:51], v[52:55]
    ds_read_b64_tr_b16 a[2:3], v12 offset:0
    s_add_u32 s60, s60, 896
    s_add_u32 m0, m0, 1056
    s_nop 0
    buffer_load_dwordx4 v0, s[28:31], s60 offen lds
    v_mfma_f32_16x16x32_bf16 v[56:59], a[20:23], a[52:55], v[56:59]
    ds_read_b64_tr_b16 a[4:5], v11 offset:32
    ds_read_b64_tr_b16 a[6:7], v12 offset:32
    v_mfma_f32_16x16x32_bf16 v[60:63], a[20:23], a[56:59], v[60:63]
    ds_read_b64_tr_b16 a[8:9], v11 offset:64
    v_mfma_f32_16x16x32_bf16 v[64:67], a[20:23], a[60:63], v[64:67]
    ds_read_b64_tr_b16 a[10:11], v12 offset:64
    ds_read_b64_tr_b16 a[12:13], v11 offset:96
    s_add_u32 s60, s63, 129024
    s_add_u32 m0, s65, 16896
    s_nop 0
    buffer_load_dwordx4 v0, s[28:31], s60 offen lds
    v_mfma_f32_16x16x32_bf16 v[68:71], a[24:27], a[48:51], v[68:71]
    ds_read_b64_tr_b16 a[14:15], v12 offset:96
    v_mfma_f32_16x16x32_bf16 v[72:75], a[24:27], a[52:55], v[72:75]
    v_mfma_f32_16x16x32_bf16 v[76:79], a[24:27], a[56:59], v[76:79]
    v_mfma_f32_16x16x32_bf16 v[80:83], a[24:27], a[60:63], v[80:83]
    s_add_u32 s60, s60, 896
    s_add_u32 m0, m0, 1056
    s_nop 0
    buffer_load_dwordx4 v0, s[28:31], s60 offen lds
    v_mfma_f32_16x16x32_bf16 v[84:87], a[28:31], a[48:51], v[84:87]
    v_mfma_f32_16x16x32_bf16 v[88:91], a[28:31], a[52:55], v[88:91]
    s_waitcnt vmcnt(4)
    s_waitcnt lgkmcnt(0)
    s_barrier
    v_mfma_f32_16x16x32_bf16 v[92:95], a[28:31], a[56:59], v[92:95]
    v_mfma_f32_16x16x32_bf16 v[96:99], a[28:31], a[60:63], v[96:99]
    v_mfma_f32_16x16x32_bf16 v[36:39], a[0:3], a[32:35], v[36:39]
    v_add_u32 v11, 33792, v18
    v_add_u32 v12, 50688, v18
    v_mfma_f32_16x16x32_bf16 v[40:43], a[0:3], a[36:39], v[40:43]
    ds_read_b128 a[48:51], v15 offset:3072
    ds_read_b128 a[52:55], v15 offset:11264
    s_add_u32 s60, s63, 143360
    s_add_u32 m0, s65, 67584
    s_nop 0
    buffer_load_dwordx4 v0, s[28:31], s60 offen lds
    v_mfma_f32_16x16x32_bf16 v[44:47], a[0:3], a[40:43], v[44:47]
    ds_read_b128 a[56:59], v15 offset:19456
    v_mfma_f32_16x16x32_bf16 v[48:51], a[0:3], a[44:47], v[48:51]
    ds_read_b128 a[60:63], v15 offset:27648
    ds_read_b64_tr_b16 a[16:17], v11 offset:0
    v_mfma_f32_16x16x32_bf16 v[52:55], a[4:7], a[32:35], v[52:55]
    ds_read_b64_tr_b16 a[18:19], v12 offset:0
    s_add_u32 s60, s60, 896
    s_add_u32 m0, m0, 1056
    s_nop 0
    buffer_load_dwordx4 v0, s[28:31], s60 offen lds
    v_mfma_f32_16x16x32_bf16 v[56:59], a[4:7], a[36:39], v[56:59]
    ds_read_b64_tr_b16 a[20:21], v11 offset:32
    ds_read_b64_tr_b16 a[22:23], v12 offset:32
    v_mfma_f32_16x16x32_bf16 v[60:63], a[4:7], a[40:43], v[60:63]
    ds_read_b64_tr_b16 a[24:25], v11 offset:64
    v_mfma_f32_16x16x32_bf16 v[64:67], a[4:7], a[44:47], v[64:67]
    ds_read_b64_tr_b16 a[26:27], v12 offset:64
    ds_read_b64_tr_b16 a[28:29], v11 offset:96
    s_add_u32 s60, s63, 157696
    s_add_u32 m0, s65, 84480
    s_nop 0
    buffer_load_dwordx4 v0, s[28:31], s60 offen lds
    v_mfma_f32_16x16x32_bf16 v[68:71], a[8:11], a[32:35], v[68:71]
    ds_read_b64_tr_b16 a[30:31], v12 offset:96
    v_mfma_f32_16x16x32_bf16 v[72:75], a[8:11], a[36:39], v[72:75]
    v_mfma_f32_16x16x32_bf16 v[76:79], a[8:11], a[40:43], v[76:79]
    v_mfma_f32_16x16x32_bf16 v[80:83], a[8:11], a[44:47], v[80:83]
    s_add_u32 s60, s60, 896
    s_add_u32 m0, m0, 1056
    s_nop 0
    buffer_load_dwordx4 v0, s[28:31], s60 offen lds
    v_mfma_f32_16x16x32_bf16 v[84:87], a[12:15], a[32:35], v[84:87]
    v_mfma_f32_16x16x32_bf16 v[88:91], a[12:15], a[36:39], v[88:91]
    s_waitcnt vmcnt(4)
    s_waitcnt lgkmcnt(0)
    s_barrier
    v_mfma_f32_16x16x32_bf16 v[92:95], a[12:15], a[40:43], v[92:95]
    v_mfma_f32_16x16x32_bf16 v[96:99], a[12:15], a[44:47], v[96:99]
    v_mfma_f32_16x16x32_bf16 v[36:39], a[16:19], a[48:51], v[36:39]
    v_add_u32 v11, 0, v18
    v_add_u32 v12, 16896, v18
    v_mfma_f32_16x16x32_bf16 v[40:43], a[16:19], a[52:55], v[40:43]
    ds_read_b128 a[32:35], v15 offset:4096
    ds_read_b128 a[36:39], v15 offset:12288
    s_add_u32 s60, s63, 172032
    s_add_u32 m0, s65, 33792
    s_nop 0
    buffer_load_dwordx4 v0, s[28:31], s60 offen lds
    v_mfma_f32_16x16x32_bf16 v[44:47], a[16:19], a[56:59], v[44:47]
    ds_read_b128 a[40:43], v15 offset:20480
    v_mfma_f32_16x16x32_bf16 v[48:51], a[16:19], a[60:63], v[48:51]
    ds_read_b128 a[44:47], v15 offset:28672
    ds_read_b64_tr_b16 a[0:1], v11 offset:0
    v_mfma_f32_16x16x32_bf16 v[52:55], a[20:23], a[48:51], v[52:55]
    ds_read_b64_tr_b16 a[2:3], v12 offset:0
    s_add_u32 s60, s60, 896
    s_add_u32 m0, m0, 1056
    s_nop 0
    buffer_load_dwordx4 v0, s[28:31], s60 offen lds
    v_mfma_f32_16x16x32_bf16 v[56:59], a[20:23], a[52:55], v[56:59]
    ds_read_b64_tr_b16 a[4:5], v11 offset:32
    ds_read_b64_tr_b16 a[6:7], v12 offset:32
    v_mfma_f32_16x16x32_bf16 v[60:63], a[20:23], a[56:59], v[60:63]
    ds_read_b64_tr_b16 a[8:9], v11 offset:64
    v_mfma_f32_16x16x32_bf16 v[64:67], a[20:23], a[60:63], v[64:67]
    ds_read_b64_tr_b16 a[10:11], v12 offset:64
    ds_read_b64_tr_b16 a[12:13], v11 offset:96
    s_add_u32 s60, s63, 186368
    s_add_u32 m0, s65, 50688
    s_nop 0
    buffer_load_dwordx4 v0, s[28:31], s60 offen lds
    v_mfma_f32_16x16x32_bf16 v[68:71], a[24:27], a[48:51], v[68:71]
    ds_read_b64_tr_b16 a[14:15], v12 offset:96
    v_mfma_f32_16x16x32_bf16 v[72:75], a[24:27], a[52:55], v[72:75]
    v_mfma_f32_16x16x32_bf16 v[76:79], a[24:27], a[56:59], v[76:79]
    v_mfma_f32_16x16x32_bf16 v[80:83], a[24:27], a[60:63], v[80:83]
    s_add_u32 s60, s60, 896
    s_add_u32 m0, m0, 1056
    s_nop 0
    buffer_load_dwordx4 v0, s[28:31], s60 offen lds
    v_mfma_f32_16x16x32_bf16 v[84:87], a[28:31], a[48:51], v[84:87]
    v_mfma_f32_16x16x32_bf16 v[88:91], a[28:31], a[52:55], v[88:91]
    s_waitcnt vmcnt(4)
    s_waitcnt lgkmcnt(0)
    s_barrier
    v_mfma_f32_16x16x32_bf16 v[92:95], a[28:31], a[56:59], v[92:95]
    v_mfma_f32_16x16x32_bf16 v[96:99], a[28:31], a[60:63], v[96:99]
    v_mfma_f32_16x16x32_bf16 v[36:39], a[0:3], a[32:35], v[36:39]
    v_add_u32 v11, 67584, v18
    v_add_u32 v12, 84480, v18
    v_mfma_f32_16x16x32_bf16 v[40:43], a[0:3], a[36:39], v[40:43]
    ds_read_b128 a[48:51], v15 offset:5120
    ds_read_b128 a[52:55], v15 offset:13312
    s_add_u32 s60, s63, 200704
    s_add_u32 m0, s65, 0
    s_nop 0
    buffer_load_dwordx4 v0, s[28:31], s60 offen lds
    v_mfma_f32_16x16x32_bf16 v[44:47], a[0:3], a[40:43], v[44:47]
    ds_read_b128 a[56:59], v15 offset:21504
    v_mfma_f32_16x16x32_bf16 v[48:51], a[0:3], a[44:47], v[48:51]
    ds_read_b128 a[60:63], v15 offset:29696
    ds_read_b64_tr_b16 a[16:17], v11 offset:0
    v_mfma_f32_16x16x32_bf16 v[52:55], a[4:7], a[32:35], v[52:55]
    ds_read_b64_tr_b16 a[18:19], v12 offset:0
    s_add_u32 s60, s60, 896
    s_add_u32 m0, m0, 1056
    s_nop 0
    buffer_load_dwordx4 v0, s[28:31], s60 offen lds
    v_mfma_f32_16x16x32_bf16 v[56:59], a[4:7], a[36:39], v[56:59]
    ds_read_b64_tr_b16 a[20:21], v11 offset:32
    ds_read_b64_tr_b16 a[22:23], v12 offset:32
    v_mfma_f32_16x16x32_bf16 v[60:63], a[4:7], a[40:43], v[60:63]
    ds_read_b64_tr_b16 a[24:25], v11 offset:64
    v_mfma_f32_16x16x32_bf16 v[64:67], a[4:7], a[44:47], v[64:67]
    ds_read_b64_tr_b16 a[26:27], v12 offset:64
    ds_read_b64_tr_b16 a[28:29], v11 offset:96
    s_add_u32 s60, s63, 215040
    s_add_u32 m0, s65, 16896
    s_nop 0
    buffer_load_dwordx4 v0, s[28:31], s60 offen lds
    v_mfma_f32_16x16x32_bf16 v[68:71], a[8:11], a[32:35], v[68:71]
    ds_read_b64_tr_b16 a[30:31], v12 offset:96
    v_mfma_f32_16x16x32_bf16 v[72:75], a[8:11], a[36:39], v[72:75]
    v_mfma_f32_16x16x32_bf16 v[76:79], a[8:11], a[40:43], v[76:79]
    v_mfma_f32_16x16x32_bf16 v[80:83], a[8:11], a[44:47], v[80:83]
    s_add_u32 s60, s60, 896
    s_add_u32 m0, m0, 1056
    s_nop 0
    buffer_load_dwordx4 v0, s[28:31], s60 offen lds
    v_mfma_f32_16x16x32_bf16 v[84:87], a[12:15], a[32:35], v[84:87]
    v_mfma_f32_16x16x32_bf16 v[88:91], a[12:15], a[36:39], v[88:91]
    s_waitcnt vmcnt(4)
    s_waitcnt lgkmcnt(0)
    s_barrier
    v_mfma_f32_16x16x32_bf16 v[92:95], a[12:15], a[40:43], v[92:95]
    v_mfma_f32_16x16x32_bf16 v[96:99], a[12:15], a[44:47], v[96:99]
    v_mfma_f32_16x16x32_bf16 v[36:39], a[16:19], a[48:51], v[36:39]
    v_add_u32 v11, 33792, v18
    v_add_u32 v12, 50688, v18
    v_mfma_f32_16x16x32_bf16 v[40:43], a[16:19], a[52:55], v[40:43]
    ds_read_b128 a[32:35], v15 offset:6144
    ds_read_b128 a[36:39], v15 offset:14336
    s_add_u32 s60, s63, 229376
    s_add_u32 m0, s65, 67584
    s_nop 0
    buffer_load_dwordx4 v0, s[28:31], s60 offen lds
    v_mfma_f32_16x16x32_bf16 v[44:47], a[16:19], a[56:59], v[44:47]
    ds_read_b128 a[40:43], v15 offset:22528
    v_mfma_f32_16x16x32_bf16 v[48:51], a[16:19], a[60:63], v[48:51]
    ds_read_b128 a[44:47], v15 offset:30720
    ds_read_b64_tr_b16 a[0:1], v11 offset:0
    v_mfma_f32_16x16x32_bf16 v[52:55], a[20:23], a[48:51], v[52:55]
    ds_read_b64_tr_b16 a[2:3], v12 offset:0
    s_add_u32 s60, s60, 896
    s_add_u32 m0, m0, 1056
    s_nop 0
    buffer_load_dwordx4 v0, s[28:31], s60 offen lds
    v_mfma_f32_16x16x32_bf16 v[56:59], a[20:23], a[52:55], v[56:59]
    ds_read_b64_tr_b16 a[4:5], v11 offset:32
    ds_read_b64_tr_b16 a[6:7], v12 offset:32
    v_mfma_f32_16x16x32_bf16 v[60:63], a[20:23], a[56:59], v[60:63]
    ds_read_b64_tr_b16 a[8:9], v11 offset:64
    v_mfma_f32_16x16x32_bf16 v[64:67], a[20:23], a[60:63], v[64:67]
    ds_read_b64_tr_b16 a[10:11], v12 offset:64
    ds_read_b64_tr_b16 a[12:13], v11 offset:96
    s_add_u32 s60, s63, 243712
    s_add_u32 m0, s65, 84480
    s_nop 0
    buffer_load_dwordx4 v0, s[28:31], s60 offen lds
    v_mfma_f32_16x16x32_bf16 v[68:71], a[24:27], a[48:51], v[68:71]
    ds_read_b64_tr_b16 a[14:15], v12 offset:96
    v_mfma_f32_16x16x32_bf16 v[72:75], a[24:27], a[52:55], v[72:75]
    v_mfma_f32_16x16x32_bf16 v[76:79], a[24:27], a[56:59], v[76:79]
    v_mfma_f32_16x16x32_bf16 v[80:83], a[24:27], a[60:63], v[80:83]
    s_add_u32 s60, s60, 896
    s_add_u32 m0, m0, 1056
    s_nop 0
    buffer_load_dwordx4 v0, s[28:31], s60 offen lds
    v_mfma_f32_16x16x32_bf16 v[84:87], a[28:31], a[48:51], v[84:87]
    v_mfma_f32_16x16x32_bf16 v[88:91], a[28:31], a[52:55], v[88:91]
    s_waitcnt vmcnt(4)
    s_waitcnt lgkmcnt(0)
    s_barrier
    v_mfma_f32_16x16x32_bf16 v[92:95], a[28:31], a[56:59], v[92:95]
    v_mfma_f32_16x16x32_bf16 v[96:99], a[28:31], a[60:63], v[96:99]
    v_mfma_f32_16x16x32_bf16 v[36:39], a[0:3], a[32:35], v[36:39]
    v_add_u32 v11, 0, v18
    v_add_u32 v12, 16896, v18
    v_mfma_f32_16x16x32_bf16 v[40:43], a[0:3], a[36:39], v[40:43]
    ds_read_b128 a[48:51], v15 offset:7168
    ds_read_b128 a[52:55], v15 offset:15360
    s_add_u32 s60, s63, 258048
    s_add_u32 m0, s65, 33792
    s_nop 0
    buffer_load_dwordx4 v0, s[28:31], s60 offen lds
    v_mfma_f32_16x16x32_bf16 v[44:47], a[0:3], a[40:43], v[44:47]
    ds_read_b128 a[56:59], v15 offset:23552
    v_mfma_f32_16x16x32_bf16 v[48:51], a[0:3], a[44:47], v[48:51]
    ds_read_b128 a[60:63], v15 offset:31744
    ds_read_b64_tr_b16 a[16:17], v11 offset:0
    v_mfma_f32_16x16x32_bf16 v[52:55], a[4:7], a[32:35], v[52:55]
    ds_read_b64_tr_b16 a[18:19], v12 offset:0
    s_add_u32 s60, s60, 896
    s_add_u32 m0, m0, 1056
    s_nop 0
    buffer_load_dwordx4 v0, s[28:31], s60 offen lds
    v_mfma_f32_16x16x32_bf16 v[56:59], a[4:7], a[36:39], v[56:59]
    ds_read_b64_tr_b16 a[20:21], v11 offset:32
    ds_read_b64_tr_b16 a[22:23], v12 offset:32
    v_mfma_f32_16x16x32_bf16 v[60:63], a[4:7], a[40:43], v[60:63]
    ds_read_b64_tr_b16 a[24:25], v11 offset:64
    v_mfma_f32_16x16x32_bf16 v[64:67], a[4:7], a[44:47], v[64:67]
    ds_read_b64_tr_b16 a[26:27], v12 offset:64
    ds_read_b64_tr_b16 a[28:29], v11 offset:96
    s_add_u32 s60, s63, 272384
    s_add_u32 m0, s65, 50688
    s_nop 0
    buffer_load_dwordx4 v0, s[28:31], s60 offen lds
    v_mfma_f32_16x16x32_bf16 v[68:71], a[8:11], a[32:35], v[68:71]
    ds_read_b64_tr_b16 a[30:31], v12 offset:96
    v_mfma_f32_16x16x32_bf16 v[72:75], a[8:11], a[36:39], v[72:75]
    v_mfma_f32_16x16x32_bf16 v[76:79], a[8:11], a[40:43], v[76:79]
    v_mfma_f32_16x16x32_bf16 v[80:83], a[8:11], a[44:47], v[80:83]
    s_add_u32 s60, s60, 896
    s_add_u32 m0, m0, 1056
    s_nop 0
    buffer_load_dwordx4 v0, s[28:31], s60 offen lds
    v_mfma_f32_16x16x32_bf16 v[84:87], a[12:15], a[32:35], v[84:87]
    v_mfma_f32_16x16x32_bf16 v[88:91], a[12:15], a[36:39], v[88:91]
    s_waitcnt vmcnt(4)
    s_waitcnt lgkmcnt(0)
    s_barrier
    v_mfma_f32_16x16x32_bf16 v[92:95], a[12:15], a[40:43], v[92:95]
    v_mfma_f32_16x16x32_bf16 v[96:99], a[12:15], a[44:47], v[96:99]
    v_mfma_f32_16x16x32_bf16 v[36:39], a[16:19], a[48:51], v[36:39]
    v_add_u32 v11, 67584, v18
    v_add_u32 v12, 84480, v18
    v_mfma_f32_16x16x32_bf16 v[40:43], a[16:19], a[52:55], v[40:43]
    ds_read_b128 a[32:35], v15 offset:32768
    ds_read_b128 a[36:39], v15 offset:39936
    s_add_u32 s60, s63, 286720
    s_add_u32 m0, s65, 0
    s_nop 0
    buffer_load_dwordx4 v0, s[28:31], s60 offen lds
    v_mfma_f32_16x16x32_bf16 v[44:47], a[16:19], a[56:59], v[44:47]
    ds_read_b128 a[40:43], v15 offset:47104
    v_mfma_f32_16x16x32_bf16 v[48:51], a[16:19], a[60:63], v[48:51]
    ds_read_b128 a[44:47], v15 offset:54272
    ds_read_b64_tr_b16 a[0:1], v11 offset:0
    v_mfma_f32_16x16x32_bf16 v[52:55], a[20:23], a[48:51], v[52:55]
    ds_read_b64_tr_b16 a[2:3], v12 offset:0
    s_add_u32 s60, s60, 896
    s_add_u32 m0, m0, 1056
    s_nop 0
    buffer_load_dwordx4 v0, s[28:31], s60 offen lds
    v_mfma_f32_16x16x32_bf16 v[56:59], a[20:23], a[52:55], v[56:59]
    ds_read_b64_tr_b16 a[4:5], v11 offset:32
    ds_read_b64_tr_b16 a[6:7], v12 offset:32
    v_mfma_f32_16x16x32_bf16 v[60:63], a[20:23], a[56:59], v[60:63]
    ds_read_b64_tr_b16 a[8:9], v11 offset:64
    v_mfma_f32_16x16x32_bf16 v[64:67], a[20:23], a[60:63], v[64:67]
    ds_read_b64_tr_b16 a[10:11], v12 offset:64
    ds_read_b64_tr_b16 a[12:13], v11 offset:96
    s_add_u32 s60, s63, 301056
    s_add_u32 m0, s65, 16896
    s_nop 0
    buffer_load_dwordx4 v0, s[28:31], s60 offen lds
    v_mfma_f32_16x16x32_bf16 v[68:71], a[24:27], a[48:51], v[68:71]
    ds_read_b64_tr_b16 a[14:15], v12 offset:96
    v_mfma_f32_16x16x32_bf16 v[72:75], a[24:27], a[52:55], v[72:75]
    v_mfma_f32_16x16x32_bf16 v[76:79], a[24:27], a[56:59], v[76:79]
    v_mfma_f32_16x16x32_bf16 v[80:83], a[24:27], a[60:63], v[80:83]
    s_add_u32 s60, s60, 896
    s_add_u32 m0, m0, 1056
    s_nop 0
    buffer_load_dwordx4 v0, s[28:31], s60 offen lds
    v_mfma_f32_16x16x32_bf16 v[84:87], a[28:31], a[48:51], v[84:87]
    v_mfma_f32_16x16x32_bf16 v[88:91], a[28:31], a[52:55], v[88:91]
    s_waitcnt vmcnt(4)
    s_waitcnt lgkmcnt(0)
    s_barrier
    v_mfma_f32_16x16x32_bf16 v[92:95], a[28:31], a[56:59], v[92:95]
    v_mfma_f32_16x16x32_bf16 v[96:99], a[28:31], a[60:63], v[96:99]
    s_cmp_ge_u32 s40, 6
    s_cbranch_scc0 L_of1_1
    ds_write_b128 v20, v[152:155] offset:3072
    ds_write_b128 v20, v[156:159] offset:11264
L_of1_1:
    v_mfma_f32_16x16x32_bf16 v[36:39], a[0:3], a[32:35], v[36:39]
    v_add_u32 v11, 33792, v18
    v_add_u32 v12, 50688, v18
    v_mfma_f32_16x16x32_bf16 v[40:43], a[0:3], a[36:39], v[40:43]
    ds_read_b128 a[48:51], v15 offset:33792
    ds_read_b128 a[52:55], v15 offset:40960
    s_add_u32 s60, s63, 315392
    s_add_u32 m0, s65, 67584
    s_nop 0
    buffer_load_dwordx4 v0, s[28:31], s60 offen lds
    v_mfma_f32_16x16x32_bf16 v[44:47], a[0:3], a[40:43], v[44:47]
    ds_read_b128 a[56:59], v15 offset:48128
    v_mfma_f32_16x16x32_bf16 v[48:51], a[0:3], a[44:47], v[48:51]
    ds_read_b128 a[60:63], v15 offset:55296
    ds_read_b64_tr_b16 a[16:17], v11 offset:0
    v_mfma_f32_16x16x32_bf16 v[52:55], a[4:7], a[32:35], v[52:55]
    ds_read_b64_tr_b16 a[18:19], v12 offset:0
    s_add_u32 s60, s60, 896
    s_add_u32 m0, m0, 1056
    s_nop 0
    buffer_load_dwordx4 v0, s[28:31], s60 offen lds
    v_mfma_f32_16x16x32_bf16 v[56:59], a[4:7], a[36:39], v[56:59]
    ds_read_b64_tr_b16 a[20:21], v11 offset:32
    ds_read_b64_tr_b16 a[22:23], v12 offset:32
    v_mfma_f32_16x16x32_bf16 v[60:63], a[4:7], a[40:43], v[60:63]
    ds_read_b64_tr_b16 a[24:25], v11 offset:64
    v_mfma_f32_16x16x32_bf16 v[64:67], a[4:7], a[44:47], v[64:67]
    ds_read_b64_tr_b16 a[26:27], v12 offset:64
    ds_read_b64_tr_b16 a[28:29], v11 offset:96
    s_add_u32 s60, s63, 329728
    s_add_u32 m0, s65, 84480
    s_nop 0
    buffer_load_dwordx4 v0, s[28:31], s60 offen lds
    v_mfma_f32_16x16x32_bf16 v[68:71], a[8:11], a[32:35], v[68:71]
    ds_read_b64_tr_b16 a[30:31], v12 offset:96
    v_mfma_f32_16x16x32_bf16 v[72:75], a[8:11], a[36:39], v[72:75]
    v_mfma_f32_16x16x32_bf16 v[76:79], a[8:11], a[40:43], v[76:79]
    v_mfma_f32_16x16x32_bf16 v[80:83], a[8:11], a[44:47], v[80:83]
    s_add_u32 s60, s60, 896
    s_add_u32 m0, m0, 1056
    s_nop 0
    buffer_load_dwordx4 v0, s[28:31], s60 offen lds
    v_mfma_f32_16x16x32_bf16 v[84:87], a[12:15], a[32:35], v[84:87]
    v_mfma_f32_16x16x32_bf16 v[88:91], a[12:15], a[36:39], v[88:91]
    s_waitcnt vmcnt(4)
    s_waitcnt lgkmcnt(0)
    s_barrier
    v_mfma_f32_16x16x32_bf16 v[92:95], a[12:15], a[40:43], v[92:95]
    v_mfma_f32_16x16x32_bf16 v[96:99], a[12:15], a[44:47], v[96:99]
    v_mfma_f32_16x16x32_bf16 v[36:39], a[16:19], a[48:51], v[36:39]
    v_add_u32 v11, 0, v18
    v_add_u32 v12, 16896, v18
    v_mfma_f32_16x16x32_bf16 v[40:43], a[16:19], a[52:55], v[40:43]
    ds_read_b128 a[32:35], v15 offset:34816
    ds_read_b128 a[36:39], v15 offset:41984
    s_add_u32 s60, s63, 344064
    s_add_u32 m0, s65, 33792
    s_nop 0
    buffer_load_dwordx4 v0, s[28:31], s60 offen lds
    v_mfma_f32_16x16x32_bf16 v[44:47], a[16:19], a[56:59], v[44:47]
    ds_read_b128 a[40:43], v15 offset:49152
    v_mfma_f32_16x16x32_bf16 v[48:51], a[16:19], a[60:63], v[48:51]
    ds_read_b128 a[44:47], v15 offset:56320
    ds_read_b64_tr_b16 a[0:1], v11 offset:0
    v_mfma_f32_16x16x32_bf16 v[52:55], a[20:23], a[48:51], v[52:55]
    ds_read_b64_tr_b16 a[2:3], v12 offset:0
    s_add_u32 s60, s60, 896
    s_add_u32 m0, m0, 1056
    s_nop 0
    buffer_load_dwordx4 v0, s[28:31], s60 offen lds
    v_mfma_f32_16x16x32_bf16 v[56:59], a[20:23], a[52:55], v[56:59]
    ds_read_b64_tr_b16 a[4:5], v11 offset:32
    ds_read_b64_tr_b16 a[6:7], v12 offset:32
    v_mfma_f32_16x16x32_bf16 v[60:63], a[20:23], a[56:59], v[60:63]
    ds_read_b64_tr_b16 a[8:9], v11 offset:64
    v_mfma_f32_16x16x32_bf16 v[64:67], a[20:23], a[60:63], v[64:67]
    ds_read_b64_tr_b16 a[10:11], v12 offset:64
    ds_read_b64_tr_b16 a[12:13], v11 offset:96
    s_add_u32 s60, s63, 358400
    s_add_u32 m0, s65, 50688
    s_nop 0
    buffer_load_dwordx4 v0, s[28:31], s60 offen lds
    v_mfma_f32_16x16x32_bf16 v[68:71], a[24:27], a[48:51], v[68:71]
    ds_read_b64_tr_b16 a[14:15], v12 offset:96
    v_mfma_f32_16x16x32_bf16 v[72:75], a[24:27], a[52:55], v[72:75]
    v_mfma_f32_16x16x32_bf16 v[76:79], a[24:27], a[56:59], v[76:79]
    v_mfma_f32_16x16x32_bf16 v[80:83], a[24:27], a[60:63], v[80:83]
    s_add_u32 s60, s60, 896
    s_add_u32 m0, m0, 1056
    s_nop 0
    buffer_load_dwordx4 v0, s[28:31], s60 offen lds
    v_mfma_f32_16x16x32_bf16 v[84:87], a[28:31], a[48:51], v[84:87]
    v_mfma_f32_16x16x32_bf16 v[88:91], a[28:31], a[52:55], v[88:91]
    s_waitcnt vmcnt(4)
    s_waitcnt lgkmcnt(0)
    s_barrier
    v_mfma_f32_16x16x32_bf16 v[92:95], a[28:31], a[56:59], v[92:95]
    v_mfma_f32_16x16x32_bf16 v[96:99], a[28:31], a[60:63], v[96:99]
    v_mfma_f32_16x16x32_bf16 v[36:39], a[0:3], a[32:35], v[36:39]
    v_add_u32 v11, 67584, v18
    v_add_u32 v12, 84480, v18
    v_mfma_f32_16x16x32_bf16 v[40:43], a[0:3], a[36:39], v[40:43]
    ds_read_b128 a[48:51], v15 offset:35840
    ds_read_b128 a[52:55], v15 offset:43008
    s_add_u32 s60, s63, 372736
    s_add_u32 m0, s65, 0
    s_nop 0
    buffer_load_dwordx4 v0, s[28:31], s60 offen lds
    v_mfma_f32_16x16x32_bf16 v[44:47], a[0:3], a[40:43], v[44:47]
    ds_read_b128 a[56:59], v15 offset:50176
    v_mfma_f32_16x16x32_bf16 v[48:51], a[0:3], a[44:47], v[48:51]
    ds_read_b128 a[60:63], v15 offset:57344
    ds_read_b64_tr_b16 a[16:17], v11 offset:0
    v_mfma_f32_16x16x32_bf16 v[52:55], a[4:7], a[32:35], v[52:55]
    ds_read_b64_tr_b16 a[18:19], v12 offset:0
    s_add_u32 s60, s60, 896
    s_add_u32 m0, m0, 1056
    s_nop 0
    buffer_load_dwordx4 v0, s[28:31], s60 offen lds
    v_mfma_f32_16x16x32_bf16 v[56:59], a[4:7], a[36:39], v[56:59]
    ds_read_b64_tr_b16 a[20:21], v11 offset:32
    ds_read_b64_tr_b16 a[22:23], v12 offset:32
    v_mfma_f32_16x16x32_bf16 v[60:63], a[4:7], a[40:43], v[60:63]
    ds_read_b64_tr_b16 a[24:25], v11 offset:64
    v_mfma_f32_16x16x32_bf16 v[64:67], a[4:7], a[44:47], v[64:67]
    ds_read_b64_tr_b16 a[26:27], v12 offset:64
    ds_read_b64_tr_b16 a[28:29], v11 offset:96
    s_add_u32 s60, s63, 387072
    s_add_u32 m0, s65, 16896
    s_nop 0
    buffer_load_dwordx4 v0, s[28:31], s60 offen lds
    v_mfma_f32_16x16x32_bf16 v[68:71], a[8:11], a[32:35], v[68:71]
    ds_read_b64_tr_b16 a[30:31], v12 offset:96
    v_mfma_f32_16x16x32_bf16 v[72:75], a[8:11], a[36:39], v[72:75]
    v_mfma_f32_16x16x32_bf16 v[76:79], a[8:11], a[40:43], v[76:79]
    v_mfma_f32_16x16x32_bf16 v[80:83], a[8:11], a[44:47], v[80:83]
    s_add_u32 s60, s60, 896
    s_add_u32 m0, m0, 1056
    s_nop 0
    buffer_load_dwordx4 v0, s[28:31], s60 offen lds
    v_mfma_f32_16x16x32_bf16 v[84:87], a[12:15], a[32:35], v[84:87]
    v_mfma_f32_16x16x32_bf16 v[88:91], a[12:15], a[36:39], v[88:91]
    s_waitcnt vmcnt(4)
    s_waitcnt lgkmcnt(0)
    s_barrier
    v_mfma_f32_16x16x32_bf16 v[92:95], a[12:15], a[40:43], v[92:95]
    v_mfma_f32_16x16x32_bf16 v[96:99], a[12:15], a[44:47], v[96:99]
    v_mfma_f32_16x16x32_bf16 v[36:39], a[16:19], a[48:51], v[36:39]
    v_add_u32 v11, 33792, v18
    v_add_u32 v12, 50688, v18
    v_mfma_f32_16x16x32_bf16 v[40:43], a[16:19], a[52:55], v[40:43]
    ds_read_b128 a[32:35], v15 offset:36864
    ds_read_b128 a[36:39], v15 offset:44032
    s_add_u32 s60, s63, 401408
    s_add_u32 m0, s65, 67584
    s_nop 0
    buffer_load_dwordx4 v0, s[28:31], s60 offen lds
    v_mfma_f32_16x16x32_bf16 v[44:47], a[16:19], a[56:59], v[44:47]
    ds_read_b128 a[40:43], v15 offset:51200
    v_mfma_f32_16x16x32_bf16 v[48:51], a[16:19], a[60:63], v[48:51]
    ds_read_b128 a[44:47], v15 offset:58368
    ds_read_b64_tr_b16 a[0:1], v11 offset:0
    v_mfma_f32_16x16x32_bf16 v[52:55], a[20:23], a[48:51], v[52:55]
    ds_read_b64_tr_b16 a[2:3], v12 offset:0
    s_add_u32 s60, s60, 896
    s_add_u32 m0, m0, 1056
    s_nop 0
    buffer_load_dwordx4 v0, s[28:31], s60 offen lds
    v_mfma_f32_16x16x32_bf16 v[56:59], a[20:23], a[52:55], v[56:59]
    ds_read_b64_tr_b16 a[4:5], v11 offset:32
    ds_read_b64_tr_b16 a[6:7], v12 offset:32
    v_mfma_f32_16x16x32_bf16 v[60:63], a[20:23], a[56:59], v[60:63]
    ds_read_b64_tr_b16 a[8:9], v11 offset:64
    v_mfma_f32_16x16x32_bf16 v[64:67], a[20:23], a[60:63], v[64:67]
    ds_read_b64_tr_b16 a[10:11], v12 offset:64
    ds_read_b64_tr_b16 a[12:13], v11 offset:96
    s_add_u32 s60, s63, 415744
    s_add_u32 m0, s65, 84480
    s_nop 0
    buffer_load_dwordx4 v0, s[28:31], s60 offen lds
    v_mfma_f32_16x16x32_bf16 v[68:71], a[24:27], a[48:51], v[68:71]
    ds_read_b64_tr_b16 a[14:15], v12 offset:96
    v_mfma_f32_16x16x32_bf16 v[72:75], a[24:27], a[52:55], v[72:75]
    v_mfma_f32_16x16x32_bf16 v[76:79], a[24:27], a[56:59], v[76:79]
    v_mfma_f32_16x16x32_bf16 v[80:83], a[24:27], a[60:63], v[80:83]
    s_add_u32 s60, s60, 896
    s_add_u32 m0, m0, 1056
    s_nop 0
    buffer_load_dwordx4 v0, s[28:31], s60 offen lds
    v_mfma_f32_16x16x32_bf16 v[84:87], a[28:31], a[48:51], v[84:87]
    v_mfma_f32_16x16x32_bf16 v[88:91], a[28:31], a[52:55], v[88:91]
    s_waitcnt vmcnt(4)
    s_waitcnt lgkmcnt(0)
    s_barrier
    v_mfma_f32_16x16x32_bf16 v[92:95], a[28:31], a[56:59], v[92:95]
    v_mfma_f32_16x16x32_bf16 v[96:99], a[28:31], a[60:63], v[96:99]
    v_mfma_f32_16x16x32_bf16 v[36:39], a[0:3], a[32:35], v[36:39]
    v_add_u32 v11, 0, v18
    v_add_u32 v12, 16896, v18
    v_mfma_f32_16x16x32_bf16 v[40:43], a[0:3], a[36:39], v[40:43]
    ds_read_b128 a[48:51], v15 offset:37888
    ds_read_b128 a[52:55], v15 offset:45056
    s_add_u32 s60, s63, 430080
    s_add_u32 m0, s65, 33792
    s_nop 0
    buffer_load_dwordx4 v0, s[28:31], s60 offen lds
    v_mfma_f32_16x16x32_bf16 v[44:47], a[0:3], a[40:43], v[44:47]
    ds_read_b128 a[56:59], v15 offset:52224
    v_mfma_f32_16x16x32_bf16 v[48:51], a[0:3], a[44:47], v[48:51]
    ds_read_b128 a[60:63], v15 offset:59392
    ds_read_b64_tr_b16 a[16:17], v11 offset:0
    v_mfma_f32_16x16x32_bf16 v[52:55], a[4:7], a[32:35], v[52:55]
    ds_read_b64_tr_b16 a[18:19], v12 offset:0
    s_add_u32 s60, s60, 896
    s_add_u32 m0, m0, 1056
    s_nop 0
    buffer_load_dwordx4 v0, s[28:31], s60 offen lds
    v_mfma_f32_16x16x32_bf16 v[56:59], a[4:7], a[36:39], v[56:59]
    ds_read_b64_tr_b16 a[20:21], v11 offset:32
    ds_read_b64_tr_b16 a[22:23], v12 offset:32
    v_mfma_f32_16x16x32_bf16 v[60:63], a[4:7], a[40:43], v[60:63]
    ds_read_b64_tr_b16 a[24:25], v11 offset:64
    v_mfma_f32_16x16x32_bf16 v[64:67], a[4:7], a[44:47], v[64:67]
    ds_read_b64_tr_b16 a[26:27], v12 offset:64
    ds_read_b64_tr_b16 a[28:29], v11 offset:96
    s_add_u32 s60, s63, 444416
    s_add_u32 m0, s65, 50688
    s_nop 0
    buffer_load_dwordx4 v0, s[28:31], s60 offen lds
    v_mfma_f32_16x16x32_bf16 v[68:71], a[8:11], a[32:35], v[68:71]
    ds_read_b64_tr_b16 a[30:31], v12 offset:96
    v_mfma_f32_16x16x32_bf16 v[72:75], a[8:11], a[36:39], v[72:75]
    v_mfma_f32_16x16x32_bf16 v[76:79], a[8:11], a[40:43], v[76:79]
    v_mfma_f32_16x16x32_bf16 v[80:83], a[8:11], a[44:47], v[80:83]
    s_add_u32 s60, s60, 896
    s_add_u32 m0, m0, 1056
    s_nop 0
    buffer_load_dwordx4 v0, s[28:31], s60 offen lds
    v_mfma_f32_16x16x32_bf16 v[84:87], a[12:15], a[32:35], v[84:87]
    v_mfma_f32_16x16x32_bf16 v[88:91], a[12:15], a[36:39], v[88:91]
    s_waitcnt vmcnt(4)
    s_waitcnt lgkmcnt(0)
    s_barrier
    v_mfma_f32_16x16x32_bf16 v[92:95], a[12:15], a[40:43], v[92:95]
    v_mfma_f32_16x16x32_bf16 v[96:99], a[12:15], a[44:47], v[96:99]
    s_waitcnt lgkmcnt(0)
    s_mul_i32 s54, s42, 57344
    s_add_u32 s8, s98, s54
    s_addc_u32 s9, s99, 0
    s_mov_b32 s10, 57344
    s_mov_b32 s11, 0x00020000
    s_mov_b32 s12, s96
    s_mov_b32 s13, s97
    s_mov_b32 s14, 896
    s_mov_b32 s15, 0x00020000
    s_mul_i32 s54, s41, 7
    s_add_u32 s54, s54, s40
    s_lshl_b32 s54, s54, 10
    s_mul_i32 s55, s42, 57344
    s_add_u32 s70, s54, s55
    s_mul_i32 s56, s41, 7
    s_add_u32 s56, s56, s40
    s_lshr_b32 s54, s56, 1
    s_lshl_b32 s54, s54, 5
    v_lshlrev_b32 v5, 3, v3
    v_add_u32 v14, s54, v5
    s_and_b32 s54, s56, 1
    s_lshl_b32 s54, s54, 5
    v_add_u32 v6, s54, v2
    v_mul_u32_u24 v6, 896, v6
    v_add_u32 v17, v6, v14
    v_add_u32 v19, 14336, v17
    s_add_u32 s54, s70, 0
    buffer_load_dwordx4 v[100:103], v9, s[36:39], s54 offen sc1
    s_add_u32 s54, s70, 1835008
    buffer_load_dwordx4 v[104:107], v9, s[36:39], s54 offen sc1
    s_add_u32 s54, s70, 3670016
    buffer_load_dwordx4 v[108:111], v9, s[36:39], s54 offen sc1
    buffer_load_dwordx2 v[28:29], v17, s[4:7], 0 offen
    v_mfma_f32_16x16x32_bf16 v[36:39], a[16:19], a[48:51], v[36:39]
    v_add_u32 v11, 67584, v18
    v_add_u32 v12, 84480, v18
    v_mfma_f32_16x16x32_bf16 v[40:43], a[16:19], a[52:55], v[40:43]
    ds_read_b128 a[32:35], v15 offset:38912
    ds_read_b128 a[36:39], v15 offset:46080
    v_mfma_f32_16x16x32_bf16 v[44:47], a[16:19], a[56:59], v[44:47]
    ds_read_b128 a[40:43], v15 offset:53248
    v_mfma_f32_16x16x32_bf16 v[48:51], a[16:19], a[60:63], v[48:51]
    ds_read_b128 a[44:47], v15 offset:60416
    ds_read_b64_tr_b16 a[0:1], v11 offset:0
    v_mfma_f32_16x16x32_bf16 v[52:55], a[20:23], a[48:51], v[52:55]
    ds_read_b64_tr_b16 a[2:3], v12 offset:0
    v_mfma_f32_16x16x32_bf16 v[56:59], a[20:23], a[52:55], v[56:59]
    ds_read_b64_tr_b16 a[4:5], v11 offset:32
    ds_read_b64_tr_b16 a[6:7], v12 offset:32
    v_mfma_f32_16x16x32_bf16 v[60:63], a[20:23], a[56:59], v[60:63]
    ds_read_b64_tr_b16 a[8:9], v11 offset:64
    v_mfma_f32_16x16x32_bf16 v[64:67], a[20:23], a[60:63], v[64:67]
    ds_read_b64_tr_b16 a[10:11], v12 offset:64
    ds_read_b64_tr_b16 a[12:13], v11 offset:96
    v_mfma_f32_16x16x32_bf16 v[68:71], a[24:27], a[48:51], v[68:71]
    ds_read_b64_tr_b16 a[14:15], v12 offset:96
    v_mfma_f32_16x16x32_bf16 v[72:75], a[24:27], a[52:55], v[72:75]
    v_mfma_f32_16x16x32_bf16 v[76:79], a[24:27], a[56:59], v[76:79]
    v_mfma_f32_16x16x32_bf16 v[80:83], a[24:27], a[60:63], v[80:83]
    v_mfma_f32_16x16x32_bf16 v[84:87], a[28:31], a[48:51], v[84:87]
    v_mfma_f32_16x16x32_bf16 v[88:91], a[28:31], a[52:55], v[88:91]
    s_waitcnt vmcnt(4)
    s_waitcnt lgkmcnt(0)
    s_barrier
    v_mfma_f32_16x16x32_bf16 v[92:95], a[28:31], a[56:59], v[92:95]
    v_mfma_f32_16x16x32_bf16 v[96:99], a[28:31], a[60:63], v[96:99]
    s_add_u32 s54, s70, 5505024
    buffer_load_dwordx4 v[112:115], v9, s[36:39], s54 offen sc1
    s_add_u32 s54, s70, 7340032
    buffer_load_dwordx4 v[116:119], v9, s[36:39], s54 offen sc1
    s_add_u32 s54, s70, 9175040
    buffer_load_dwordx4 v[120:123], v9, s[36:39], s54 offen sc1
    buffer_load_dwordx2 v[30:31], v19, s[4:7], 0 offen
    v_mfma_f32_16x16x32_bf16 v[36:39], a[0:3], a[32:35], v[36:39]
    v_add_u32 v11, 33792, v18
    v_add_u32 v12, 50688, v18
    v_mfma_f32_16x16x32_bf16 v[40:43], a[0:3], a[36:39], v[40:43]
    ds_read_b128 a[48:51], v15 offset:7168
    ds_read_b128 a[52:55], v15 offset:15360
    v_mfma_f32_16x16x32_bf16 v[44:47], a[0:3], a[40:43], v[44:47]
    ds_read_b128 a[56:59], v15 offset:23552
    v_mfma_f32_16x16x32_bf16 v[48:51], a[0:3], a[44:47], v[48:51]
    ds_read_b128 a[60:63], v15 offset:31744
    ds_read_b64_tr_b16 a[16:17], v11 offset:0
    v_mfma_f32_16x16x32_bf16 v[52:55], a[4:7], a[32:35], v[52:55]
    ds_read_b64_tr_b16 a[18:19], v12 offset:0
    v_mfma_f32_16x16x32_bf16 v[56:59], a[4:7], a[36:39], v[56:59]
    ds_read_b64_tr_b16 a[20:21], v11 offset:32
    ds_read_b64_tr_b16 a[22:23], v12 offset:32
    v_mfma_f32_16x16x32_bf16 v[60:63], a[4:7], a[40:43], v[60:63]
    ds_read_b64_tr_b16 a[24:25], v11 offset:64
    v_mfma_f32_16x16x32_bf16 v[64:67], a[4:7], a[44:47], v[64:67]
    ds_read_b64_tr_b16 a[26:27], v12 offset:64
    ds_read_b64_tr_b16 a[28:29], v11 offset:96
    v_mfma_f32_16x16x32_bf16 v[68:71], a[8:11], a[32:35], v[68:71]
    ds_read_b64_tr_b16 a[30:31], v12 offset:96
    v_mfma_f32_16x16x32_bf16 v[72:75], a[8:11], a[36:39], v[72:75]
    v_mfma_f32_16x16x32_bf16 v[76:79], a[8:11], a[40:43], v[76:79]
    v_mfma_f32_16x16x32_bf16 v[80:83], a[8:11], a[44:47], v[80:83]
    v_mfma_f32_16x16x32_bf16 v[84:87], a[12:15], a[32:35], v[84:87]
    v_mfma_f32_16x16x32_bf16 v[88:91], a[12:15], a[36:39], v[88:91]
    s_waitcnt lgkmcnt(0)
    s_barrier
    v_mfma_f32_16x16x32_bf16 v[92:95], a[12:15], a[40:43], v[92:95]
    v_mfma_f32_16x16x32_bf16 v[96:99], a[12:15], a[44:47], v[96:99]
    s_add_u32 s54, s70, 11010048
    buffer_load_dwordx4 v[124:127], v9, s[36:39], s54 offen sc1
    s_add_u32 s54, s70, 12845056
    buffer_load_dwordx4 v[24:27], v9, s[36:39], s54 offen sc1
    buffer_load_dwordx2 v[32:33], v14, s[12:15], 0 offen
    v_mfma_f32_16x16x32_bf16 v[36:39], a[16:19], a[48:51], v[36:39]
    v_mfma_f32_16x16x32_bf16 v[40:43], a[16:19], a[52:55], v[40:43]
    v_mfma_f32_16x16x32_bf16 v[44:47], a[16:19], a[56:59], v[44:47]
    v_mfma_f32_16x16x32_bf16 v[48:51], a[16:19], a[60:63], v[48:51]
    v_mfma_f32_16x16x32_bf16 v[52:55], a[20:23], a[48:51], v[52:55]
    v_mfma_f32_16x16x32_bf16 v[56:59], a[20:23], a[52:55], v[56:59]
    v_mfma_f32_16x16x32_bf16 v[60:63], a[20:23], a[56:59], v[60:63]
    v_mfma_f32_16x16x32_bf16 v[64:67], a[20:23], a[60:63], v[64:67]
    v_mfma_f32_16x16x32_bf16 v[68:71], a[24:27], a[48:51], v[68:71]
    v_mfma_f32_16x16x32_bf16 v[72:75], a[24:27], a[52:55], v[72:75]
    v_mfma_f32_16x16x32_bf16 v[76:79], a[24:27], a[56:59], v[76:79]
    v_mfma_f32_16x16x32_bf16 v[80:83], a[24:27], a[60:63], v[80:83]
    v_mfma_f32_16x16x32_bf16 v[84:87], a[28:31], a[48:51], v[84:87]
    v_mfma_f32_16x16x32_bf16 v[88:91], a[28:31], a[52:55], v[88:91]
    v_mfma_f32_16x16x32_bf16 v[92:95], a[28:31], a[56:59], v[92:95]
    v_mfma_f32_16x16x32_bf16 v[96:99], a[28:31], a[60:63], v[96:99]
    s_lshl_b32 s54, s41, 5
    s_add_u32 s54, s54, s42
    s_mul_i32 s54, s54, 57344
    s_add_u32 s54, s54, s71
    s_add_u32 s54, s54, 16777216
    s_nop 7
    v_cvt_pk_bf16_f32 v128, v36, v37
    v_cvt_pk_bf16_f32 v129, v38, v39
    v_cvt_pk_bf16_f32 v130, v40, v41
    v_cvt_pk_bf16_f32 v131, v42, v43
    v_cvt_pk_bf16_f32 v132, v44, v45
    v_cvt_pk_bf16_f32 v133, v46, v47
    v_cvt_pk_bf16_f32 v134, v48, v49
    v_cvt_pk_bf16_f32 v135, v50, v51
    v_cvt_pk_bf16_f32 v136, v52, v53
    v_cvt_pk_bf16_f32 v137, v54, v55
    v_cvt_pk_bf16_f32 v138, v56, v57
    v_cvt_pk_bf16_f32 v139, v58, v59
    v_cvt_pk_bf16_f32 v140, v60, v61
    v_cvt_pk_bf16_f32 v141, v62, v63
    v_cvt_pk_bf16_f32 v142, v64, v65
    v_cvt_pk_bf16_f32 v143, v66, v67
    v_cvt_pk_bf16_f32 v144, v68, v69
    v_cvt_pk_bf16_f32 v145, v70, v71
    v_cvt_pk_bf16_f32 v146, v72, v73
    v_cvt_pk_bf16_f32 v147, v74, v75
    v_cvt_pk_bf16_f32 v148, v76, v77
    v_cvt_pk_bf16_f32 v149, v78, v79
    v_cvt_pk_bf16_f32 v150, v80, v81
    v_cvt_pk_bf16_f32 v151, v82, v83
    v_cvt_pk_bf16_f32 v152, v84, v85
    v_cvt_pk_bf16_f32 v153, v86, v87
    v_cvt_pk_bf16_f32 v154, v88, v89
    v_cvt_pk_bf16_f32 v155, v90, v91
    v_cvt_pk_bf16_f32 v156, v92, v93
    v_cvt_pk_bf16_f32 v157, v94, v95
    v_cvt_pk_bf16_f32 v158, v96, v97
    v_cvt_pk_bf16_f32 v159, v98, v99
    buffer_store_dwordx4 v[128:131], v9, s[36:39], s54 offen offset:0 sc1
    buffer_store_dwordx4 v[132:135], v9, s[36:39], s54 offen offset:1024 sc1
    buffer_store_dwordx4 v[136:139], v9, s[36:39], s54 offen offset:2048 sc1
    buffer_store_dwordx4 v[140:143], v9, s[36:39], s54 offen offset:3072 sc1
    s_add_u32 s54, s54, 4096
    buffer_store_dwordx4 v[144:147], v9, s[36:39], s54 offen offset:0 sc1
    buffer_store_dwordx4 v[148:151], v9, s[36:39], s54 offen offset:1024 sc1
    buffer_store_dwordx4 v[152:155], v9, s[36:39], s54 offen offset:2048 sc1
    buffer_store_dwordx4 v[156:159], v9, s[36:39], s54 offen offset:3072 sc1
    s_branch L_opD
L_opB:
    v_add_u32 v11, 33792, v18
    v_add_u32 v12, 50688, v18
    ds_read_b64_tr_b16 a[0:1], v11 offset:0
    ds_read_b64_tr_b16 a[2:3], v12 offset:0
    ds_read_b64_tr_b16 a[4:5], v11 offset:32
    ds_read_b64_tr_b16 a[6:7], v12 offset:32
    ds_read_b64_tr_b16 a[8:9], v11 offset:64
    ds_read_b64_tr_b16 a[10:11], v12 offset:64
    s_waitcnt lgkmcnt(0)
    s_barrier
    ds_read_b128 a[32:35], v15 offset:0
    ds_read_b128 a[36:39], v15 offset:8192
    ds_read_b128 a[40:43], v15 offset:16384
    ds_read_b128 a[44:47], v15 offset:24576
    s_waitcnt lgkmcnt(0)
    v_mfma_f32_16x16x32_bf16 v[36:39], a[0:3], a[32:35], 0
    v_add_u32 v11, 0, v18
    v_add_u32 v12, 16896, v18
    s_add_u32 s60, s63, 86016
    s_add_u32 m0, s65, 33792
    s_nop 0
    buffer_load_dwordx4 v0, s[28:31], s60 offen lds
    v_mfma_f32_16x16x32_bf16 v[40:43], a[0:3], a[36:39], 0
    ds_read_b128 a[48:51], v15 offset:1024
    ds_read_b128 a[52:55], v15 offset:9216
    v_mfma_f32_16x16x32_bf16 v[44:47], a[0:3], a[40:43], 0
    ds_read_b128 a[56:59], v15 offset:17408
    ds_read_b128 a[60:63], v15 offset:25600
    v_mfma_f32_16x16x32_bf16 v[48:51], a[0:3], a[44:47], 0
    ds_read_b64_tr_b16 a[16:17], v11 offset:0
    s_add_u32 s60, s60, 896
    s_add_u32 m0, m0, 1056
    s_nop 0
    buffer_load_dwordx4 v0, s[28:31], s60 offen lds
    v_mfma_f32_16x16x32_bf16 v[52:55], a[4:7], a[32:35], 0
    ds_read_b64_tr_b16 a[18:19], v12 offset:0
    ds_read_b64_tr_b16 a[20:21], v11 offset:32
    v_mfma_f32_16x16x32_bf16 v[56:59], a[4:7], a[36:39], 0
    ds_read_b64_tr_b16 a[22:23], v12 offset:32
    ds_read_b64_tr_b16 a[24:25], v11 offset:64
    s_add_u32 s60, s63, 100352
    s_add_u32 m0, s65, 50688
    s_nop 0
    buffer_load_dwordx4 v0, s[28:31], s60 offen lds
    v_mfma_f32_16x16x32_bf16 v[60:63], a[4:7], a[40:43], 0
    ds_read_b64_tr_b16 a[26:27], v12 offset:64
    v_mfma_f32_16x16x32_bf16 v[64:67], a[4:7], a[44:47], 0
    s_add_u32 s60, s60, 896
    s_add_u32 m0, m0, 1056
    s_nop 0
    buffer_load_dwordx4 v0, s[28:31], s60 offen lds
    v_mfma_f32_16x16x32_bf16 v[68:71], a[8:11], a[32:35], 0
    v_mfma_f32_16x16x32_bf16 v[72:75], a[8:11], a[36:39], 0
    s_waitcnt vmcnt(4)
    s_waitcnt lgkmcnt(0)
    s_barrier
    v_mfma_f32_16x16x32_bf16 v[76:79], a[8:11], a[40:43], 0
    v_mfma_f32_16x16x32_bf16 v[80:83], a[8:11], a[44:47], 0
    v_mfma_f32_16x16x32_bf16 v[36:39], a[16:19], a[48:51], v[36:39]
    v_add_u32 v11, 67584, v18
    v_add_u32 v12, 84480, v18
    s_add_u32 s60, s63, 114688
    s_add_u32 m0, s65, 0
    s_nop 0
    buffer_load_dwordx4 v0, s[28:31], s60 offen lds
    v_mfma_f32_16x16x32_bf16 v[40:43], a[16:19], a[52:55], v[40:43]
    ds_read_b128 a[32:35], v15 offset:2048
    ds_read_b128 a[36:39], v15 offset:10240
    v_mfma_f32_16x16x32_bf16 v[44:47], a[16:19], a[56:59], v[44:47]
    ds_read_b128 a[40:43], v15 offset:18432
    ds_read_b128 a[44:47], v15 offset:26624
    v_mfma_f32_16x16x32_bf16 v[48:51], a[16:19], a[60:63], v[48:51]
    ds_read_b64_tr_b16 a[0:1], v11 offset:0
    s_add_u32 s60, s60, 896
    s_add_u32 m0, m0, 1056
    s_nop 0
    buffer_load_dwordx4 v0, s[28:31], s60 offen lds
    v_mfma_f32_16x16x32_bf16 v[52:55], a[20:23], a[48:51], v[52:55]
    ds_read_b64_tr_b16 a[2:3], v12 offset:0
    ds_read_b64_tr_b16 a[4:5], v11 offset:32
    v_mfma_f32_16x16x32_bf16 v[56:59], a[20:23], a[52:55], v[56:59]
    ds_read_b64_tr_b16 a[6:7], v12 offset:32
    ds_read_b64_tr_b16 a[8:9], v11 offset:64
    s_add_u32 s60, s63, 129024
    s_add_u32 m0, s65, 16896
    s_nop 0
    buffer_load_dwordx4 v0, s[28:31], s60 offen lds
    v_mfma_f32_16x16x32_bf16 v[60:63], a[20:23], a[56:59], v[60:63]
    ds_read_b64_tr_b16 a[10:11], v12 offset:64
    v_mfma_f32_16x16x32_bf16 v[64:67], a[20:23], a[60:63], v[64:67]
    s_add_u32 s60, s60, 896
    s_add_u32 m0, m0, 1056
    s_nop 0
    buffer_load_dwordx4 v0, s[28:31], s60 offen lds
    v_mfma_f32_16x16x32_bf16 v[68:71], a[24:27], a[48:51], v[68:71]
    v_mfma_f32_16x16x32_bf16 v[72:75], a[24:27], a[52:55], v[72:75]
    s_waitcnt vmcnt(4)
    s_waitcnt lgkmcnt(0)
    s_barrier
    v_mfma_f32_16x16x32_bf16 v[76:79], a[24:27], a[56:59], v[76:79]
    v_mfma_f32_16x16x32_bf16 v[80:83], a[24:27], a[60:63], v[80:83]
    v_mfma_f32_16x16x32_bf16 v[36:39], a[0:3], a[32:35], v[36:39]
    v_add_u32 v11, 33792, v18
    v_add_u32 v12, 50688, v18
    s_add_u32 s60, s63, 143360
    s_add_u32 m0, s65, 67584
    s_nop 0
    buffer_load_dwordx4 v0, s[28:31], s60 offen lds
    v_mfma_f32_16x16x32_bf16 v[40:43], a[0:3], a[36:39], v[40:43]
    ds_read_b128 a[48:51], v15 offset:3072
    ds_read_b128 a[52:55], v15 offset:11264
    v_mfma_f32_16x16x32_bf16 v[44:47], a[0:3], a[40:43], v[44:47]
    ds_read_b128 a[56:59], v15 offset:19456
    ds_read_b128 a[60:63], v15 offset:27648
    v_mfma_f32_16x16x32_bf16 v[48:51], a[0:3], a[44:47], v[48:51]
    ds_read_b64_tr_b16 a[16:17], v11 offset:0
    s_add_u32 s60, s60, 896
    s_add_u32 m0, m0, 1056
    s_nop 0
    buffer_load_dwordx4 v0, s[28:31], s60 offen lds
    v_mfma_f32_16x16x32_bf16 v[52:55], a[4:7], a[32:35], v[52:55]
    ds_read_b64_tr_b16 a[18:19], v12 offset:0
    ds_read_b64_tr_b16 a[20:21], v11 offset:32
    v_mfma_f32_16x16x32_bf16 v[56:59], a[4:7], a[36:39], v[56:59]
    ds_read_b64_tr_b16 a[22:23], v12 offset:32
    ds_read_b64_tr_b16 a[24:25], v11 offset:64
    s_add_u32 s60, s63, 157696
    s_add_u32 m0, s65, 84480
    s_nop 0
    buffer_load_dwordx4 v0, s[28:31], s60 offen lds
    v_mfma_f32_16x16x32_bf16 v[60:63], a[4:7], a[40:43], v[60:63]
    ds_read_b64_tr_b16 a[26:27], v12 offset:64
    v_mfma_f32_16x16x32_bf16 v[64:67], a[4:7], a[44:47], v[64:67]
    s_add_u32 s60, s60, 896
    s_add_u32 m0, m0, 1056
    s_nop 0
    buffer_load_dwordx4 v0, s[28:31], s60 offen lds
    v_mfma_f32_16x16x32_bf16 v[68:71], a[8:11], a[32:35], v[68:71]
    v_mfma_f32_16x16x32_bf16 v[72:75], a[8:11], a[36:39], v[72:75]
    s_waitcnt vmcnt(4)
    s_waitcnt lgkmcnt(0)
    s_barrier
    v_mfma_f32_16x16x32_bf16 v[76:79], a[8:11], a[40:43], v[76:79]
    v_mfma_f32_16x16x32_bf16 v[80:83], a[8:11], a[44:47], v[80:83]
    v_mfma_f32_16x16x32_bf16 v[36:39], a[16:19], a[48:51], v[36:39]
    v_add_u32 v11, 0, v18
    v_add_u32 v12, 16896, v18
    s_add_u32 s60, s63, 172032
    s_add_u32 m0, s65, 33792
    s_nop 0
    buffer_load_dwordx4 v0, s[28:31], s60 offen lds
    v_mfma_f32_16x16x32_bf16 v[40:43], a[16:19], a[52:55], v[40:43]
    ds_read_b128 a[32:35], v15 offset:4096
    ds_read_b128 a[36:39], v15 offset:12288
    v_mfma_f32_16x16x32_bf16 v[44:47], a[16:19], a[56:59], v[44:47]
    ds_read_b128 a[40:43], v15 offset:20480
    ds_read_b128 a[44:47], v15 offset:28672
    v_mfma_f32_16x16x32_bf16 v[48:51], a[16:19], a[60:63], v[48:51]
    ds_read_b64_tr_b16 a[0:1], v11 offset:0
    s_add_u32 s60, s60, 896
    s_add_u32 m0, m0, 1056
    s_nop 0
    buffer_load_dwordx4 v0, s[28:31], s60 offen lds
    v_mfma_f32_16x16x32_bf16 v[52:55], a[20:23], a[48:51], v[52:55]
    ds_read_b64_tr_b16 a[2:3], v12 offset:0
    ds_read_b64_tr_b16 a[4:5], v11 offset:32
    v_mfma_f32_16x16x32_bf16 v[56:59], a[20:23], a[52:55], v[56:59]
    ds_read_b64_tr_b16 a[6:7], v12 offset:32
    ds_read_b64_tr_b16 a[8:9], v11 offset:64
    s_add_u32 s60, s63, 186368
    s_add_u32 m0, s65, 50688
    s_nop 0
    buffer_load_dwordx4 v0, s[28:31], s60 offen lds
    v_mfma_f32_16x16x32_bf16 v[60:63], a[20:23], a[56:59], v[60:63]
    ds_read_b64_tr_b16 a[10:11], v12 offset:64
    v_mfma_f32_16x16x32_bf16 v[64:67], a[20:23], a[60:63], v[64:67]
    s_add_u32 s60, s60, 896
    s_add_u32 m0, m0, 1056
    s_nop 0
    buffer_load_dwordx4 v0, s[28:31], s60 offen lds
    v_mfma_f32_16x16x32_bf16 v[68:71], a[24:27], a[48:51], v[68:71]
    v_mfma_f32_16x16x32_bf16 v[72:75], a[24:27], a[52:55], v[72:75]
    s_waitcnt vmcnt(4)
    s_waitcnt lgkmcnt(0)
    s_barrier
    v_mfma_f32_16x16x32_bf16 v[76:79], a[24:27], a[56:59], v[76:79]
    v_mfma_f32_16x16x32_bf16 v[80:83], a[24:27], a[60:63], v[80:83]
    v_mfma_f32_16x16x32_bf16 v[36:39], a[0:3], a[32:35], v[36:39]
    v_add_u32 v11, 67584, v18
    v_add_u32 v12, 84480, v18
    s_add_u32 s60, s63, 200704
    s_add_u32 m0, s65, 0
    s_nop 0
    buffer_load_dwordx4 v0, s[28:31], s60 offen lds
    v_mfma_f32_16x16x32_bf16 v[40:43], a[0:3], a[36:39], v[40:43]
    ds_read_b128 a[48:51], v15 offset:5120
    ds_read_b128 a[52:55], v15 offset:13312
    v_mfma_f32_16x16x32_bf16 v[44:47], a[0:3], a[40:43], v[44:47]
    ds_read_b128 a[56:59], v15 offset:21504
    ds_read_b128 a[60:63], v15 offset:29696
    v_mfma_f32_16x16x32_bf16 v[48:51], a[0:3], a[44:47], v[48:51]
    ds_read_b64_tr_b16 a[16:17], v11 offset:0
    s_add_u32 s60, s60, 896
    s_add_u32 m0, m0, 1056
    s_nop 0
    buffer_load_dwordx4 v0, s[28:31], s60 offen lds
    v_mfma_f32_16x16x32_bf16 v[52:55], a[4:7], a[32:35], v[52:55]
    ds_read_b64_tr_b16 a[18:19], v12 offset:0
    ds_read_b64_tr_b16 a[20:21], v11 offset:32
    v_mfma_f32_16x16x32_bf16 v[56:59], a[4:7], a[36:39], v[56:59]
    ds_read_b64_tr_b16 a[22:23], v12 offset:32
    ds_read_b64_tr_b16 a[24:25], v11 offset:64
    s_add_u32 s60, s63, 215040
    s_add_u32 m0, s65, 16896
    s_nop 0
    buffer_load_dwordx4 v0, s[28:31], s60 offen lds
    v_mfma_f32_16x16x32_bf16 v[60:63], a[4:7], a[40:43], v[60:63]
    ds_read_b64_tr_b16 a[26:27], v12 offset:64
    v_mfma_f32_16x16x32_bf16 v[64:67], a[4:7], a[44:47], v[64:67]
    s_add_u32 s60, s60, 896
    s_add_u32 m0, m0, 1056
    s_nop 0
    buffer_load_dwordx4 v0, s[28:31], s60 offen lds
    v_mfma_f32_16x16x32_bf16 v[68:71], a[8:11], a[32:35], v[68:71]
    v_mfma_f32_16x16x32_bf16 v[72:75], a[8:11], a[36:39], v[72:75]
    s_waitcnt vmcnt(4)
    s_waitcnt lgkmcnt(0)
    s_barrier
    v_mfma_f32_16x16x32_bf16 v[76:79], a[8:11], a[40:43], v[76:79]
    v_mfma_f32_16x16x32_bf16 v[80:83], a[8:11], a[44:47], v[80:83]
    v_mfma_f32_16x16x32_bf16 v[36:39], a[16:19], a[48:51], v[36:39]
    v_add_u32 v11, 33792, v18
    v_add_u32 v12, 50688, v18
    s_add_u32 s60, s63, 229376
    s_add_u32 m0, s65, 67584
    s_nop 0
    buffer_load_dwordx4 v0, s[28:31], s60 offen lds
    v_mfma_f32_16x16x32_bf16 v[40:43], a[16:19], a[52:55], v[40:43]
    ds_read_b128 a[32:35], v15 offset:6144
    ds_read_b128 a[36:39], v15 offset:14336
    v_mfma_f32_16x16x32_bf16 v[44:47], a[16:19], a[56:59], v[44:47]
    ds_read_b128 a[40:43], v15 offset:22528
    ds_read_b128 a[44:47], v15 offset:30720
    v_mfma_f32_16x16x32_bf16 v[48:51], a[16:19], a[60:63], v[48:51]
    ds_read_b64_tr_b16 a[0:1], v11 offset:0
    s_add_u32 s60, s60, 896
    s_add_u32 m0, m0, 1056
    s_nop 0
    buffer_load_dwordx4 v0, s[28:31], s60 offen lds
    v_mfma_f32_16x16x32_bf16 v[52:55], a[20:23], a[48:51], v[52:55]
    ds_read_b64_tr_b16 a[2:3], v12 offset:0
    ds_read_b64_tr_b16 a[4:5], v11 offset:32
    v_mfma_f32_16x16x32_bf16 v[56:59], a[20:23], a[52:55], v[56:59]
    ds_read_b64_tr_b16 a[6:7], v12 offset:32
    ds_read_b64_tr_b16 a[8:9], v11 offset:64
    s_add_u32 s60, s63, 243712
    s_add_u32 m0, s65, 84480
    s_nop 0
    buffer_load_dwordx4 v0, s[28:31], s60 offen lds
    v_mfma_f32_16x16x32_bf16 v[60:63], a[20:23], a[56:59], v[60:63]
    ds_read_b64_tr_b16 a[10:11], v12 offset:64
    v_mfma_f32_16x16x32_bf16 v[64:67], a[20:23], a[60:63], v[64:67]
    s_add_u32 s60, s60, 896
    s_add_u32 m0, m0, 1056
    s_nop 0
    buffer_load_dwordx4 v0, s[28:31], s60 offen lds
    v_mfma_f32_16x16x32_bf16 v[68:71], a[24:27], a[48:51], v[68:71]
    v_mfma_f32_16x16x32_bf16 v[72:75], a[24:27], a[52:55], v[72:75]
    s_waitcnt vmcnt(4)
    s_waitcnt lgkmcnt(0)
    s_barrier
    v_mfma_f32_16x16x32_bf16 v[76:79], a[24:27], a[56:59], v[76:79]
    v_mfma_f32_16x16x32_bf16 v[80:83], a[24:27], a[60:63], v[80:83]
    v_mfma_f32_16x16x32_bf16 v[36:39], a[0:3], a[32:35], v[36:39]
    v_add_u32 v11, 0, v18
    v_add_u32 v12, 16896, v18
    s_add_u32 s60, s63, 258048
    s_add_u32 m0, s65, 33792
    s_nop 0
    buffer_load_dwordx4 v0, s[28:31], s60 offen lds
    v_mfma_f32_16x16x32_bf16 v[40:43], a[0:3], a[36:39], v[40:43]
    ds_read_b128 a[48:51], v15 offset:7168
    ds_read_b128 a[52:55], v15 offset:15360
    v_mfma_f32_16x16x32_bf16 v[44:47], a[0:3], a[40:43], v[44:47]
    ds_read_b128 a[56:59], v15 offset:23552
    ds_read_b128 a[60:63], v15 offset:31744
    v_mfma_f32_16x16x32_bf16 v[48:51], a[0:3], a[44:47], v[48:51]
    ds_read_b64_tr_b16 a[16:17], v11 offset:0
    s_add_u32 s60, s60, 896
    s_add_u32 m0, m0, 1056
    s_nop 0
    buffer_load_dwordx4 v0, s[28:31], s60 offen lds
    v_mfma_f32_16x16x32_bf16 v[52:55], a[4:7], a[32:35], v[52:55]
    ds_read_b64_tr_b16 a[18:19], v12 offset:0
    ds_read_b64_tr_b16 a[20:21], v11 offset:32
    v_mfma_f32_16x16x32_bf16 v[56:59], a[4:7], a[36:39], v[56:59]
    ds_read_b64_tr_b16 a[22:23], v12 offset:32
    ds_read_b64_tr_b16 a[24:25], v11 offset:64
    s_add_u32 s60, s63, 272384
    s_add_u32 m0, s65, 50688
    s_nop 0
    buffer_load_dwordx4 v0, s[28:31], s60 offen lds
    v_mfma_f32_16x16x32_bf16 v[60:63], a[4:7], a[40:43], v[60:63]
    ds_read_b64_tr_b16 a[26:27], v12 offset:64
    v_mfma_f32_16x16x32_bf16 v[64:67], a[4:7], a[44:47], v[64:67]
    s_add_u32 s60, s60, 896
    s_add_u32 m0, m0, 1056
    s_nop 0
    buffer_load_dwordx4 v0, s[28:31], s60 offen lds
    v_mfma_f32_16x16x32_bf16 v[68:71], a[8:11], a[32:35], v[68:71]
    v_mfma_f32_16x16x32_bf16 v[72:75], a[8:11], a[36:39], v[72:75]
    s_waitcnt vmcnt(4)
    s_waitcnt lgkmcnt(0)
    s_barrier
    v_mfma_f32_16x16x32_bf16 v[76:79], a[8:11], a[40:43], v[76:79]
    v_mfma_f32_16x16x32_bf16 v[80:83], a[8:11], a[44:47], v[80:83]
    v_mfma_f32_16x16x32_bf16 v[36:39], a[16:19], a[48:51], v[36:39]
    v_add_u32 v11, 67584, v18
    v_add_u32 v12, 84480, v18
    s_add_u32 s60, s63, 286720
    s_add_u32 m0, s65, 0
    s_nop 0
    buffer_load_dwordx4 v0, s[28:31], s60 offen lds
    v_mfma_f32_16x16x32_bf16 v[40:43], a[16:19], a[52:55], v[40:43]
    ds_read_b128 a[32:35], v15 offset:32768
    ds_read_b128 a[36:39], v15 offset:39936
    v_mfma_f32_16x16x32_bf16 v[44:47], a[16:19], a[56:59], v[44:47]
    ds_read_b128 a[40:43], v15 offset:47104
    ds_read_b128 a[44:47], v15 offset:54272
    v_mfma_f32_16x16x32_bf16 v[48:51], a[16:19], a[60:63], v[48:51]
    ds_read_b64_tr_b16 a[0:1], v11 offset:0
    s_add_u32 s60, s60, 896
    s_add_u32 m0, m0, 1056
    s_nop 0
    buffer_load_dwordx4 v0, s[28:31], s60 offen lds
    v_mfma_f32_16x16x32_bf16 v[52:55], a[20:23], a[48:51], v[52:55]
    ds_read_b64_tr_b16 a[2:3], v12 offset:0
    ds_read_b64_tr_b16 a[4:5], v11 offset:32
    v_mfma_f32_16x16x32_bf16 v[56:59], a[20:23], a[52:55], v[56:59]
    ds_read_b64_tr_b16 a[6:7], v12 offset:32
    ds_read_b64_tr_b16 a[8:9], v11 offset:64
    s_add_u32 s60, s63, 301056
    s_add_u32 m0, s65, 16896
    s_nop 0
    buffer_load_dwordx4 v0, s[28:31], s60 offen lds
    v_mfma_f32_16x16x32_bf16 v[60:63], a[20:23], a[56:59], v[60:63]
    ds_read_b64_tr_b16 a[10:11], v12 offset:64
    v_mfma_f32_16x16x32_bf16 v[64:67], a[20:23], a[60:63], v[64:67]
    s_add_u32 s60, s60, 896
    s_add_u32 m0, m0, 1056
    s_nop 0
    buffer_load_dwordx4 v0, s[28:31], s60 offen lds
    v_mfma_f32_16x16x32_bf16 v[68:71], a[24:27], a[48:51], v[68:71]
    v_mfma_f32_16x16x32_bf16 v[72:75], a[24:27], a[52:55], v[72:75]
    s_waitcnt vmcnt(4)
    s_waitcnt lgkmcnt(0)
    s_barrier
    v_mfma_f32_16x16x32_bf16 v[76:79], a[24:27], a[56:59], v[76:79]
    v_mfma_f32_16x16x32_bf16 v[80:83], a[24:27], a[60:63], v[80:83]
    s_cmp_ge_u32 s40, 6
    s_cbranch_scc0 L_of1_2
    ds_write_b128 v20, v[152:155] offset:3072
    ds_write_b128 v20, v[156:159] offset:11264
L_of1_2:
    v_mfma_f32_16x16x32_bf16 v[36:39], a[0:3], a[32:35], v[36:39]
    v_add_u32 v11, 33792, v18
    v_add_u32 v12, 50688, v18
    s_add_u32 s60, s63, 315392
    s_add_u32 m0, s65, 67584
    s_nop 0
    buffer_load_dwordx4 v0, s[28:31], s60 offen lds
    v_mfma_f32_16x16x32_bf16 v[40:43], a[0:3], a[36:39], v[40:43]
    ds_read_b128 a[48:51], v15 offset:33792
    ds_read_b128 a[52:55], v15 offset:40960
    v_mfma_f32_16x16x32_bf16 v[44:47], a[0:3], a[40:43], v[44:47]
    ds_read_b128 a[56:59], v15 offset:48128
    ds_read_b128 a[60:63], v15 offset:55296
    v_mfma_f32_16x16x32_bf16 v[48:51], a[0:3], a[44:47], v[48:51]
    ds_read_b64_tr_b16 a[16:17], v11 offset:0
    s_add_u32 s60, s60, 896
    s_add_u32 m0, m0, 1056
    s_nop 0
    buffer_load_dwordx4 v0, s[28:31], s60 offen lds
    v_mfma_f32_16x16x32_bf16 v[52:55], a[4:7], a[32:35], v[52:55]
    ds_read_b64_tr_b16 a[18:19], v12 offset:0
    ds_read_b64_tr_b16 a[20:21], v11 offset:32
    v_mfma_f32_16x16x32_bf16 v[56:59], a[4:7], a[36:39], v[56:59]
    ds_read_b64_tr_b16 a[22:23], v12 offset:32
    ds_read_b64_tr_b16 a[24:25], v11 offset:64
    s_add_u32 s60, s63, 329728
    s_add_u32 m0, s65, 84480
    s_nop 0
    buffer_load_dwordx4 v0, s[28:31], s60 offen lds
    v_mfma_f32_16x16x32_bf16 v[60:63], a[4:7], a[40:43], v[60:63]
    ds_read_b64_tr_b16 a[26:27], v12 offset:64
    v_mfma_f32_16x16x32_bf16 v[64:67], a[4:7], a[44:47], v[64:67]
    s_add_u32 s60, s60, 896
    s_add_u32 m0, m0, 1056
    s_nop 0
    buffer_load_dwordx4 v0, s[28:31], s60 offen lds
    v_mfma_f32_16x16x32_bf16 v[68:71], a[8:11], a[32:35], v[68:71]
    v_mfma_f32_16x16x32_bf16 v[72:75], a[8:11], a[36:39], v[72:75]
    s_waitcnt vmcnt(4)
    s_waitcnt lgkmcnt(0)
    s_barrier
    v_mfma_f32_16x16x32_bf16 v[76:79], a[8:11], a[40:43], v[76:79]
    v_mfma_f32_16x16x32_bf16 v[80:83], a[8:11], a[44:47], v[80:83]
    v_mfma_f32_16x16x32_bf16 v[36:39], a[16:19], a[48:51], v[36:39]
    v_add_u32 v11, 0, v18
    v_add_u32 v12, 16896, v18
    s_add_u32 s60, s63, 344064
    s_add_u32 m0, s65, 33792
    s_nop 0
    buffer_load_dwordx4 v0, s[28:31], s60 offen lds
    v_mfma_f32_16x16x32_bf16 v[40:43], a[16:19], a[52:55], v[40:43]
    ds_read_b128 a[32:35], v15 offset:34816
    ds_read_b128 a[36:39], v15 offset:41984
    v_mfma_f32_16x16x32_bf16 v[44:47], a[16:19], a[56:59], v[44:47]
    ds_read_b128 a[40:43], v15 offset:49152
    ds_read_b128 a[44:47], v15 offset:56320
    v_mfma_f32_16x16x32_bf16 v[48:51], a[16:19], a[60:63], v[48:51]
    ds_read_b64_tr_b16 a[0:1], v11 offset:0
    s_add_u32 s60, s60, 896
    s_add_u32 m0, m0, 1056
    s_nop 0
    buffer_load_dwordx4 v0, s[28:31], s60 offen lds
    v_mfma_f32_16x16x32_bf16 v[52:55], a[20:23], a[48:51], v[52:55]
    ds_read_b64_tr_b16 a[2:3], v12 offset:0
    ds_read_b64_tr_b16 a[4:5], v11 offset:32
    v_mfma_f32_16x16x32_bf16 v[56:59], a[20:23], a[52:55], v[56:59]
    ds_read_b64_tr_b16 a[6:7], v12 offset:32
    ds_read_b64_tr_b16 a[8:9], v11 offset:64
    s_add_u32 s60, s63, 358400
    s_add_u32 m0, s65, 50688
    s_nop 0
    buffer_load_dwordx4 v0, s[28:31], s60 offen lds
    v_mfma_f32_16x16x32_bf16 v[60:63], a[20:23], a[56:59], v[60:63]
    ds_read_b64_tr_b16 a[10:11], v12 offset:64
    v_mfma_f32_16x16x32_bf16 v[64:67], a[20:23], a[60:63], v[64:67]
    s_add_u32 s60, s60, 896
    s_add_u32 m0, m0, 1056
    s_nop 0
    buffer_load_dwordx4 v0, s[28:31], s60 offen lds
    v_mfma_f32_16x16x32_bf16 v[68:71], a[24:27], a[48:51], v[68:71]
    v_mfma_f32_16x16x32_bf16 v[72:75], a[24:27], a[52:55], v[72:75]
    s_waitcnt vmcnt(4)
    s_waitcnt lgkmcnt(0)
    s_barrier
    v_mfma_f32_16x16x32_bf16 v[76:79], a[24:27], a[56:59], v[76:79]
    v_mfma_f32_16x16x32_bf16 v[80:83], a[24:27], a[60:63], v[80:83]
    v_mfma_f32_16x16x32_bf16 v[36:39], a[0:3], a[32:35], v[36:39]
    v_add_u32 v11, 67584, v18
    v_add_u32 v12, 84480, v18
    s_add_u32 s60, s63, 372736
    s_add_u32 m0, s65, 0
    s_nop 0
    buffer_load_dwordx4 v0, s[28:31], s60 offen lds
    v_mfma_f32_16x16x32_bf16 v[40:43], a[0:3], a[36:39], v[40:43]
    ds_read_b128 a[48:51], v15 offset:35840
    ds_read_b128 a[52:55], v15 offset:43008
    v_mfma_f32_16x16x32_bf16 v[44:47], a[0:3], a[40:43], v[44:47]
    ds_read_b128 a[56:59], v15 offset:50176
    ds_read_b128 a[60:63], v15 offset:57344
    v_mfma_f32_16x16x32_bf16 v[48:51], a[0:3], a[44:47], v[48:51]
    ds_read_b64_tr_b16 a[16:17], v11 offset:0
    s_add_u32 s60, s60, 896
    s_add_u32 m0, m0, 1056
    s_nop 0
    buffer_load_dwordx4 v0, s[28:31], s60 offen lds
    v_mfma_f32_16x16x32_bf16 v[52:55], a[4:7], a[32:35], v[52:55]
    ds_read_b64_tr_b16 a[18:19], v12 offset:0
    ds_read_b64_tr_b16 a[20:21], v11 offset:32
    v_mfma_f32_16x16x32_bf16 v[56:59], a[4:7], a[36:39], v[56:59]
    ds_read_b64_tr_b16 a[22:23], v12 offset:32
    ds_read_b64_tr_b16 a[24:25], v11 offset:64
    s_add_u32 s60, s63, 387072
    s_add_u32 m0, s65, 16896
    s_nop 0
    buffer_load_dwordx4 v0, s[28:31], s60 offen lds
    v_mfma_f32_16x16x32_bf16 v[60:63], a[4:7], a[40:43], v[60:63]
    ds_read_b64_tr_b16 a[26:27], v12 offset:64
    v_mfma_f32_16x16x32_bf16 v[64:67], a[4:7], a[44:47], v[64:67]
    s_add_u32 s60, s60, 896
    s_add_u32 m0, m0, 1056
    s_nop 0
    buffer_load_dwordx4 v0, s[28:31], s60 offen lds
    v_mfma_f32_16x16x32_bf16 v[68:71], a[8:11], a[32:35], v[68:71]
    v_mfma_f32_16x16x32_bf16 v[72:75], a[8:11], a[36:39], v[72:75]
    s_waitcnt vmcnt(4)
    s_waitcnt lgkmcnt(0)
    s_barrier
    v_mfma_f32_16x16x32_bf16 v[76:79], a[8:11], a[40:43], v[76:79]
    v_mfma_f32_16x16x32_bf16 v[80:83], a[8:11], a[44:47], v[80:83]
    v_mfma_f32_16x16x32_bf16 v[36:39], a[16:19], a[48:51], v[36:39]
    v_add_u32 v11, 33792, v18
    v_add_u32 v12, 50688, v18
    s_add_u32 s60, s63, 401408
    s_add_u32 m0, s65, 67584
    s_nop 0
    buffer_load_dwordx4 v0, s[28:31], s60 offen lds
    v_mfma_f32_16x16x32_bf16 v[40:43], a[16:19], a[52:55], v[40:43]
    ds_read_b128 a[32:35], v15 offset:36864
    ds_read_b128 a[36:39], v15 offset:44032
    v_mfma_f32_16x16x32_bf16 v[44:47], a[16:19], a[56:59], v[44:47]
    ds_read_b128 a[40:43], v15 offset:51200
    ds_read_b128 a[44:47], v15 offset:58368
    v_mfma_f32_16x16x32_bf16 v[48:51], a[16:19], a[60:63], v[48:51]
    ds_read_b64_tr_b16 a[0:1], v11 offset:0
    s_add_u32 s60, s60, 896
    s_add_u32 m0, m0, 1056
    s_nop 0
    buffer_load_dwordx4 v0, s[28:31], s60 offen lds
    v_mfma_f32_16x16x32_bf16 v[52:55], a[20:23], a[48:51], v[52:55]
    ds_read_b64_tr_b16 a[2:3], v12 offset:0
    ds_read_b64_tr_b16 a[4:5], v11 offset:32
    v_mfma_f32_16x16x32_bf16 v[56:59], a[20:23], a[52:55], v[56:59]
    ds_read_b64_tr_b16 a[6:7], v12 offset:32
    ds_read_b64_tr_b16 a[8:9], v11 offset:64
    s_add_u32 s60, s63, 415744
    s_add_u32 m0, s65, 84480
    s_nop 0
    buffer_load_dwordx4 v0, s[28:31], s60 offen lds
    v_mfma_f32_16x16x32_bf16 v[60:63], a[20:23], a[56:59], v[60:63]
    ds_read_b64_tr_b16 a[10:11], v12 offset:64
    v_mfma_f32_16x16x32_bf16 v[64:67], a[20:23], a[60:63], v[64:67]
    s_add_u32 s60, s60, 896
    s_add_u32 m0, m0, 1056
    s_nop 0
    buffer_load_dwordx4 v0, s[28:31], s60 offen lds
    v_mfma_f32_16x16x32_bf16 v[68:71], a[24:27], a[48:51], v[68:71]
    v_mfma_f32_16x16x32_bf16 v[72:75], a[24:27], a[52:55], v[72:75]
    s_waitcnt vmcnt(4)
    s_waitcnt lgkmcnt(0)
    s_barrier
    v_mfma_f32_16x16x32_bf16 v[76:79], a[24:27], a[56:59], v[76:79]
    v_mfma_f32_16x16x32_bf16 v[80:83], a[24:27], a[60:63], v[80:83]
    v_mfma_f32_16x16x32_bf16 v[36:39], a[0:3], a[32:35], v[36:39]
    v_add_u32 v11, 0, v18
    v_add_u32 v12, 16896, v18
    s_add_u32 s60, s63, 430080
    s_add_u32 m0, s65, 33792
    s_nop 0
    buffer_load_dwordx4 v0, s[28:31], s60 offen lds
    v_mfma_f32_16x16x32_bf16 v[40:43], a[0:3], a[36:39], v[40:43]
    ds_read_b128 a[48:51], v15 offset:37888
    ds_read_b128 a[52:55], v15 offset:45056
    v_mfma_f32_16x16x32_bf16 v[44:47], a[0:3], a[40:43], v[44:47]
    ds_read_b128 a[56:59], v15 offset:52224
    ds_read_b128 a[60:63], v15 offset:59392
    v_mfma_f32_16x16x32_bf16 v[48:51], a[0:3], a[44:47], v[48:51]
    ds_read_b64_tr_b16 a[16:17], v11 offset:0
    s_add_u32 s60, s60, 896
    s_add_u32 m0, m0, 1056
    s_nop 0
    buffer_load_dwordx4 v0, s[28:31], s60 offen lds
    v_mfma_f32_16x16x32_bf16 v[52:55], a[4:7], a[32:35], v[52:55]
    ds_read_b64_tr_b16 a[18:19], v12 offset:0
    ds_read_b64_tr_b16 a[20:21], v11 offset:32
    v_mfma_f32_16x16x32_bf16 v[56:59], a[4:7], a[36:39], v[56:59]
    ds_read_b64_tr_b16 a[22:23], v12 offset:32
    ds_read_b64_tr_b16 a[24:25], v11 offset:64
    s_add_u32 s60, s63, 444416
    s_add_u32 m0, s65, 50688
    s_nop 0
    buffer_load_dwordx4 v0, s[28:31], s60 offen lds
    v_mfma_f32_16x16x32_bf16 v[60:63], a[4:7], a[40:43], v[60:63]
    ds_read_b64_tr_b16 a[26:27], v12 offset:64
    v_mfma_f32_16x16x32_bf16 v[64:67], a[4:7], a[44:47], v[64:67]
    s_add_u32 s60, s60, 896
    s_add_u32 m0, m0, 1056
    s_nop 0
    buffer_load_dwordx4 v0, s[28:31], s60 offen lds
    v_mfma_f32_16x16x32_bf16 v[68:71], a[8:11], a[32:35], v[68:71]
    v_mfma_f32_16x16x32_bf16 v[72:75], a[8:11], a[36:39], v[72:75]
    s_waitcnt vmcnt(4)
    s_waitcnt lgkmcnt(0)
    s_barrier
    v_mfma_f32_16x16x32_bf16 v[76:79], a[8:11], a[40:43], v[76:79]
    v_mfma_f32_16x16x32_bf16 v[80:83], a[8:11], a[44:47], v[80:83]
    s_waitcnt lgkmcnt(0)
    s_mul_i32 s54, s42, 57344
    s_add_u32 s8, s98, s54
    s_addc_u32 s9, s99, 0
    s_mov_b32 s10, 57344
    s_mov_b32 s11, 0x00020000
    s_mov_b32 s12, s96
    s_mov_b32 s13, s97
    s_mov_b32 s14, 896
    s_mov_b32 s15, 0x00020000
    s_mul_i32 s54, s41, 7
    s_add_u32 s54, s54, s40
    s_lshl_b32 s54, s54, 10
    s_mul_i32 s55, s42, 57344
    s_add_u32 s70, s54, s55
    s_mul_i32 s56, s41, 7
    s_add_u32 s56, s56, s40
    s_lshr_b32 s54, s56, 1
    s_lshl_b32 s54, s54, 5
    v_lshlrev_b32 v5, 3, v3
    v_add_u32 v14, s54, v5
    s_and_b32 s54, s56, 1
    s_lshl_b32 s54, s54, 5
    v_add_u32 v6, s54, v2
    v_mul_u32_u24 v6, 896, v6
    v_add_u32 v17, v6, v14
    v_add_u32 v19, 14336, v17
    s_add_u32 s54, s70, 0
    buffer_load_dwordx4 v[100:103], v9, s[36:39], s54 offen sc1
    s_add_u32 s54, s70, 1835008
    buffer_load_dwordx4 v[104:107], v9, s[36:39], s54 offen sc1
    s_add_u32 s54, s70, 3670016
    buffer_load_dwordx4 v[108:111], v9, s[36:39], s54 offen sc1
    buffer_load_dwordx2 v[28:29], v17, s[4:7], 0 offen
    v_mfma_f32_16x16x32_bf16 v[36:39], a[16:19], a[48:51], v[36:39]
    v_add_u32 v11, 67584, v18
    v_add_u32 v12, 84480, v18
    v_mfma_f32_16x16x32_bf16 v[40:43], a[16:19], a[52:55], v[40:43]
    ds_read_b128 a[32:35], v15 offset:38912
    ds_read_b128 a[36:39], v15 offset:46080
    v_mfma_f32_16x16x32_bf16 v[44:47], a[16:19], a[56:59], v[44:47]
    ds_read_b128 a[40:43], v15 offset:53248
    ds_read_b128 a[44:47], v15 offset:60416
    v_mfma_f32_16x16x32_bf16 v[48:51], a[16:19], a[60:63], v[48:51]
    ds_read_b64_tr_b16 a[0:1], v11 offset:0
    v_mfma_f32_16x16x32_bf16 v[52:55], a[20:23], a[48:51], v[52:55]
    ds_read_b64_tr_b16 a[2:3], v12 offset:0
    ds_read_b64_tr_b16 a[4:5], v11 offset:32
    v_mfma_f32_16x16x32_bf16 v[56:59], a[20:23], a[52:55], v[56:59]
    ds_read_b64_tr_b16 a[6:7], v12 offset:32
    ds_read_b64_tr_b16 a[8:9], v11 offset:64
    v_mfma_f32_16x16x32_bf16 v[60:63], a[20:23], a[56:59], v[60:63]
    ds_read_b64_tr_b16 a[10:11], v12 offset:64
    v_mfma_f32_16x16x32_bf16 v[64:67], a[20:23], a[60:63], v[64:67]
    v_mfma_f32_16x16x32_bf16 v[68:71], a[24:27], a[48:51], v[68:71]
    v_mfma_f32_16x16x32_bf16 v[72:75], a[24:27], a[52:55], v[72:75]
    s_waitcnt vmcnt(4)
    s_waitcnt lgkmcnt(0)
    s_barrier
    v_mfma_f32_16x16x32_bf16 v[76:79], a[24:27], a[56:59], v[76:79]
    v_mfma_f32_16x16x32_bf16 v[80:83], a[24:27], a[60:63], v[80:83]
    s_add_u32 s54, s70, 5505024
    buffer_load_dwordx4 v[112:115], v9, s[36:39], s54 offen sc1
    s_add_u32 s54, s70, 7340032
    buffer_load_dwordx4 v[116:119], v9, s[36:39], s54 offen sc1
    s_add_u32 s54, s70, 9175040
    buffer_load_dwordx4 v[120:123], v9, s[36:39], s54 offen sc1
    buffer_load_dwordx2 v[30:31], v19, s[4:7], 0 offen
    v_mfma_f32_16x16x32_bf16 v[36:39], a[0:3], a[32:35], v[36:39]
    v_add_u32 v11, 33792, v18
    v_add_u32 v12, 50688, v18
    v_mfma_f32_16x16x32_bf16 v[40:43], a[0:3], a[36:39], v[40:43]
    ds_read_b128 a[48:51], v15 offset:7168
    ds_read_b128 a[52:55], v15 offset:15360
    v_mfma_f32_16x16x32_bf16 v[44:47], a[0:3], a[40:43], v[44:47]
    ds_read_b128 a[56:59], v15 offset:23552
    ds_read_b128 a[60:63], v15 offset:31744
    v_mfma_f32_16x16x32_bf16 v[48:51], a[0:3], a[44:47], v[48:51]
    ds_read_b64_tr_b16 a[16:17], v11 offset:0
    v_mfma_f32_16x16x32_bf16 v[52:55], a[4:7], a[32:35], v[52:55]
    ds_read_b64_tr_b16 a[18:19], v12 offset:0
    ds_read_b64_tr_b16 a[20:21], v11 offset:32
    v_mfma_f32_16x16x32_bf16 v[56:59], a[4:7], a[36:39], v[56:59]
    ds_read_b64_tr_b16 a[22:23], v12 offset:32
    ds_read_b64_tr_b16 a[24:25], v11 offset:64
    v_mfma_f32_16x16x32_bf16 v[60:63], a[4:7], a[40:43], v[60:63]
    ds_read_b64_tr_b16 a[26:27], v12 offset:64
    v_mfma_f32_16x16x32_bf16 v[64:67], a[4:7], a[44:47], v[64:67]
    v_mfma_f32_16x16x32_bf16 v[68:71], a[8:11], a[32:35], v[68:71]
    v_mfma_f32_16x16x32_bf16 v[72:75], a[8:11], a[36:39], v[72:75]
    s_waitcnt lgkmcnt(0)
    s_barrier
    v_mfma_f32_16x16x32_bf16 v[76:79], a[8:11], a[40:43], v[76:79]
    v_mfma_f32_16x16x32_bf16 v[80:83], a[8:11], a[44:47], v[80:83]
    s_add_u32 s54, s70, 11010048
    buffer_load_dwordx4 v[124:127], v9, s[36:39], s54 offen sc1
    s_add_u32 s54, s70, 12845056
    buffer_load_dwordx4 v[24:27], v9, s[36:39], s54 offen sc1
    buffer_load_dwordx2 v[32:33], v14, s[12:15], 0 offen
    v_mfma_f32_16x16x32_bf16 v[36:39], a[16:19], a[48:51], v[36:39]
    v_mfma_f32_16x16x32_bf16 v[40:43], a[16:19], a[52:55], v[40:43]
    v_mfma_f32_16x16x32_bf16 v[44:47], a[16:19], a[56:59], v[44:47]
    v_mfma_f32_16x16x32_bf16 v[48:51], a[16:19], a[60:63], v[48:51]
    v_mfma_f32_16x16x32_bf16 v[52:55], a[20:23], a[48:51], v[52:55]
    v_mfma_f32_16x16x32_bf16 v[56:59], a[20:23], a[52:55], v[56:59]
    v_mfma_f32_16x16x32_bf16 v[60:63], a[20:23], a[56:59], v[60:63]
    v_mfma_f32_16x16x32_bf16 v[64:67], a[20:23], a[60:63], v[64:67]
    v_mfma_f32_16x16x32_bf16 v[68:71], a[24:27], a[48:51], v[68:71]
    v_mfma_f32_16x16x32_bf16 v[72:75], a[24:27], a[52:55], v[72:75]
    v_mfma_f32_16x16x32_bf16 v[76:79], a[24:27], a[56:59], v[76:79]
    v_mfma_f32_16x16x32_bf16 v[80:83], a[24:27], a[60:63], v[80:83]
    s_lshl_b32 s54, s41, 5
    s_add_u32 s54, s54, s42
    s_mul_i32 s54, s54, 57344
    s_add_u32 s54, s54, s71
    s_add_u32 s54, s54, 16777216
    s_nop 7
    v_cvt_pk_bf16_f32 v128, v36, v37
    v_cvt_pk_bf16_f32 v129, v38, v39
    v_cvt_pk_bf16_f32 v130, v40, v41
    v_cvt_pk_bf16_f32 v131, v42, v43
    v_cvt_pk_bf16_f32 v132, v44, v45
    v_cvt_pk_bf16_f32 v133, v46, v47
    v_cvt_pk_bf16_f32 v134, v48, v49
    v_cvt_pk_bf16_f32 v135, v50, v51
    v_cvt_pk_bf16_f32 v136, v52, v53
    v_cvt_pk_bf16_f32 v137, v54, v55
    v_cvt_pk_bf16_f32 v138, v56, v57
    v_cvt_pk_bf16_f32 v139, v58, v59
    v_cvt_pk_bf16_f32 v140, v60, v61
    v_cvt_pk_bf16_f32 v141, v62, v63
    v_cvt_pk_bf16_f32 v142, v64, v65
    v_cvt_pk_bf16_f32 v143, v66, v67
    v_cvt_pk_bf16_f32 v144, v68, v69
    v_cvt_pk_bf16_f32 v145, v70, v71
    v_cvt_pk_bf16_f32 v146, v72, v73
    v_cvt_pk_bf16_f32 v147, v74, v75
    v_cvt_pk_bf16_f32 v148, v76, v77
    v_cvt_pk_bf16_f32 v149, v78, v79
    v_cvt_pk_bf16_f32 v150, v80, v81
    v_cvt_pk_bf16_f32 v151, v82, v83
    buffer_store_dwordx4 v[128:131], v9, s[36:39], s54 offen offset:0 sc1
    buffer_store_dwordx4 v[132:135], v9, s[36:39], s54 offen offset:1024 sc1
    buffer_store_dwordx4 v[136:139], v9, s[36:39], s54 offen offset:2048 sc1
    buffer_store_dwordx4 v[140:143], v9, s[36:39], s54 offen offset:3072 sc1
    s_add_u32 s54, s54, 4096
    buffer_store_dwordx4 v[144:147], v9, s[36:39], s54 offen offset:0 sc1
    buffer_store_dwordx4 v[148:151], v9, s[36:39], s54 offen offset:1024 sc1
L_opD:
    s_waitcnt vmcnt(6)
    v_lshlrev_b32 v36, 16, v100
    v_and_b32 v37, 0xffff0000, v100
    v_lshlrev_b32 v38, 16, v101
    v_and_b32 v39, 0xffff0000, v101
    v_lshlrev_b32 v40, 16, v102
    v_and_b32 v41, 0xffff0000, v102
    v_lshlrev_b32 v42, 16, v103
    v_and_b32 v43, 0xffff0000, v103
    v_lshlrev_b32 v84, 16, v104
    v_and_b32 v85, 0xffff0000, v104
    v_pk_add_f32 v[36:37], v[36:37], v[84:85]
    v_lshlrev_b32 v86, 16, v105
    v_and_b32 v87, 0xffff0000, v105
    v_pk_add_f32 v[38:39], v[38:39], v[86:87]
    v_lshlrev_b32 v84, 16, v106
    v_and_b32 v85, 0xffff0000, v106
    v_pk_add_f32 v[40:41], v[40:41], v[84:85]
    v_lshlrev_b32 v86, 16, v107
    v_and_b32 v87, 0xffff0000, v107
    v_pk_add_f32 v[42:43], v[42:43], v[86:87]
    v_lshlrev_b32 v84, 16, v108
    v_and_b32 v85, 0xffff0000, v108
    v_pk_add_f32 v[36:37], v[36:37], v[84:85]
    v_lshlrev_b32 v86, 16, v109
    v_and_b32 v87, 0xffff0000, v109
    v_pk_add_f32 v[38:39], v[38:39], v[86:87]
    v_lshlrev_b32 v84, 16, v110
    v_and_b32 v85, 0xffff0000, v110
    v_pk_add_f32 v[40:41], v[40:41], v[84:85]
    v_lshlrev_b32 v86, 16, v111
    v_and_b32 v87, 0xffff0000, v111
    v_pk_add_f32 v[42:43], v[42:43], v[86:87]
    v_lshlrev_b32 v84, 16, v112
    v_and_b32 v85, 0xffff0000, v112
    v_pk_add_f32 v[36:37], v[36:37], v[84:85]
    v_lshlrev_b32 v86, 16, v113
    v_and_b32 v87, 0xffff0000, v113
    v_pk_add_f32 v[38:39], v[38:39], v[86:87]
    v_lshlrev_b32 v84, 16, v114
    v_and_b32 v85, 0xffff0000, v114
    v_pk_add_f32 v[40:41], v[40:41], v[84:85]
    v_lshlrev_b32 v86, 16, v115
    v_and_b32 v87, 0xffff0000, v115
    v_pk_add_f32 v[42:43], v[42:43], v[86:87]
    v_lshlrev_b32 v84, 16, v116
    v_and_b32 v85, 0xffff0000, v116
    v_pk_add_f32 v[36:37], v[36:37], v[84:85]
    v_lshlrev_b32 v86, 16, v117
    v_and_b32 v87, 0xffff0000, v117
    v_pk_add_f32 v[38:39], v[38:39], v[86:87]
    v_lshlrev_b32 v84, 16, v118
    v_and_b32 v85, 0xffff0000, v118
    v_pk_add_f32 v[40:41], v[40:41], v[84:85]
    v_lshlrev_b32 v86, 16, v119
    v_and_b32 v87, 0xffff0000, v119
    v_pk_add_f32 v[42:43], v[42:43], v[86:87]
    v_lshlrev_b32 v84, 16, v120
    v_and_b32 v85, 0xffff0000, v120
    v_pk_add_f32 v[36:37], v[36:37], v[84:85]
    v_lshlrev_b32 v86, 16, v121
    v_and_b32 v87, 0xffff0000, v121
    v_pk_add_f32 v[38:39], v[38:39], v[86:87]
    v_lshlrev_b32 v84, 16, v122
    v_and_b32 v85, 0xffff0000, v122
    v_pk_add_f32 v[40:41], v[40:41], v[84:85]
    v_lshlrev_b32 v86, 16, v123
    v_and_b32 v87, 0xffff0000, v123
    v_pk_add_f32 v[42:43], v[42:43], v[86:87]
    v_lshlrev_b32 v84, 16, v124
    v_and_b32 v85, 0xffff0000, v124
    v_pk_add_f32 v[36:37], v[36:37], v[84:85]
    v_lshlrev_b32 v86, 16, v125
    v_and_b32 v87, 0xffff0000, v125
    v_pk_add_f32 v[38:39], v[38:39], v[86:87]
    v_lshlrev_b32 v84, 16, v126
    v_and_b32 v85, 0xffff0000, v126
    v_pk_add_f32 v[40:41], v[40:41], v[84:85]
    v_lshlrev_b32 v86, 16, v127
    v_and_b32 v87, 0xffff0000, v127
    v_pk_add_f32 v[42:43], v[42:43], v[86:87]
    v_lshlrev_b32 v84, 16, v24
    v_and_b32 v85, 0xffff0000, v24
    v_pk_add_f32 v[36:37], v[36:37], v[84:85]
    v_lshlrev_b32 v86, 16, v25
    v_and_b32 v87, 0xffff0000, v25
    v_pk_add_f32 v[38:39], v[38:39], v[86:87]
    v_lshlrev_b32 v84, 16, v26
    v_and_b32 v85, 0xffff0000, v26
    v_pk_add_f32 v[40:41], v[40:41], v[84:85]
    v_lshlrev_b32 v86, 16, v27
    v_and_b32 v87, 0xffff0000, v27
    v_pk_add_f32 v[42:43], v[42:43], v[86:87]
    v_lshlrev_b32 v44, 16, v32
    v_and_b32 v45, 0xffff0000, v32
    v_lshlrev_b32 v46, 16, v33
    v_and_b32 v47, 0xffff0000, v33
    v_lshlrev_b32 v48, 16, v28
    v_and_b32 v49, 0xffff0000, v28
    v_lshlrev_b32 v50, 16, v29
    v_and_b32 v51, 0xffff0000, v29
    v_lshlrev_b32 v52, 16, v30
    v_and_b32 v53, 0xffff0000, v30
    v_lshlrev_b32 v54, 16, v31
    v_and_b32 v55, 0xffff0000, v31
    s_mov_b32 s56, 0xbfb8aa3b
    v_cvt_pk_bf16_f32 v36, v36, v36
    v_and_b32 v36, 0xffff0000, v36
    v_add_f32 v36, v36, v44
    v_cvt_pk_bf16_f32 v36, v36, v36
    v_and_b32 v36, 0xffff0000, v36
    v_mul_f32 v84, s56, v36
    v_exp_f32 v84, v84
    s_nop 0
    v_add_f32 v84, 1.0, v84
    v_rcp_f32 v84, v84
    s_nop 0
    v_mul_f32 v36, v36, v84
    v_cvt_pk_bf16_f32 v36, v36, v36
    v_and_b32 v36, 0xffff0000, v36
    v_cvt_pk_bf16_f32 v37, v37, v37
    v_and_b32 v37, 0xffff0000, v37
    v_add_f32 v37, v37, v45
    v_cvt_pk_bf16_f32 v37, v37, v37
    v_and_b32 v37, 0xffff0000, v37
    v_mul_f32 v84, s56, v37
    v_exp_f32 v84, v84
    s_nop 0
    v_add_f32 v84, 1.0, v84
    v_rcp_f32 v84, v84
    s_nop 0
    v_mul_f32 v37, v37, v84
    v_cvt_pk_bf16_f32 v37, v37, v37
    v_and_b32 v37, 0xffff0000, v37
    v_cvt_pk_bf16_f32 v38, v38, v38
    v_and_b32 v38, 0xffff0000, v38
    v_add_f32 v38, v38, v46
    v_cvt_pk_bf16_f32 v38, v38, v38
    v_and_b32 v38, 0xffff0000, v38
    v_mul_f32 v84, s56, v38
    v_exp_f32 v84, v84
    s_nop 0
    v_add_f32 v84, 1.0, v84
    v_rcp_f32 v84, v84
    s_nop 0
    v_mul_f32 v38, v38, v84
    v_cvt_pk_bf16_f32 v38, v38, v38
    v_and_b32 v38, 0xffff0000, v38
    v_cvt_pk_bf16_f32 v39, v39, v39
    v_and_b32 v39, 0xffff0000, v39
    v_add_f32 v39, v39, v47
    v_cvt_pk_bf16_f32 v39, v39, v39
    v_and_b32 v39, 0xffff0000, v39
    v_mul_f32 v84, s56, v39
    v_exp_f32 v84, v84
    s_nop 0
    v_add_f32 v84, 1.0, v84
    v_rcp_f32 v84, v84
    s_nop 0
    v_mul_f32 v39, v39, v84
    v_cvt_pk_bf16_f32 v39, v39, v39
    v_and_b32 v39, 0xffff0000, v39
    v_cvt_pk_bf16_f32 v40, v40, v40
    v_and_b32 v40, 0xffff0000, v40
    v_add_f32 v40, v40, v44
    v_cvt_pk_bf16_f32 v40, v40, v40
    v_and_b32 v40, 0xffff0000, v40
    v_mul_f32 v84, s56, v40
    v_exp_f32 v84, v84
    s_nop 0
    v_add_f32 v84, 1.0, v84
    v_rcp_f32 v84, v84
    s_nop 0
    v_mul_f32 v40, v40, v84
    v_cvt_pk_bf16_f32 v40, v40, v40
    v_and_b32 v40, 0xffff0000, v40
    v_cvt_pk_bf16_f32 v41, v41, v41
    v_and_b32 v41, 0xffff0000, v41
    v_add_f32 v41, v41, v45
    v_cvt_pk_bf16_f32 v41, v41, v41
    v_and_b32 v41, 0xffff0000, v41
    v_mul_f32 v84, s56, v41
    v_exp_f32 v84, v84
    s_nop 0
    v_add_f32 v84, 1.0, v84
    v_rcp_f32 v84, v84
    s_nop 0
    v_mul_f32 v41, v41, v84
    v_cvt_pk_bf16_f32 v41, v41, v41
    v_and_b32 v41, 0xffff0000, v41
    v_cvt_pk_bf16_f32 v42, v42, v42
    v_and_b32 v42, 0xffff0000, v42
    v_add_f32 v42, v42, v46
    v_cvt_pk_bf16_f32 v42, v42, v42
    v_and_b32 v42, 0xffff0000, v42
    v_mul_f32 v84, s56, v42
    v_exp_f32 v84, v84
    s_nop 0
    v_add_f32 v84, 1.0, v84
    v_rcp_f32 v84, v84
    s_nop 0
    v_mul_f32 v42, v42, v84
    v_cvt_pk_bf16_f32 v42, v42, v42
    v_and_b32 v42, 0xffff0000, v42
    v_cvt_pk_bf16_f32 v43, v43, v43
    v_and_b32 v43, 0xffff0000, v43
    v_add_f32 v43, v43, v47
    v_cvt_pk_bf16_f32 v43, v43, v43
    v_and_b32 v43, 0xffff0000, v43
    v_mul_f32 v84, s56, v43
    v_exp_f32 v84, v84
    s_nop 0
    v_add_f32 v84, 1.0, v84
    v_rcp_f32 v84, v84
    s_nop 0
    v_mul_f32 v43, v43, v84
    v_cvt_pk_bf16_f32 v43, v43, v43
    v_and_b32 v43, 0xffff0000, v43
    s_waitcnt vmcnt(0)
    s_lshl_b32 s54, s42, 3
    s_add_u32 s54, s54, s41
    s_lshl_b32 s54, s54, 3
    s_add_u32 s54, s54, s40
    s_lshl_b32 s54, s54, 7
    s_add_u32 s54, s54, 50331648
    v_mov_b32 v84, 0
    v_mov_b32 v85, 1
    v_lshlrev_b32 v87, 10, v1
    s_mov_b64 exec, 1
    buffer_store_dword v85, v84, s[36:39], s54 offen sc1
    s_mov_b64 exec, -1
    s_cmp_eq_u32 s40, 7
    s_cbranch_scc1 L_fdone
    s_mul_i32 s54, s41, 7
    s_add_u32 s54, s54, s40
    s_lshr_b32 s54, s54, 1
    s_mul_i32 s55, s54, 37
    s_lshr_b32 s55, s55, 8
    s_mul_i32 s56, s55, 7
    s_sub_u32 s56, s54, s56
    s_cmp_ge_u32 s56, 4
    s_cselect_b32 s56, 4, 0
    s_add_u32 s55, s55, s56
    s_lshl_b32 s58, s42, 6
    s_add_u32 s58, s58, s55
    s_lshl_b32 s58, s58, 7
    s_add_u32 s58, s58, 50331648
    s_mov_b64 exec, 0xff
    s_mov_b32 s59, 0
L_sp1:
    buffer_load_dword v86, v87, s[36:39], s58 offen sc1
    s_waitcnt vmcnt(0)
    v_cmp_eq_u32 vcc, 1, v86
    s_nop 4
    s_cmp_eq_u32 vcc_lo, 0xff
    s_cbranch_scc1 L_sp3
    s_add_u32 s59, s59, 1
    s_cmp_ge_u32 s59, 40000
    s_cbranch_scc1 L_sp3
    s_sleep 4
    s_branch L_sp1
L_sp3:
    s_mov_b64 exec, -1
    s_add_u32 s54, s70, 16777216
    buffer_load_dwordx4 v[92:95], v9, s[36:39], s54 offen sc1
    s_add_u32 s54, s70, 18612224
    buffer_load_dwordx4 v[96:99], v9, s[36:39], s54 offen sc1
    s_add_u32 s54, s70, 20447232
    buffer_load_dwordx4 v[100:103], v9, s[36:39], s54 offen sc1
    s_add_u32 s54, s70, 22282240
    buffer_load_dwordx4 v[104:107], v9, s[36:39], s54 offen sc1
    s_add_u32 s54, s70, 24117248
    buffer_load_dwordx4 v[108:111], v9, s[36:39], s54 offen sc1
    s_add_u32 s54, s70, 25952256
    buffer_load_dwordx4 v[112:115], v9, s[36:39], s54 offen sc1
    s_add_u32 s54, s70, 27787264
    buffer_load_dwordx4 v[116:119], v9, s[36:39], s54 offen sc1
    s_add_u32 s54, s70, 29622272
    buffer_load_dwordx4 v[120:123], v9, s[36:39], s54 offen sc1
    s_waitcnt vmcnt(7)
    v_lshlrev_b32 v56, 16, v92
    v_and_b32 v57, 0xffff0000, v92
    v_lshlrev_b32 v58, 16, v93
    v_and_b32 v59, 0xffff0000, v93
    v_lshlrev_b32 v60, 16, v94
    v_and_b32 v61, 0xffff0000, v94
    v_lshlrev_b32 v62, 16, v95
    v_and_b32 v63, 0xffff0000, v95
    s_waitcnt vmcnt(6)
    v_lshlrev_b32 v84, 16, v96
    v_and_b32 v85, 0xffff0000, v96
    v_pk_add_f32 v[56:57], v[56:57], v[84:85]
    v_lshlrev_b32 v86, 16, v97
    v_and_b32 v87, 0xffff0000, v97
    v_pk_add_f32 v[58:59], v[58:59], v[86:87]
    v_lshlrev_b32 v84, 16, v98
    v_and_b32 v85, 0xffff0000, v98
    v_pk_add_f32 v[60:61], v[60:61], v[84:85]
    v_lshlrev_b32 v86, 16, v99
    v_and_b32 v87, 0xffff0000, v99
    v_pk_add_f32 v[62:63], v[62:63], v[86:87]
    s_waitcnt vmcnt(5)
    v_lshlrev_b32 v84, 16, v100
    v_and_b32 v85, 0xffff0000, v100
    v_pk_add_f32 v[56:57], v[56:57], v[84:85]
    v_lshlrev_b32 v86, 16, v101
    v_and_b32 v87, 0xffff0000, v101
    v_pk_add_f32 v[58:59], v[58:59], v[86:87]
    v_lshlrev_b32 v84, 16, v102
    v_and_b32 v85, 0xffff0000, v102
    v_pk_add_f32 v[60:61], v[60:61], v[84:85]
    v_lshlrev_b32 v86, 16, v103
    v_and_b32 v87, 0xffff0000, v103
    v_pk_add_f32 v[62:63], v[62:63], v[86:87]
    s_waitcnt vmcnt(4)
    v_lshlrev_b32 v84, 16, v104
    v_and_b32 v85, 0xffff0000, v104
    v_pk_add_f32 v[56:57], v[56:57], v[84:85]
    v_lshlrev_b32 v86, 16, v105
    v_and_b32 v87, 0xffff0000, v105
    v_pk_add_f32 v[58:59], v[58:59], v[86:87]
    v_lshlrev_b32 v84, 16, v106
    v_and_b32 v85, 0xffff0000, v106
    v_pk_add_f32 v[60:61], v[60:61], v[84:85]
    v_lshlrev_b32 v86, 16, v107
    v_and_b32 v87, 0xffff0000, v107
    v_pk_add_f32 v[62:63], v[62:63], v[86:87]
    s_waitcnt vmcnt(3)
    v_lshlrev_b32 v84, 16, v108
    v_and_b32 v85, 0xffff0000, v108
    v_pk_add_f32 v[56:57], v[56:57], v[84:85]
    v_lshlrev_b32 v86, 16, v109
    v_and_b32 v87, 0xffff0000, v109
    v_pk_add_f32 v[58:59], v[58:59], v[86:87]
    v_lshlrev_b32 v84, 16, v110
    v_and_b32 v85, 0xffff0000, v110
    v_pk_add_f32 v[60:61], v[60:61], v[84:85]
    v_lshlrev_b32 v86, 16, v111
    v_and_b32 v87, 0xffff0000, v111
    v_pk_add_f32 v[62:63], v[62:63], v[86:87]
    s_waitcnt vmcnt(2)
    v_lshlrev_b32 v84, 16, v112
    v_and_b32 v85, 0xffff0000, v112
    v_pk_add_f32 v[56:57], v[56:57], v[84:85]
    v_lshlrev_b32 v86, 16, v113
    v_and_b32 v87, 0xffff0000, v113
    v_pk_add_f32 v[58:59], v[58:59], v[86:87]
    v_lshlrev_b32 v84, 16, v114
    v_and_b32 v85, 0xffff0000, v114
    v_pk_add_f32 v[60:61], v[60:61], v[84:85]
    v_lshlrev_b32 v86, 16, v115
    v_and_b32 v87, 0xffff0000, v115
    v_pk_add_f32 v[62:63], v[62:63], v[86:87]
    s_waitcnt vmcnt(1)
    v_lshlrev_b32 v84, 16, v116
    v_and_b32 v85, 0xffff0000, v116
    v_pk_add_f32 v[56:57], v[56:57], v[84:85]
    v_lshlrev_b32 v86, 16, v117
    v_and_b32 v87, 0xffff0000, v117
    v_pk_add_f32 v[58:59], v[58:59], v[86:87]
    v_lshlrev_b32 v84, 16, v118
    v_and_b32 v85, 0xffff0000, v118
    v_pk_add_f32 v[60:61], v[60:61], v[84:85]
    v_lshlrev_b32 v86, 16, v119
    v_and_b32 v87, 0xffff0000, v119
    v_pk_add_f32 v[62:63], v[62:63], v[86:87]
    s_waitcnt vmcnt(0)
    v_lshlrev_b32 v84, 16, v120
    v_and_b32 v85, 0xffff0000, v120
    v_pk_add_f32 v[56:57], v[56:57], v[84:85]
    v_lshlrev_b32 v86, 16, v121
    v_and_b32 v87, 0xffff0000, v121
    v_pk_add_f32 v[58:59], v[58:59], v[86:87]
    v_lshlrev_b32 v84, 16, v122
    v_and_b32 v85, 0xffff0000, v122
    v_pk_add_f32 v[60:61], v[60:61], v[84:85]
    v_lshlrev_b32 v86, 16, v123
    v_and_b32 v87, 0xffff0000, v123
    v_pk_add_f32 v[62:63], v[62:63], v[86:87]
    v_cvt_pk_bf16_f32 v56, v56, v56
    v_and_b32 v56, 0xffff0000, v56
    v_mul_f32 v56, v56, v36
    v_cvt_pk_bf16_f32 v56, v56, v56
    v_and_b32 v56, 0xffff0000, v56
    v_add_f32 v48, v48, v56
    v_cvt_pk_bf16_f32 v57, v57, v57
    v_and_b32 v57, 0xffff0000, v57
    v_mul_f32 v57, v57, v37
    v_cvt_pk_bf16_f32 v57, v57, v57
    v_and_b32 v57, 0xffff0000, v57
    v_add_f32 v49, v49, v57
    v_cvt_pk_bf16_f32 v58, v58, v58
    v_and_b32 v58, 0xffff0000, v58
    v_mul_f32 v58, v58, v38
    v_cvt_pk_bf16_f32 v58, v58, v58
    v_and_b32 v58, 0xffff0000, v58
    v_add_f32 v50, v50, v58
    v_cvt_pk_bf16_f32 v59, v59, v59
    v_and_b32 v59, 0xffff0000, v59
    v_mul_f32 v59, v59, v39
    v_cvt_pk_bf16_f32 v59, v59, v59
    v_and_b32 v59, 0xffff0000, v59
    v_add_f32 v51, v51, v59
    v_cvt_pk_bf16_f32 v60, v60, v60
    v_and_b32 v60, 0xffff0000, v60
    v_mul_f32 v60, v60, v40
    v_cvt_pk_bf16_f32 v60, v60, v60
    v_and_b32 v60, 0xffff0000, v60
    v_add_f32 v52, v52, v60
    v_cvt_pk_bf16_f32 v61, v61, v61
    v_and_b32 v61, 0xffff0000, v61
    v_mul_f32 v61, v61, v41
    v_cvt_pk_bf16_f32 v61, v61, v61
    v_and_b32 v61, 0xffff0000, v61
    v_add_f32 v53, v53, v61
    v_cvt_pk_bf16_f32 v62, v62, v62
    v_and_b32 v62, 0xffff0000, v62
    v_mul_f32 v62, v62, v42
    v_cvt_pk_bf16_f32 v62, v62, v62
    v_and_b32 v62, 0xffff0000, v62
    v_add_f32 v54, v54, v62
    v_cvt_pk_bf16_f32 v63, v63, v63
    v_and_b32 v63, 0xffff0000, v63
    v_mul_f32 v63, v63, v43
    v_cvt_pk_bf16_f32 v63, v63, v63
    v_and_b32 v63, 0xffff0000, v63
    v_add_f32 v55, v55, v63
    v_cvt_pk_bf16_f32 v64, v48, v49
    v_cvt_pk_bf16_f32 v65, v50, v51
    v_cvt_pk_bf16_f32 v66, v52, v53
    v_cvt_pk_bf16_f32 v67, v54, v55
    buffer_store_dwordx2 v[64:65], v17, s[8:11], 0 offen
    buffer_store_dwordx2 v[66:67], v19, s[8:11], 0 offen
L_fdone:
    s_endpgm
L_rareL:
    v_max3_f32 v7, v12, v13, v14
    v_max3_f32 v7, v7, v15, v16
    v_max3_f32 v7, v7, v17, v18
    v_max_f32 v7, v7, v19
    v_mov_b32 v9, v7
    v_mov_b32 v10, v7
    s_nop 1
    v_permlane32_swap_b32 v9, v10
    s_nop 1
    v_max_f32 v9, v9, v10
    v_mov_b32 v10, v9
    s_nop 1
    v_permlane16_swap_b32 v9, v10
    s_nop 1
    v_max_f32 v7, v9, v10
    v_max_f32 v7, 0, v7
    v_sub_f32 v8, 0, v7
    v_exp_f32 v8, v8
    s_nop 1
    v_mul_f32 v36, v36, v8
    v_mul_f32 v37, v37, v8
    v_mul_f32 v38, v38, v8
    v_mul_f32 v39, v39, v8
    v_mul_f32 v44, v44, v8
    v_mul_f32 v45, v45, v8
    v_mul_f32 v46, v46, v8
    v_mul_f32 v47, v47, v8
    v_mul_f32 v52, v52, v8
    v_mul_f32 v53, v53, v8
    v_mul_f32 v54, v54, v8
    v_mul_f32 v55, v55, v8
    v_mul_f32 v60, v60, v8
    v_mul_f32 v61, v61, v8
    v_mul_f32 v62, v62, v8
    v_mul_f32 v63, v63, v8
    v_mul_f32 v68, v68, v8
    v_mul_f32 v69, v69, v8
    v_mul_f32 v70, v70, v8
    v_mul_f32 v71, v71, v8
    v_mul_f32 v76, v76, v8
    v_mul_f32 v77, v77, v8
    v_mul_f32 v78, v78, v8
    v_mul_f32 v79, v79, v8
    v_mul_f32 v84, v84, v8
    v_mul_f32 v85, v85, v8
    v_mul_f32 v86, v86, v8
    v_mul_f32 v87, v87, v8
    v_mul_f32 v92, v92, v8
    v_mul_f32 v93, v93, v8
    v_mul_f32 v94, v94, v8
    v_mul_f32 v95, v95, v8
    v_mul_f32 v100, v100, v8
    v_mul_f32 v101, v101, v8
    v_mul_f32 v102, v102, v8
    v_mul_f32 v103, v103, v8
    v_mul_f32 v108, v108, v8
    v_mul_f32 v109, v109, v8
    v_mul_f32 v110, v110, v8
    v_mul_f32 v111, v111, v8
    v_mul_f32 v116, v116, v8
    v_mul_f32 v117, v117, v8
    v_mul_f32 v118, v118, v8
    v_mul_f32 v119, v119, v8
    v_mul_f32 v124, v124, v8
    v_mul_f32 v125, v125, v8
    v_mul_f32 v126, v126, v8
    v_mul_f32 v127, v127, v8
    v_mul_f32 v132, v132, v8
    v_mul_f32 v133, v133, v8
    v_mul_f32 v134, v134, v8
    v_mul_f32 v135, v135, v8
    v_mul_f32 v140, v140, v8
    v_mul_f32 v141, v141, v8
    v_mul_f32 v142, v142, v8
    v_mul_f32 v143, v143, v8
    v_mul_f32 v148, v148, v8
    v_mul_f32 v149, v149, v8
    v_mul_f32 v150, v150, v8
    v_mul_f32 v151, v151, v8
    v_mul_f32 v156, v156, v8
    v_mul_f32 v157, v157, v8
    v_mul_f32 v158, v158, v8
    v_mul_f32 v159, v159, v8
    v_mul_f32 v5, v5, v8
    v_sub_f32 v28, v28, v7
    v_sub_f32 v29, v29, v7
    v_sub_f32 v30, v30, v7
    v_sub_f32 v31, v31, v7
    v_sub_f32 v12, v12, v7
    v_sub_f32 v13, v13, v7
    v_sub_f32 v14, v14, v7
    v_sub_f32 v15, v15, v7
    v_sub_f32 v16, v16, v7
    v_sub_f32 v17, v17, v7
    v_sub_f32 v18, v18, v7
    v_sub_f32 v19, v19, v7
    v_max3_f32 v7, v20, v21, v22
    v_max3_f32 v7, v7, v23, v24
    v_max3_f32 v7, v7, v25, v26
    v_max_f32 v7, v7, v27
    v_mov_b32 v9, v7
    v_mov_b32 v10, v7
    s_nop 1
    v_permlane32_swap_b32 v9, v10
    s_nop 1
    v_max_f32 v9, v9, v10
    v_mov_b32 v10, v9
    s_nop 1
    v_permlane16_swap_b32 v9, v10
    s_nop 1
    v_max_f32 v7, v9, v10
    v_max_f32 v7, 0, v7
    v_sub_f32 v8, 0, v7
    v_exp_f32 v8, v8
    s_nop 1
    v_mul_f32 v40, v40, v8
    v_mul_f32 v41, v41, v8
    v_mul_f32 v42, v42, v8
    v_mul_f32 v43, v43, v8
    v_mul_f32 v48, v48, v8
    v_mul_f32 v49, v49, v8
    v_mul_f32 v50, v50, v8
    v_mul_f32 v51, v51, v8
    v_mul_f32 v56, v56, v8
    v_mul_f32 v57, v57, v8
    v_mul_f32 v58, v58, v8
    v_mul_f32 v59, v59, v8
    v_mul_f32 v64, v64, v8
    v_mul_f32 v65, v65, v8
    v_mul_f32 v66, v66, v8
    v_mul_f32 v67, v67, v8
    v_mul_f32 v72, v72, v8
    v_mul_f32 v73, v73, v8
    v_mul_f32 v74, v74, v8
    v_mul_f32 v75, v75, v8
    v_mul_f32 v80, v80, v8
    v_mul_f32 v81, v81, v8
    v_mul_f32 v82, v82, v8
    v_mul_f32 v83, v83, v8
    v_mul_f32 v88, v88, v8
    v_mul_f32 v89, v89, v8
    v_mul_f32 v90, v90, v8
    v_mul_f32 v91, v91, v8
    v_mul_f32 v96, v96, v8
    v_mul_f32 v97, v97, v8
    v_mul_f32 v98, v98, v8
    v_mul_f32 v99, v99, v8
    v_mul_f32 v104, v104, v8
    v_mul_f32 v105, v105, v8
    v_mul_f32 v106, v106, v8
    v_mul_f32 v107, v107, v8
    v_mul_f32 v112, v112, v8
    v_mul_f32 v113, v113, v8
    v_mul_f32 v114, v114, v8
    v_mul_f32 v115, v115, v8
    v_mul_f32 v120, v120, v8
    v_mul_f32 v121, v121, v8
    v_mul_f32 v122, v122, v8
    v_mul_f32 v123, v123, v8
    v_mul_f32 v128, v128, v8
    v_mul_f32 v129, v129, v8
    v_mul_f32 v130, v130, v8
    v_mul_f32 v131, v131, v8
    v_mul_f32 v136, v136, v8
    v_mul_f32 v137, v137, v8
    v_mul_f32 v138, v138, v8
    v_mul_f32 v139, v139, v8
    v_mul_f32 v144, v144, v8
    v_mul_f32 v145, v145, v8
    v_mul_f32 v146, v146, v8
    v_mul_f32 v147, v147, v8
    v_mul_f32 v152, v152, v8
    v_mul_f32 v153, v153, v8
    v_mul_f32 v154, v154, v8
    v_mul_f32 v155, v155, v8
    v_mul_f32 v160, v160, v8
    v_mul_f32 v161, v161, v8
    v_mul_f32 v162, v162, v8
    v_mul_f32 v163, v163, v8
    v_mul_f32 v6, v6, v8
    v_sub_f32 v32, v32, v7
    v_sub_f32 v33, v33, v7
    v_sub_f32 v34, v34, v7
    v_sub_f32 v35, v35, v7
    v_sub_f32 v20, v20, v7
    v_sub_f32 v21, v21, v7
    v_sub_f32 v22, v22, v7
    v_sub_f32 v23, v23, v7
    v_sub_f32 v24, v24, v7
    v_sub_f32 v25, v25, v7
    v_sub_f32 v26, v26, v7
    v_sub_f32 v27, v27, v7
    s_nop 1
    s_branch L_backL
L_rareP1:
    v_max3_f32 v7, v12, v13, v14
    v_max3_f32 v7, v7, v15, v16
    v_max3_f32 v7, v7, v17, v18
    v_max_f32 v7, v7, v19
    v_mov_b32 v9, v7
    v_mov_b32 v10, v7
    s_nop 1
    v_permlane32_swap_b32 v9, v10
    s_nop 1
    v_max_f32 v9, v9, v10
    v_mov_b32 v10, v9
    s_nop 1
    v_permlane16_swap_b32 v9, v10
    s_nop 1
    v_max_f32 v7, v9, v10
    v_max_f32 v7, 0, v7
    v_sub_f32 v8, 0, v7
    v_exp_f32 v8, v8
    s_nop 1
    v_mul_f32 v36, v36, v8
    v_mul_f32 v37, v37, v8
    v_mul_f32 v38, v38, v8
    v_mul_f32 v39, v39, v8
    v_mul_f32 v44, v44, v8
    v_mul_f32 v45, v45, v8
    v_mul_f32 v46, v46, v8
    v_mul_f32 v47, v47, v8
    v_mul_f32 v52, v52, v8
    v_mul_f32 v53, v53, v8
    v_mul_f32 v54, v54, v8
    v_mul_f32 v55, v55, v8
    v_mul_f32 v60, v60, v8
    v_mul_f32 v61, v61, v8
    v_mul_f32 v62, v62, v8
    v_mul_f32 v63, v63, v8
    v_mul_f32 v68, v68, v8
    v_mul_f32 v69, v69, v8
    v_mul_f32 v70, v70, v8
    v_mul_f32 v71, v71, v8
    v_mul_f32 v76, v76, v8
    v_mul_f32 v77, v77, v8
    v_mul_f32 v78, v78, v8
    v_mul_f32 v79, v79, v8
    v_mul_f32 v84, v84, v8
    v_mul_f32 v85, v85, v8
    v_mul_f32 v86, v86, v8
    v_mul_f32 v87, v87, v8
    v_mul_f32 v92, v92, v8
    v_mul_f32 v93, v93, v8
    v_mul_f32 v94, v94, v8
    v_mul_f32 v95, v95, v8
    v_mul_f32 v100, v100, v8
    v_mul_f32 v101, v101, v8
    v_mul_f32 v102, v102, v8
    v_mul_f32 v103, v103, v8
    v_mul_f32 v108, v108, v8
    v_mul_f32 v109, v109, v8
    v_mul_f32 v110, v110, v8
    v_mul_f32 v111, v111, v8
    v_mul_f32 v116, v116, v8
    v_mul_f32 v117, v117, v8
    v_mul_f32 v118, v118, v8
    v_mul_f32 v119, v119, v8
    v_mul_f32 v124, v124, v8
    v_mul_f32 v125, v125, v8
    v_mul_f32 v126, v126, v8
    v_mul_f32 v127, v127, v8
    v_mul_f32 v132, v132, v8
    v_mul_f32 v133, v133, v8
    v_mul_f32 v134, v134, v8
    v_mul_f32 v135, v135, v8
    v_mul_f32 v140, v140, v8
    v_mul_f32 v141, v141, v8
    v_mul_f32 v142, v142, v8
    v_mul_f32 v143, v143, v8
    v_mul_f32 v148, v148, v8
    v_mul_f32 v149, v149, v8
    v_mul_f32 v150, v150, v8
    v_mul_f32 v151, v151, v8
    v_mul_f32 v156, v156, v8
    v_mul_f32 v157, v157, v8
    v_mul_f32 v158, v158, v8
    v_mul_f32 v159, v159, v8
    v_mul_f32 v5, v5, v8
    v_sub_f32 v28, v28, v7
    v_sub_f32 v29, v29, v7
    v_sub_f32 v30, v30, v7
    v_sub_f32 v31, v31, v7
    v_sub_f32 v12, v12, v7
    v_sub_f32 v13, v13, v7
    v_sub_f32 v14, v14, v7
    v_sub_f32 v15, v15, v7
    v_sub_f32 v16, v16, v7
    v_sub_f32 v17, v17, v7
    v_sub_f32 v18, v18, v7
    v_sub_f32 v19, v19, v7
    v_max3_f32 v7, v20, v21, v22
    v_max3_f32 v7, v7, v23, v24
    v_max3_f32 v7, v7, v25, v26
    v_max_f32 v7, v7, v27
    v_mov_b32 v9, v7
    v_mov_b32 v10, v7
    s_nop 1
    v_permlane32_swap_b32 v9, v10
    s_nop 1
    v_max_f32 v9, v9, v10
    v_mov_b32 v10, v9
    s_nop 1
    v_permlane16_swap_b32 v9, v10
    s_nop 1
    v_max_f32 v7, v9, v10
    v_max_f32 v7, 0, v7
    v_sub_f32 v8, 0, v7
    v_exp_f32 v8, v8
    s_nop 1
    v_mul_f32 v40, v40, v8
    v_mul_f32 v41, v41, v8
    v_mul_f32 v42, v42, v8
    v_mul_f32 v43, v43, v8
    v_mul_f32 v48, v48, v8
    v_mul_f32 v49, v49, v8
    v_mul_f32 v50, v50, v8
    v_mul_f32 v51, v51, v8
    v_mul_f32 v56, v56, v8
    v_mul_f32 v57, v57, v8
    v_mul_f32 v58, v58, v8
    v_mul_f32 v59, v59, v8
    v_mul_f32 v64, v64, v8
    v_mul_f32 v65, v65, v8
    v_mul_f32 v66, v66, v8
    v_mul_f32 v67, v67, v8
    v_mul_f32 v72, v72, v8
    v_mul_f32 v73, v73, v8
    v_mul_f32 v74, v74, v8
    v_mul_f32 v75, v75, v8
    v_mul_f32 v80, v80, v8
    v_mul_f32 v81, v81, v8
    v_mul_f32 v82, v82, v8
    v_mul_f32 v83, v83, v8
    v_mul_f32 v88, v88, v8
    v_mul_f32 v89, v89, v8
    v_mul_f32 v90, v90, v8
    v_mul_f32 v91, v91, v8
    v_mul_f32 v96, v96, v8
    v_mul_f32 v97, v97, v8
    v_mul_f32 v98, v98, v8
    v_mul_f32 v99, v99, v8
    v_mul_f32 v104, v104, v8
    v_mul_f32 v105, v105, v8
    v_mul_f32 v106, v106, v8
    v_mul_f32 v107, v107, v8
    v_mul_f32 v112, v112, v8
    v_mul_f32 v113, v113, v8
    v_mul_f32 v114, v114, v8
    v_mul_f32 v115, v115, v8
    v_mul_f32 v120, v120, v8
    v_mul_f32 v121, v121, v8
    v_mul_f32 v122, v122, v8
    v_mul_f32 v123, v123, v8
    v_mul_f32 v128, v128, v8
    v_mul_f32 v129, v129, v8
    v_mul_f32 v130, v130, v8
    v_mul_f32 v131, v131, v8
    v_mul_f32 v136, v136, v8
    v_mul_f32 v137, v137, v8
    v_mul_f32 v138, v138, v8
    v_mul_f32 v139, v139, v8
    v_mul_f32 v144, v144, v8
    v_mul_f32 v145, v145, v8
    v_mul_f32 v146, v146, v8
    v_mul_f32 v147, v147, v8
    v_mul_f32 v152, v152, v8
    v_mul_f32 v153, v153, v8
    v_mul_f32 v154, v154, v8
    v_mul_f32 v155, v155, v8
    v_mul_f32 v160, v160, v8
    v_mul_f32 v161, v161, v8
    v_mul_f32 v162, v162, v8
    v_mul_f32 v163, v163, v8
    v_mul_f32 v6, v6, v8
    v_sub_f32 v32, v32, v7
    v_sub_f32 v33, v33, v7
    v_sub_f32 v34, v34, v7
    v_sub_f32 v35, v35, v7
    v_sub_f32 v20, v20, v7
    v_sub_f32 v21, v21, v7
    v_sub_f32 v22, v22, v7
    v_sub_f32 v23, v23, v7
    v_sub_f32 v24, v24, v7
    v_sub_f32 v25, v25, v7
    v_sub_f32 v26, v26, v7
    v_sub_f32 v27, v27, v7
    s_nop 1
    s_branch L_backP1
L_rareP2:
    v_max3_f32 v7, v12, v13, v14
    v_max3_f32 v7, v7, v15, v16
    v_max3_f32 v7, v7, v17, v18
    v_max_f32 v7, v7, v19
    v_mov_b32 v9, v7
    v_mov_b32 v10, v7
    s_nop 1
    v_permlane32_swap_b32 v9, v10
    s_nop 1
    v_max_f32 v9, v9, v10
    v_mov_b32 v10, v9
    s_nop 1
    v_permlane16_swap_b32 v9, v10
    s_nop 1
    v_max_f32 v7, v9, v10
    v_max_f32 v7, 0, v7
    v_sub_f32 v8, 0, v7
    v_exp_f32 v8, v8
    s_nop 1
    v_mul_f32 v36, v36, v8
    v_mul_f32 v37, v37, v8
    v_mul_f32 v38, v38, v8
    v_mul_f32 v39, v39, v8
    v_mul_f32 v44, v44, v8
    v_mul_f32 v45, v45, v8
    v_mul_f32 v46, v46, v8
    v_mul_f32 v47, v47, v8
    v_mul_f32 v52, v52, v8
    v_mul_f32 v53, v53, v8
    v_mul_f32 v54, v54, v8
    v_mul_f32 v55, v55, v8
    v_mul_f32 v60, v60, v8
    v_mul_f32 v61, v61, v8
    v_mul_f32 v62, v62, v8
    v_mul_f32 v63, v63, v8
    v_mul_f32 v68, v68, v8
    v_mul_f32 v69, v69, v8
    v_mul_f32 v70, v70, v8
    v_mul_f32 v71, v71, v8
    v_mul_f32 v76, v76, v8
    v_mul_f32 v77, v77, v8
    v_mul_f32 v78, v78, v8
    v_mul_f32 v79, v79, v8
    v_mul_f32 v84, v84, v8
    v_mul_f32 v85, v85, v8
    v_mul_f32 v86, v86, v8
    v_mul_f32 v87, v87, v8
    v_mul_f32 v92, v92, v8
    v_mul_f32 v93, v93, v8
    v_mul_f32 v94, v94, v8
    v_mul_f32 v95, v95, v8
    v_mul_f32 v100, v100, v8
    v_mul_f32 v101, v101, v8
    v_mul_f32 v102, v102, v8
    v_mul_f32 v103, v103, v8
    v_mul_f32 v108, v108, v8
    v_mul_f32 v109, v109, v8
    v_mul_f32 v110, v110, v8
    v_mul_f32 v111, v111, v8
    v_mul_f32 v116, v116, v8
    v_mul_f32 v117, v117, v8
    v_mul_f32 v118, v118, v8
    v_mul_f32 v119, v119, v8
    v_mul_f32 v124, v124, v8
    v_mul_f32 v125, v125, v8
    v_mul_f32 v126, v126, v8
    v_mul_f32 v127, v127, v8
    v_mul_f32 v132, v132, v8
    v_mul_f32 v133, v133, v8
    v_mul_f32 v134, v134, v8
    v_mul_f32 v135, v135, v8
    v_mul_f32 v140, v140, v8
    v_mul_f32 v141, v141, v8
    v_mul_f32 v142, v142, v8
    v_mul_f32 v143, v143, v8
    v_mul_f32 v148, v148, v8
    v_mul_f32 v149, v149, v8
    v_mul_f32 v150, v150, v8
    v_mul_f32 v151, v151, v8
    v_mul_f32 v156, v156, v8
    v_mul_f32 v157, v157, v8
    v_mul_f32 v158, v158, v8
    v_mul_f32 v159, v159, v8
    v_mul_f32 v5, v5, v8
    v_sub_f32 v28, v28, v7
    v_sub_f32 v29, v29, v7
    v_sub_f32 v30, v30, v7
    v_sub_f32 v31, v31, v7
    v_sub_f32 v12, v12, v7
    v_sub_f32 v13, v13, v7
    v_sub_f32 v14, v14, v7
    v_sub_f32 v15, v15, v7
    v_sub_f32 v16, v16, v7
    v_sub_f32 v17, v17, v7
    v_sub_f32 v18, v18, v7
    v_sub_f32 v19, v19, v7
    v_max3_f32 v7, v20, v21, v22
    v_max3_f32 v7, v7, v23, v24
    v_max3_f32 v7, v7, v25, v26
    v_max_f32 v7, v7, v27
    v_mov_b32 v9, v7
    v_mov_b32 v10, v7
    s_nop 1
    v_permlane32_swap_b32 v9, v10
    s_nop 1
    v_max_f32 v9, v9, v10
    v_mov_b32 v10, v9
    s_nop 1
    v_permlane16_swap_b32 v9, v10
    s_nop 1
    v_max_f32 v7, v9, v10
    v_max_f32 v7, 0, v7
    v_sub_f32 v8, 0, v7
    v_exp_f32 v8, v8
    s_nop 1
    v_mul_f32 v40, v40, v8
    v_mul_f32 v41, v41, v8
    v_mul_f32 v42, v42, v8
    v_mul_f32 v43, v43, v8
    v_mul_f32 v48, v48, v8
    v_mul_f32 v49, v49, v8
    v_mul_f32 v50, v50, v8
    v_mul_f32 v51, v51, v8
    v_mul_f32 v56, v56, v8
    v_mul_f32 v57, v57, v8
    v_mul_f32 v58, v58, v8
    v_mul_f32 v59, v59, v8
    v_mul_f32 v64, v64, v8
    v_mul_f32 v65, v65, v8
    v_mul_f32 v66, v66, v8
    v_mul_f32 v67, v67, v8
    v_mul_f32 v72, v72, v8
    v_mul_f32 v73, v73, v8
    v_mul_f32 v74, v74, v8
    v_mul_f32 v75, v75, v8
    v_mul_f32 v80, v80, v8
    v_mul_f32 v81, v81, v8
    v_mul_f32 v82, v82, v8
    v_mul_f32 v83, v83, v8
    v_mul_f32 v88, v88, v8
    v_mul_f32 v89, v89, v8
    v_mul_f32 v90, v90, v8
    v_mul_f32 v91, v91, v8
    v_mul_f32 v96, v96, v8
    v_mul_f32 v97, v97, v8
    v_mul_f32 v98, v98, v8
    v_mul_f32 v99, v99, v8
    v_mul_f32 v104, v104, v8
    v_mul_f32 v105, v105, v8
    v_mul_f32 v106, v106, v8
    v_mul_f32 v107, v107, v8
    v_mul_f32 v112, v112, v8
    v_mul_f32 v113, v113, v8
    v_mul_f32 v114, v114, v8
    v_mul_f32 v115, v115, v8
    v_mul_f32 v120, v120, v8
    v_mul_f32 v121, v121, v8
    v_mul_f32 v122, v122, v8
    v_mul_f32 v123, v123, v8
    v_mul_f32 v128, v128, v8
    v_mul_f32 v129, v129, v8
    v_mul_f32 v130, v130, v8
    v_mul_f32 v131, v131, v8
    v_mul_f32 v136, v136, v8
    v_mul_f32 v137, v137, v8
    v_mul_f32 v138, v138, v8
    v_mul_f32 v139, v139, v8
    v_mul_f32 v144, v144, v8
    v_mul_f32 v145, v145, v8
    v_mul_f32 v146, v146, v8
    v_mul_f32 v147, v147, v8
    v_mul_f32 v152, v152, v8
    v_mul_f32 v153, v153, v8
    v_mul_f32 v154, v154, v8
    v_mul_f32 v155, v155, v8
    v_mul_f32 v160, v160, v8
    v_mul_f32 v161, v161, v8
    v_mul_f32 v162, v162, v8
    v_mul_f32 v163, v163, v8
    v_mul_f32 v6, v6, v8
    v_sub_f32 v32, v32, v7
    v_sub_f32 v33, v33, v7
    v_sub_f32 v34, v34, v7
    v_sub_f32 v35, v35, v7
    v_sub_f32 v20, v20, v7
    v_sub_f32 v21, v21, v7
    v_sub_f32 v22, v22, v7
    v_sub_f32 v23, v23, v7
    v_sub_f32 v24, v24, v7
    v_sub_f32 v25, v25, v7
    v_sub_f32 v26, v26, v7
    v_sub_f32 v27, v27, v7
    s_nop 1
    s_branch L_backP2
L_end:
    s_endpgm
L_codeend:
.section .rodata,"a"
.p2align 6
.amdhsa_kernel recurrent_scan__gqa_block_cached__mixer_channel_mlp__prompt_kernel
  .amdhsa_next_free_vgpr 256
  .amdhsa_next_free_sgpr 102
  .amdhsa_accum_offset 164
  .amdhsa_group_segment_fixed_size 0
  .amdhsa_kernarg_size 104
  .amdhsa_user_sgpr_count 2
  .amdhsa_user_sgpr_kernarg_segment_ptr 1
  .amdhsa_system_sgpr_workgroup_id_x 1
.end_amdhsa_kernel
```
